```python
import torch

def _softmax(x, axis=-1):
    return torch.softmax(x, dim=axis)
def _gelu(x):
    return torch.nn.functional.gelu(x, approximate="tanh")
def _silu(x):
    return torch.nn.functional.silu(x)
def _sigmoid(x):
    return torch.sigmoid(x)
def _layernorm(x, axis=-1, eps=1e-5):
    m = x.mean(dim=axis, keepdim=True)
    v = x.var(dim=axis, keepdim=True, unbiased=False)
    return (x - m) / torch.sqrt(v + eps)
def _scatter_add(tgt, idx, src, axis=0):
    return tgt.clone().index_add_(axis, idx, src)
def _segment_sum(src, seg, n):
    out = torch.zeros((n,) + src.shape[1:], dtype=src.dtype)
    return out.index_add_(0, seg, src)
def _pad(x, pw):
    flat = tuple(v for pair in reversed(pw) for v in pair)
    return torch.nn.functional.pad(x, flat)

kernel_name = 'recurrent_scan__linear_attn_block__glu_gated_geglu__prompt'

def setup_inputs():

    _w = (lambda a: (lambda t: t.to(torch.bfloat16) if t.is_floating_point() else t)(torch.as_tensor(a)))
    def _A_setup():
        B, S, D = 1, 2048, 512
        return {
            "x": _w((lambda *s: torch.randn(*s, dtype=torch.bfloat16) * 0.05)(B, S, D)),
            "wqkv": _w((lambda *s: torch.randn(*s, dtype=torch.bfloat16) * 0.8)(D, 3 * D)),
            "wo": _w((lambda *s: torch.randn(*s, dtype=torch.bfloat16) * 0.8)(D, D)),
        }
    _A_in = _A_setup()

    def _B_setup():
        B, S, Dm, Df = 1, 2048, 512, 1792
        return {
            "x": _w((lambda *s: torch.randn(*s, dtype=torch.bfloat16) * 0.05)(B, S, Dm)),
            "w_gate": _w((lambda *s: torch.randn(*s, dtype=torch.bfloat16) * 0.2)(Dm, Df) * (Dm ** -0.5)),
            "w_up": _w((lambda *s: torch.randn(*s, dtype=torch.bfloat16) * 0.2)(Dm, Df) * (Dm ** -0.5)),
            "w_down": _w((lambda *s: torch.randn(*s, dtype=torch.bfloat16) * 0.2)(Df, Dm) * (Df ** -0.5)),
        }
    _B_in = _B_setup()

    return {
        "A_x": _A_in["x"],
        "A_wqkv": _A_in["wqkv"],
        "A_wo": _A_in["wo"],
        "B_x": _B_in["x"],
        "B_w_gate": _B_in["w_gate"],
        "B_w_up": _B_in["w_up"],
        "B_w_down": _B_in["w_down"],
    }

def reference(A_x, A_wqkv, A_wo, B_x, B_w_gate, B_w_up, B_w_down):
    def _A_ref(x, wqkv, wo):
        B, S, D = x.shape
        H = 32; Dh = D // H
        qkv = (lambda x, *d: x.permute(*d))((x @ wqkv).reshape(B, S, 3, H, Dh), 2, 0, 3, 1, 4)
        q, k, v = qkv[0], qkv[1], qkv[2]
        phi = lambda t: torch.where(t > 0, t + 1, torch.exp(t)) + 1e-6
        pq, pk = phi(q), phi(k)
        kv = torch.einsum("bhsd,bhse->bhde", pk, v)
        z = torch.einsum("bhsd->bhd", pk)
        num = torch.einsum("bhqd,bhde->bhqe", pq, kv)
        den = torch.einsum("bhqd,bhd->bhq", pq, z)[..., None] + 1e-6
        o = num / den
        return (lambda x, *d: x.permute(*d))(o, 0, 2, 1, 3).reshape(B, S, D) @ wo

    def _B_ref(x, w_gate, w_up, w_down):
        g = torch.einsum("bsd,df->bsf", x, w_gate)
        u = torch.einsum("bsd,df->bsf", x, w_up)
        h = _gelu(g) * u
        return torch.einsum("bsf,fd->bsd", h, w_down)

    x = A_x
    xn = _layernorm(x, axis=-1)
    s = _A_ref(xn, A_wqkv, A_wo)
    g = _silu(_B_ref(xn, B_w_gate, B_w_up, B_w_down))
    return x + s * g
```

```asm
; @launch grid=(256,1,1) block=(512,1,1) lds=163840
.amdgcn_target "amdgcn-amd-amdhsa--gfx950"
.text
.globl recurrent_scan__linear_attn_block__glu_gated_geglu__prompt_kernel
.p2align 8
.type recurrent_scan__linear_attn_block__glu_gated_geglu__prompt_kernel,@function
recurrent_scan__linear_attn_block__glu_gated_geglu__prompt_kernel:
  s_cmp_ge_u32 s2, 256
  s_cbranch_scc1 L_k1_exit
  s_getpc_b64 s[80:81]
  s_bfe_u32 s3, s2, 0x30003
  s_lshl_b32 s3, s3, 13
  v_lshl_add_u32 v255, v0, 4, s3
  global_load_dwordx4 v[236:239], v255, s[80:81]
  s_memtime s[96:97]
  s_load_dwordx16 s[4:19], s[0:1], 0
  s_load_dwordx4 s[20:23], s[0:1], 64
  s_getpc_b64 s[80:81]
L_k1_pc:
  v_lshlrev_b32 v27, 4, v0
  v_and_b32 v12, 63, v0
  v_lshrrev_b32 v20, 6, v0
  v_lshlrev_b32 v1, 4, v12
  v_readfirstlane_b32 s48, v20
  s_and_b32 s60, s2, 7
  s_lshr_b32 s77, s2, 3
  s_lshr_b32 s61, s60, 1
  s_and_b32 s78, s60, 1
  s_lshr_b32 s62, s77, 2
  s_lshl_b32 s63, s78, 3
  s_add_u32 s62, s62, s63
  s_mov_b32 s83, s62
  s_and_b32 s79, s62, 1
  s_cmp_eq_u32 s79, 0
  s_mov_b32 s63, L_k1_E-L_k1_pc
  s_mov_b32 s93, L_k1_O-L_k1_pc
  s_cselect_b32 s63, s63, s93
  s_add_u32 s80, s80, s63
  s_addc_u32 s81, s81, 0
  s_lshr_b32 s52, s62, 1
  s_lshl_b32 s51, s61, 2
  s_and_b32 s62, s77, 3
  s_add_u32 s51, s51, s62
  s_and_b32 s49, s48, 3
  s_lshr_b32 s50, s48, 2
  s_and_b32 s60, s51, 3
  s_lshl_b32 s60, s60, 1
  s_add_u32 s3, s60, s83
  s_and_b32 s61, s83, 7
  s_add_u32 s60, s60, s61
  s_sub_u32 s61, s60, 7
  s_cmp_ge_u32 s60, 7
  s_cselect_b32 s60, s61, s60
  s_lshl_b32 s60, s60, 2
  s_mov_b32 s61, 0x7654321
  s_lshr_b32 s3, s61, s60
  s_sub_u32 s60, 28, s60
  s_lshl_b32 s61, s61, s60
  s_or_b32 s3, s3, s61
  s_lshl_b32 s3, s3, 4
  s_lshl_b32 s53, s51, 17
  s_lshl_b32 s54, s48, 10
  s_lshl_b32 s55, s48, 11
  s_lshl_b32 s58, s52, 7
  v_lshrrev_b32 v20, 3, v12
  s_lshl_b32 s60, s48, 4
  v_add_u32 v25, s60, v20
  v_lshlrev_b32 v23, 10, v25
  v_and_b32 v21, 7, v12
  v_lshrrev_b32 v22, 4, v12
  v_xor_b32 v22, v21, v22
  v_lshl_add_u32 v10, v22, 4, v23
  v_xor_b32 v11, 64, v10
  v_add_u32 v11, 0x2000, v11
  v_lshrrev_b32 v22, 2, v12
  v_and_b32 v22, 4, v22
  v_xor_b32 v21, v21, v22
  v_lshlrev_b32 v21, 4, v21
  s_lshl_b32 s60, s48, 3
  v_add_u32 v23, s60, v20
  v_mul_u32_u24 v8, 3584, v23
  v_add_u32 v8, v8, v21
  s_lshl_b32 s60, s49, 4
  v_add_u32 v25, s60, v20
  s_cmp_eq_u32 s79, 0
  s_cselect_b64 vcc, -1, 0
  v_cndmask_b32 v23, v23, v25
  v_mul_u32_u24 v9, 3072, v23
  v_add_u32 v9, v9, v21
  s_mul_i32 s60, s52, 224
  s_and_b32 s61, s52, 1
  s_lshl_b32 s61, s61, 1
  s_add_u32 s61, s61, s79
  s_mov_b32 s62, 0
  s_mov_b32 s63, 64
  s_cmp_eq_u32 s61, 1
  s_cselect_b32 s62, 128, s62
  s_cselect_b32 s63, 192, s63
  s_cmp_eq_u32 s61, 2
  s_cselect_b32 s62, 96, s62
  s_cselect_b32 s63, 160, s63
  s_cmp_eq_u32 s61, 3
  s_cselect_b32 s62, 32, s62
  s_cselect_b32 s63, 0, s63
  s_add_u32 s62, s62, s60
  s_add_u32 s63, s63, s60
  s_lshl_b32 s56, s62, 1
  s_lshl_b32 s57, s63, 1
  s_waitcnt lgkmcnt(0)
  s_mov_b32 s24, s4
  s_mov_b32 s25, s5
  s_mov_b32 s26, 0x200000
  s_mov_b32 s27, 0x20000
  s_add_u32 m0, s55, 0
  s_bfe_u32 s60, s3, 0x40000
  s_mul_i32 s60, s60, 128
  s_add_u32 s60, s60, s53
  buffer_load_dwordx4 v10, s[24:27], s60 offen lds
  s_add_u32 m0, s55, 1024
  s_bfe_u32 s60, s3, 0x40000
  s_mul_i32 s60, s60, 128
  s_add_u32 s60, s60, s53
  buffer_load_dwordx4 v11, s[24:27], s60 offen lds
  s_mov_b32 s28, s6
  s_mov_b32 s29, s7
  s_mov_b32 s30, 0x180000
  s_mov_b32 s31, 0x20000
  s_mov_b32 s32, s12
  s_mov_b32 s33, s13
  s_mov_b32 s34, 0x1c0000
  s_mov_b32 s35, 0x20000
  s_mov_b32 s36, s14
  s_mov_b32 s37, s15
  s_mov_b32 s38, 0x1c0000
  s_mov_b32 s39, 0x20000
  s_mov_b32 s12, s3
  s_lshl_b32 s60, s50, 2
  s_lshr_b32 s13, s3, s60
  s_cmp_eq_u32 s79, 0
  s_cbranch_scc0 L_k1_O
L_k1_E:
  s_nop 0
  s_add_u32 m0, s54, 16384
  s_bfe_u32 s60, s12, 0x40000
  s_mul_i32 s60, s60, 229376
  s_add_u32 s60, s60, s56
  buffer_load_dwordx4 v8, s[32:35], s60 offen lds
  s_add_u32 m0, s54, 24576
  s_bfe_u32 s60, s12, 0x40000
  s_mul_i32 s60, s60, 229376
  s_add_u32 s60, s60, s56
  buffer_load_dwordx4 v8, s[36:39], s60 offen lds
  s_mov_b32 s40, s22
  s_mov_b32 s41, s23
  s_mov_b32 s42, 0x980000
  s_mov_b32 s43, 0x20000
  s_lshl_b32 s86, s51, 8
  s_add_u32 s86, s86, 0x970000
  s_lshl_b32 s87, s51, 8
  s_add_u32 s87, s87, 0x971000
  s_lshl_b32 s88, s52, 8
  s_add_u32 s88, s88, 0x972000
  s_lshl_b32 s84, s52, 13
  s_add_u32 s84, s84, 0x900000
  v_mov_b32 v28, 0
  v_mov_b32 v29, 0
  v_mov_b32 v30, 0
  v_mov_b32 v31, 0
  v_mov_b32 v17, 0x7ffffff0
  v_cmp_eq_u32 vcc, 0, v0
  s_nop 1
  v_cndmask_b32 v16, v17, v28
  v_mov_b32 v45, 0
  v_mov_b32 v47, 0
  s_mov_b32 s93, 0x7ffffff0
  s_cmp_eq_u32 s83, 0
  s_cselect_b32 s60, s86, s93
  s_cselect_b32 s61, s87, s93
  buffer_store_dword v28, v16, s[40:43], s61 offen sc1
  s_lshl_b32 s61, s51, 8
  s_add_u32 s61, s61, 0x972800
  s_cmp_eq_u32 s83, 0
  s_cselect_b32 s61, s61, s93
  buffer_store_dword v28, v16, s[40:43], s61 offen sc1
  buffer_store_dword v28, v16, s[40:43], s60 offen sc1
  s_cmp_eq_u32 s51, 0
  s_cselect_b32 s60, s87, s93
  s_cselect_b32 s61, s88, s93
  s_cselect_b32 s62, s84, s93
  s_mov_b32 s44, s20
  s_mov_b32 s45, s21
  s_mov_b32 s46, 0x100
  s_mov_b32 s47, 0x20000
  s_lshl_b32 s60, s51, 2
  s_add_u32 s60, s60, s49
  s_mul_i32 s59, s60, 147456
  s_mov_b32 s64, 0xffff
  s_mov_b32 s65, 0xffff
  s_lshl_b32 s60, s50, 12
  s_add_u32 s85, s84, s60
  s_lshl_b32 s91, s51, 2
  s_lshl_b32 s92, s83, 2
  s_add_u32 s92, s92, 128
  s_lshl_b32 s60, s50, 7
  s_add_u32 s95, s60, 0x20000
  s_lshl_b32 s60, s56, 5
  s_add_u32 s66, s59, s60
  s_lshl_b32 s61, s50, 11
  s_add_u32 s66, s66, s61
  s_lshl_b32 s60, s57, 5
  s_add_u32 s67, s59, s60
  s_add_u32 s67, s67, s61
  s_lshl_b32 s60, s52, 12
  s_add_u32 s76, s59, s60
  s_add_u32 s76, s76, s61
  s_add_u32 s76, s76, 114688
  v_mov_b32 v28, 0x21200
  v_mov_b32 v30, 0
  v_mov_b32 v31, 0
  ds_write_b64 v28, v[30:31]
  ds_write_b32 v28, v30 offset:8
  v_lshrrev_b32 v28, 9, v1
  v_lshlrev_b32 v28, 3, v28
  v_bfe_u32 v29, v1, 6, 2
  v_add_u32 v28, v28, v29
  v_bfe_u32 v29, v1, 8, 1
  v_bfe_u32 v30, v1, 5, 1
  v_lshl_add_u32 v30, v29, 1, v30
  s_lshl_b32 s60, s50, 2
  v_add_u32 v30, s60, v30
  v_bfe_u32 v31, v1, 7, 1
  v_lshlrev_b32 v31, 2, v31
  v_xor_b32 v30, v30, v31
  v_lshlrev_b32 v30, 4, v30
  v_lshl_add_u32 v6, v28, 7, v30
  v_bfe_u32 v31, v1, 4, 1
  v_lshl_add_u32 v6, v31, 3, v6
  v_add_u32 v7, 0x10000, v6
  v_bfe_u32 v28, v1, 4, 5
  s_lshl_b32 s60, s49, 5
  v_add_u32 v29, s60, v28
  v_lshlrev_b32 v29, 7, v29
  v_bfe_u32 v30, v1, 5, 3
  v_lshrrev_b32 v31, 9, v1
  v_xor_b32 v30, v30, v31
  v_xor_b32 v31, 0, v30
  v_lshl_add_u32 v20, v31, 4, v29
  v_add_u32 v24, 0x10000, v20
  v_xor_b32 v31, 2, v30
  v_lshl_add_u32 v21, v31, 4, v29
  v_add_u32 v25, 0x10000, v21
  v_xor_b32 v31, 4, v30
  v_lshl_add_u32 v22, v31, 4, v29
  v_add_u32 v26, 0x10000, v22
  v_xor_b32 v31, 6, v30
  v_lshl_add_u32 v23, v31, 4, v29
  v_add_u32 v27, 0x10000, v23
  s_add_u32 m0, s55, 32768
  s_bfe_u32 s60, s12, 0x40004
  s_mul_i32 s60, s60, 128
  s_add_u32 s60, s60, s53
  buffer_load_dwordx4 v10, s[24:27], s60 offen lds
  s_add_u32 m0, s55, 33792
  s_bfe_u32 s60, s12, 0x40004
  s_mul_i32 s60, s60, 128
  s_add_u32 s60, s60, s53
  buffer_load_dwordx4 v11, s[24:27], s60 offen lds
  s_add_u32 m0, s54, 49152
  s_bfe_u32 s60, s12, 0x40004
  s_mul_i32 s60, s60, 229376
  s_add_u32 s60, s60, s56
  buffer_load_dwordx4 v8, s[32:35], s60 offen lds
  s_add_u32 m0, s54, 57344
  s_bfe_u32 s60, s12, 0x40004
  s_mul_i32 s60, s60, 229376
  s_add_u32 s60, s60, s56
  buffer_load_dwordx4 v8, s[36:39], s60 offen lds
  s_lshl_b32 s60, s50, 1
  s_add_u32 s60, s60, s49
  s_and_b32 s6, s60, 3
  s_lshl_b32 s60, s50, 10
  s_add_u32 s4, s60, 0x22000
  s_lshl_b32 s60, s49, 2
  s_add_u32 s5, s4, s60
  v_bfe_u32 v28, v1, 4, 4
  v_bfe_u32 v29, v1, 8, 1
  v_cmp_eq_u32 vcc, v28, v29
  v_mov_b32 v30, 0x3f803f80
  v_mov_b32 v31, 0
  v_cndmask_b32 v32, v31, v30
  v_cndmask_b32 v33, v31, v30
  v_cndmask_b32 v34, v31, v30
  v_cndmask_b32 v35, v31, v30
  v_mov_b32 v12, 0
  v_mov_b32 v13, 0
  v_mov_b32 v14, 0
  v_mov_b32 v15, 0
  s_waitcnt vmcnt(7)
  s_waitcnt vmcnt(4)
  s_waitcnt lgkmcnt(0)
  s_barrier
  v_add_u32 v28, s54, v1
  v_mov_b32 v29, 0x7ffffff0
  v_cmp_ne_u32 vcc, 0, v28
  s_nop 1
  v_cndmask_b32 v28, v28, v29
  v_mov_b32 v29, 1
  s_mov_b32 s61, 0x7ffffff0
  s_cmp_eq_u32 s83, 0
  s_cselect_b32 s60, s91, s61
  buffer_store_dword v29, v28, s[44:47], s60 offen sc1
  s_memtime s[22:23]
  ds_read_b128 v[128:131], v20 offset:0
  ds_read_b64_tr_b16 v[48:49], v6 offset:16384
  ds_read_b64_tr_b16 v[50:51], v6 offset:16896
  ds_read_b64_tr_b16 v[52:53], v6 offset:24576
  ds_read_b64_tr_b16 v[54:55], v6 offset:25088
  s_waitcnt lgkmcnt(2)
  v_mfma_f32_32x32x16_bf16 v[64:79], v[48:51], v[128:131], 0
  ds_read_b128 v[132:135], v21 offset:0
  ds_read_b64_tr_b16 v[56:57], v6 offset:18432
  ds_read_b64_tr_b16 v[58:59], v6 offset:18944
  s_waitcnt lgkmcnt(3)
  v_mfma_f32_32x32x16_bf16 v[80:95], v[52:55], v[128:131], 0
  s_cmp_eq_u32 s6, 0
  s_cbranch_scc1 L_k1E_c1
L_k1E_c1_r:
  ds_read_b64_tr_b16 v[60:61], v6 offset:26624
  ds_read_b64_tr_b16 v[62:63], v6 offset:27136
  s_add_u32 m0, s55, 65536
  s_bfe_u32 s60, s12, 0x40008
  s_mul_i32 s60, s60, 128
  s_add_u32 s60, s60, s53
  buffer_load_dwordx4 v10, s[24:27], s60 offen lds
  s_waitcnt lgkmcnt(2)
  v_mfma_f32_32x32x16_bf16 v[64:79], v[56:59], v[132:135], v[64:79]
  ds_read_b128 v[136:139], v22 offset:0
  ds_read_b64_tr_b16 v[48:49], v6 offset:20480
  ds_read_b64_tr_b16 v[50:51], v6 offset:20992
  s_waitcnt lgkmcnt(3)
  v_mfma_f32_32x32x16_bf16 v[80:95], v[60:63], v[132:135], v[80:95]
  s_cmp_eq_u32 s6, 1
  s_cbranch_scc1 L_k1E_c2
L_k1E_c2_r:
  ds_read_b64_tr_b16 v[52:53], v6 offset:28672
  ds_read_b64_tr_b16 v[54:55], v6 offset:29184
  s_add_u32 m0, s55, 66560
  s_bfe_u32 s60, s12, 0x40008
  s_mul_i32 s60, s60, 128
  s_add_u32 s60, s60, s53
  buffer_load_dwordx4 v11, s[24:27], s60 offen lds
  s_cmp_eq_u32 s50, 0
  s_cbranch_scc1 L_k1E_c3
L_k1E_c3_r:
  s_waitcnt lgkmcnt(2)
  v_mfma_f32_32x32x16_bf16 v[64:79], v[48:51], v[136:139], v[64:79]
  ds_read_b128 v[140:143], v23 offset:0
  ds_read_b64_tr_b16 v[56:57], v6 offset:22528
  ds_read_b64_tr_b16 v[58:59], v6 offset:23040
  s_waitcnt lgkmcnt(3)
  v_mfma_f32_32x32x16_bf16 v[80:95], v[52:55], v[136:139], v[80:95]
  s_cmp_eq_u32 s6, 2
  s_cbranch_scc1 L_k1E_c4
L_k1E_c4_r:
  ds_read_b64_tr_b16 v[60:61], v6 offset:30720
  ds_read_b64_tr_b16 v[62:63], v6 offset:31232
  s_add_u32 m0, s54, 81920
  s_bfe_u32 s60, s12, 0x40008
  s_mul_i32 s60, s60, 229376
  s_add_u32 s60, s60, s56
  buffer_load_dwordx4 v8, s[32:35], s60 offen lds
  s_waitcnt vmcnt(4)
  s_barrier
  s_waitcnt lgkmcnt(2)
  v_mfma_f32_32x32x16_bf16 v[64:79], v[56:59], v[140:143], v[64:79]
  ds_read_b128 v[144:147], v20 offset:32768
  ds_read_b64_tr_b16 v[48:49], v6 offset:49152
  ds_read_b64_tr_b16 v[50:51], v6 offset:49664
  s_waitcnt lgkmcnt(3)
  v_mfma_f32_32x32x16_bf16 v[80:95], v[60:63], v[140:143], v[80:95]
  s_cmp_eq_u32 s6, 3
  s_cbranch_scc1 L_k1E_c5
L_k1E_c5_r:
  ds_read_b64_tr_b16 v[52:53], v6 offset:57344
  ds_read_b64_tr_b16 v[54:55], v6 offset:57856
  s_add_u32 m0, s54, 90112
  s_bfe_u32 s60, s12, 0x40008
  s_mul_i32 s60, s60, 229376
  s_add_u32 s60, s60, s56
  buffer_load_dwordx4 v8, s[36:39], s60 offen lds
  s_cmp_eq_u32 s50, 1
  s_cbranch_scc1 L_k1E_c6
L_k1E_c6_r:
  s_waitcnt lgkmcnt(2)
  v_mfma_f32_32x32x16_bf16 v[64:79], v[48:51], v[144:147], v[64:79]
  ds_read_b128 v[148:151], v21 offset:32768
  ds_read_b64_tr_b16 v[56:57], v6 offset:51200
  ds_read_b64_tr_b16 v[58:59], v6 offset:51712
  s_waitcnt lgkmcnt(3)
  v_mfma_f32_32x32x16_bf16 v[80:95], v[52:55], v[144:147], v[80:95]
  s_cmp_eq_u32 s6, 0
  s_cbranch_scc1 L_k1E_c7
L_k1E_c7_r:
  ds_read_b64_tr_b16 v[60:61], v6 offset:59392
  ds_read_b64_tr_b16 v[62:63], v6 offset:59904
  s_add_u32 m0, s55, 98304
  s_bfe_u32 s60, s12, 0x4000c
  s_mul_i32 s60, s60, 128
  s_add_u32 s60, s60, s53
  buffer_load_dwordx4 v10, s[24:27], s60 offen lds
  s_waitcnt lgkmcnt(2)
  v_mfma_f32_32x32x16_bf16 v[64:79], v[56:59], v[148:151], v[64:79]
  ds_read_b128 v[152:155], v22 offset:32768
  ds_read_b64_tr_b16 v[48:49], v6 offset:53248
  ds_read_b64_tr_b16 v[50:51], v6 offset:53760
  s_waitcnt lgkmcnt(3)
  v_mfma_f32_32x32x16_bf16 v[80:95], v[60:63], v[148:151], v[80:95]
  s_cmp_eq_u32 s6, 1
  s_cbranch_scc1 L_k1E_c8
L_k1E_c8_r:
  ds_read_b64_tr_b16 v[52:53], v6 offset:61440
  ds_read_b64_tr_b16 v[54:55], v6 offset:61952
  s_add_u32 m0, s55, 99328
  s_bfe_u32 s60, s12, 0x4000c
  s_mul_i32 s60, s60, 128
  s_add_u32 s60, s60, s53
  buffer_load_dwordx4 v11, s[24:27], s60 offen lds
  s_cmp_eq_u32 s50, 0
  s_cbranch_scc1 L_k1E_c9
L_k1E_c9_r:
  s_waitcnt lgkmcnt(2)
  v_mfma_f32_32x32x16_bf16 v[64:79], v[48:51], v[152:155], v[64:79]
  ds_read_b128 v[156:159], v23 offset:32768
  ds_read_b64_tr_b16 v[56:57], v6 offset:55296
  ds_read_b64_tr_b16 v[58:59], v6 offset:55808
  s_waitcnt lgkmcnt(3)
  v_mfma_f32_32x32x16_bf16 v[80:95], v[52:55], v[152:155], v[80:95]
  s_cmp_eq_u32 s6, 2
  s_cbranch_scc1 L_k1E_c10
L_k1E_c10_r:
  ds_read_b64_tr_b16 v[60:61], v6 offset:63488
  ds_read_b64_tr_b16 v[62:63], v6 offset:64000
  s_add_u32 m0, s54, 114688
  s_bfe_u32 s60, s12, 0x4000c
  s_mul_i32 s60, s60, 229376
  s_add_u32 s60, s60, s56
  buffer_load_dwordx4 v8, s[32:35], s60 offen lds
  s_waitcnt vmcnt(3)
  s_barrier
  s_waitcnt lgkmcnt(2)
  v_mfma_f32_32x32x16_bf16 v[64:79], v[56:59], v[156:159], v[64:79]
  ds_read_b128 v[160:163], v24 offset:0
  ds_read_b64_tr_b16 v[48:49], v7 offset:16384
  ds_read_b64_tr_b16 v[50:51], v7 offset:16896
  s_waitcnt lgkmcnt(3)
  v_mfma_f32_32x32x16_bf16 v[80:95], v[60:63], v[156:159], v[80:95]
  s_cmp_eq_u32 s6, 3
  s_cbranch_scc1 L_k1E_c11
L_k1E_c11_r:
  ds_read_b64_tr_b16 v[52:53], v7 offset:24576
  ds_read_b64_tr_b16 v[54:55], v7 offset:25088
  s_add_u32 m0, s54, 122880
  s_bfe_u32 s60, s12, 0x4000c
  s_mul_i32 s60, s60, 229376
  s_add_u32 s60, s60, s56
  buffer_load_dwordx4 v8, s[36:39], s60 offen lds
  s_cmp_eq_u32 s50, 1
  s_cbranch_scc1 L_k1E_c12
L_k1E_c12_r:
  s_waitcnt lgkmcnt(2)
  v_mfma_f32_32x32x16_bf16 v[64:79], v[48:51], v[160:163], v[64:79]
  ds_read_b128 v[164:167], v25 offset:0
  ds_read_b64_tr_b16 v[56:57], v7 offset:18432
  ds_read_b64_tr_b16 v[58:59], v7 offset:18944
  s_waitcnt lgkmcnt(3)
  v_mfma_f32_32x32x16_bf16 v[80:95], v[52:55], v[160:163], v[80:95]
  s_cmp_eq_u32 s6, 0
  s_cbranch_scc1 L_k1E_c13
L_k1E_c13_r:
  ds_read_b64_tr_b16 v[60:61], v7 offset:26624
  ds_read_b64_tr_b16 v[62:63], v7 offset:27136
  s_add_u32 m0, s55, 0
  s_bfe_u32 s60, s12, 0x40010
  s_mul_i32 s60, s60, 128
  s_add_u32 s60, s60, s53
  buffer_load_dwordx4 v10, s[24:27], s60 offen lds
  s_waitcnt lgkmcnt(2)
  v_mfma_f32_32x32x16_bf16 v[64:79], v[56:59], v[164:167], v[64:79]
  ds_read_b128 v[168:171], v26 offset:0
  ds_read_b64_tr_b16 v[48:49], v7 offset:20480
  ds_read_b64_tr_b16 v[50:51], v7 offset:20992
  s_waitcnt lgkmcnt(3)
  v_mfma_f32_32x32x16_bf16 v[80:95], v[60:63], v[164:167], v[80:95]
  s_cmp_eq_u32 s6, 1
  s_cbranch_scc1 L_k1E_c14
L_k1E_c14_r:
  ds_read_b64_tr_b16 v[52:53], v7 offset:28672
  ds_read_b64_tr_b16 v[54:55], v7 offset:29184
  s_add_u32 m0, s55, 1024
  s_bfe_u32 s60, s12, 0x40010
  s_mul_i32 s60, s60, 128
  s_add_u32 s60, s60, s53
  buffer_load_dwordx4 v11, s[24:27], s60 offen lds
  s_cmp_eq_u32 s50, 0
  s_cbranch_scc1 L_k1E_c15
L_k1E_c15_r:
  s_waitcnt lgkmcnt(2)
  v_mfma_f32_32x32x16_bf16 v[64:79], v[48:51], v[168:171], v[64:79]
  ds_read_b128 v[172:175], v27 offset:0
  ds_read_b64_tr_b16 v[56:57], v7 offset:22528
  ds_read_b64_tr_b16 v[58:59], v7 offset:23040
  s_waitcnt lgkmcnt(3)
  v_mfma_f32_32x32x16_bf16 v[80:95], v[52:55], v[168:171], v[80:95]
  s_cmp_eq_u32 s6, 2
  s_cbranch_scc1 L_k1E_c16
L_k1E_c16_r:
  ds_read_b64_tr_b16 v[60:61], v7 offset:30720
  ds_read_b64_tr_b16 v[62:63], v7 offset:31232
  s_add_u32 m0, s54, 16384
  s_bfe_u32 s60, s12, 0x40010
  s_mul_i32 s60, s60, 229376
  s_add_u32 s60, s60, s56
  buffer_load_dwordx4 v8, s[32:35], s60 offen lds
  s_waitcnt vmcnt(3)
  s_barrier
  s_waitcnt lgkmcnt(2)
  v_mfma_f32_32x32x16_bf16 v[64:79], v[56:59], v[172:175], v[64:79]
  ds_read_b128 v[176:179], v24 offset:32768
  ds_read_b64_tr_b16 v[48:49], v7 offset:49152
  ds_read_b64_tr_b16 v[50:51], v7 offset:49664
  s_waitcnt lgkmcnt(3)
  v_mfma_f32_32x32x16_bf16 v[80:95], v[60:63], v[172:175], v[80:95]
  s_cmp_eq_u32 s6, 3
  s_cbranch_scc1 L_k1E_c17
L_k1E_c17_r:
  ds_read_b64_tr_b16 v[52:53], v7 offset:57344
  ds_read_b64_tr_b16 v[54:55], v7 offset:57856
  s_add_u32 m0, s54, 24576
  s_bfe_u32 s60, s12, 0x40010
  s_mul_i32 s60, s60, 229376
  s_add_u32 s60, s60, s56
  buffer_load_dwordx4 v8, s[36:39], s60 offen lds
  s_cmp_eq_u32 s50, 1
  s_cbranch_scc1 L_k1E_c18
L_k1E_c18_r:
  s_cmp_eq_u32 s48, 0
  s_mov_b32 s61, 0x7ffffff0
  s_cselect_b32 s11, s91, s61
  buffer_load_dword v31, off, s[44:47], s11 sc1
  s_waitcnt lgkmcnt(2)
  v_mfma_f32_32x32x16_bf16 v[64:79], v[48:51], v[176:179], v[64:79]
  ds_read_b128 v[180:183], v25 offset:32768
  ds_read_b64_tr_b16 v[56:57], v7 offset:51200
  ds_read_b64_tr_b16 v[58:59], v7 offset:51712
  s_waitcnt lgkmcnt(3)
  v_mfma_f32_32x32x16_bf16 v[80:95], v[52:55], v[176:179], v[80:95]
  s_cmp_eq_u32 s6, 0
  s_cbranch_scc1 L_k1E_c19
L_k1E_c19_r:
  ds_read_b64_tr_b16 v[60:61], v7 offset:59392
  ds_read_b64_tr_b16 v[62:63], v7 offset:59904
  s_add_u32 m0, s55, 32768
  s_bfe_u32 s60, s12, 0x40014
  s_mul_i32 s60, s60, 128
  s_add_u32 s60, s60, s53
  buffer_load_dwordx4 v10, s[24:27], s60 offen lds
  s_waitcnt lgkmcnt(2)
  v_mfma_f32_32x32x16_bf16 v[64:79], v[56:59], v[180:183], v[64:79]
  ds_read_b128 v[184:187], v26 offset:32768
  ds_read_b64_tr_b16 v[48:49], v7 offset:53248
  ds_read_b64_tr_b16 v[50:51], v7 offset:53760
  s_waitcnt lgkmcnt(3)
  v_mfma_f32_32x32x16_bf16 v[80:95], v[60:63], v[180:183], v[80:95]
  s_cmp_eq_u32 s6, 1
  s_cbranch_scc1 L_k1E_c20
L_k1E_c20_r:
  ds_read_b64_tr_b16 v[52:53], v7 offset:61440
  ds_read_b64_tr_b16 v[54:55], v7 offset:61952
  s_add_u32 m0, s55, 33792
  s_bfe_u32 s60, s12, 0x40014
  s_mul_i32 s60, s60, 128
  s_add_u32 s60, s60, s53
  buffer_load_dwordx4 v11, s[24:27], s60 offen lds
  s_cmp_eq_u32 s50, 0
  s_cbranch_scc1 L_k1E_c21
L_k1E_c21_r:
  s_waitcnt lgkmcnt(2)
  v_mfma_f32_32x32x16_bf16 v[64:79], v[48:51], v[184:187], v[64:79]
  ds_read_b128 v[188:191], v27 offset:32768
  ds_read_b64_tr_b16 v[56:57], v7 offset:55296
  ds_read_b64_tr_b16 v[58:59], v7 offset:55808
  s_waitcnt lgkmcnt(3)
  v_mfma_f32_32x32x16_bf16 v[80:95], v[52:55], v[184:187], v[80:95]
  s_cmp_eq_u32 s6, 2
  s_cbranch_scc1 L_k1E_c22
L_k1E_c22_r:
  ds_read_b64_tr_b16 v[60:61], v7 offset:63488
  ds_read_b64_tr_b16 v[62:63], v7 offset:64000
  s_add_u32 m0, s54, 49152
  s_bfe_u32 s60, s12, 0x40014
  s_mul_i32 s60, s60, 229376
  s_add_u32 s60, s60, s56
  buffer_load_dwordx4 v8, s[32:35], s60 offen lds
  s_waitcnt vmcnt(4)
  s_barrier
  s_waitcnt lgkmcnt(2)
  v_mfma_f32_32x32x16_bf16 v[64:79], v[56:59], v[188:191], v[64:79]
  ds_read_b128 v[192:195], v20 offset:0
  ds_read_b64_tr_b16 v[48:49], v6 offset:16384
  ds_read_b64_tr_b16 v[50:51], v6 offset:16896
  s_waitcnt lgkmcnt(3)
  v_mfma_f32_32x32x16_bf16 v[80:95], v[60:63], v[188:191], v[80:95]
  s_cmp_eq_u32 s6, 3
  s_cbranch_scc1 L_k1E_c23
L_k1E_c23_r:
  ds_read_b64_tr_b16 v[52:53], v6 offset:24576
  ds_read_b64_tr_b16 v[54:55], v6 offset:25088
  s_add_u32 m0, s54, 57344
  s_bfe_u32 s60, s12, 0x40014
  s_mul_i32 s60, s60, 229376
  s_add_u32 s60, s60, s56
  buffer_load_dwordx4 v8, s[36:39], s60 offen lds
  s_cmp_eq_u32 s50, 1
  s_cbranch_scc1 L_k1E_c24
L_k1E_c24_r:
  s_waitcnt lgkmcnt(2)
  v_mfma_f32_32x32x16_bf16 v[64:79], v[48:51], v[192:195], v[64:79]
  ds_read_b128 v[196:199], v21 offset:0
  ds_read_b64_tr_b16 v[56:57], v6 offset:18432
  ds_read_b64_tr_b16 v[58:59], v6 offset:18944
  s_waitcnt lgkmcnt(3)
  v_mfma_f32_32x32x16_bf16 v[80:95], v[52:55], v[192:195], v[80:95]
  s_cmp_eq_u32 s6, 0
  s_cbranch_scc1 L_k1E_c25
L_k1E_c25_r:
  ds_read_b64_tr_b16 v[60:61], v6 offset:26624
  ds_read_b64_tr_b16 v[62:63], v6 offset:27136
  s_add_u32 m0, s55, 65536
  s_bfe_u32 s60, s12, 0x40018
  s_mul_i32 s60, s60, 128
  s_add_u32 s60, s60, s53
  buffer_load_dwordx4 v10, s[24:27], s60 offen lds
  s_waitcnt lgkmcnt(2)
  v_mfma_f32_32x32x16_bf16 v[64:79], v[56:59], v[196:199], v[64:79]
  ds_read_b128 v[200:203], v22 offset:0
  ds_read_b64_tr_b16 v[48:49], v6 offset:20480
  ds_read_b64_tr_b16 v[50:51], v6 offset:20992
  s_waitcnt lgkmcnt(3)
  v_mfma_f32_32x32x16_bf16 v[80:95], v[60:63], v[196:199], v[80:95]
  s_cmp_eq_u32 s6, 1
  s_cbranch_scc1 L_k1E_c26
L_k1E_c26_r:
  ds_read_b64_tr_b16 v[52:53], v6 offset:28672
  ds_read_b64_tr_b16 v[54:55], v6 offset:29184
  s_add_u32 m0, s55, 66560
  s_bfe_u32 s60, s12, 0x40018
  s_mul_i32 s60, s60, 128
  s_add_u32 s60, s60, s53
  buffer_load_dwordx4 v11, s[24:27], s60 offen lds
  s_cmp_eq_u32 s50, 0
  s_cbranch_scc1 L_k1E_c27
L_k1E_c27_r:
  s_waitcnt lgkmcnt(2)
  v_mfma_f32_32x32x16_bf16 v[64:79], v[48:51], v[200:203], v[64:79]
  ds_read_b128 v[204:207], v23 offset:0
  ds_read_b64_tr_b16 v[56:57], v6 offset:22528
  ds_read_b64_tr_b16 v[58:59], v6 offset:23040
  s_waitcnt lgkmcnt(3)
  v_mfma_f32_32x32x16_bf16 v[80:95], v[52:55], v[200:203], v[80:95]
  s_cmp_eq_u32 s6, 2
  s_cbranch_scc1 L_k1E_c28
L_k1E_c28_r:
  ds_read_b64_tr_b16 v[60:61], v6 offset:30720
  ds_read_b64_tr_b16 v[62:63], v6 offset:31232
  s_add_u32 m0, s54, 81920
  s_bfe_u32 s60, s12, 0x40018
  s_mul_i32 s60, s60, 229376
  s_add_u32 s60, s60, s56
  buffer_load_dwordx4 v8, s[32:35], s60 offen lds
  s_waitcnt vmcnt(3)
  s_barrier
  s_waitcnt lgkmcnt(2)
  v_mfma_f32_32x32x16_bf16 v[64:79], v[56:59], v[204:207], v[64:79]
  ds_read_b128 v[208:211], v20 offset:32768
  ds_read_b64_tr_b16 v[48:49], v6 offset:49152
  ds_read_b64_tr_b16 v[50:51], v6 offset:49664
  s_waitcnt lgkmcnt(3)
  v_mfma_f32_32x32x16_bf16 v[80:95], v[60:63], v[204:207], v[80:95]
  s_cmp_eq_u32 s6, 3
  s_cbranch_scc1 L_k1E_c29
L_k1E_c29_r:
  ds_read_b64_tr_b16 v[52:53], v6 offset:57344
  ds_read_b64_tr_b16 v[54:55], v6 offset:57856
  s_add_u32 m0, s54, 90112
  s_bfe_u32 s60, s12, 0x40018
  s_mul_i32 s60, s60, 229376
  s_add_u32 s60, s60, s56
  buffer_load_dwordx4 v8, s[36:39], s60 offen lds
  s_cmp_eq_u32 s50, 1
  s_cbranch_scc1 L_k1E_c30
L_k1E_c30_r:
  s_waitcnt lgkmcnt(2)
  v_mfma_f32_32x32x16_bf16 v[64:79], v[48:51], v[208:211], v[64:79]
  ds_read_b128 v[212:215], v21 offset:32768
  ds_read_b64_tr_b16 v[56:57], v6 offset:51200
  ds_read_b64_tr_b16 v[58:59], v6 offset:51712
  s_waitcnt lgkmcnt(3)
  v_mfma_f32_32x32x16_bf16 v[80:95], v[52:55], v[208:211], v[80:95]
  s_cmp_eq_u32 s6, 0
  s_cbranch_scc1 L_k1E_c31
L_k1E_c31_r:
  ds_read_b64_tr_b16 v[60:61], v6 offset:59392
  ds_read_b64_tr_b16 v[62:63], v6 offset:59904
  s_add_u32 m0, s55, 98304
  s_bfe_u32 s60, s12, 0x4001c
  s_mul_i32 s60, s60, 128
  s_add_u32 s60, s60, s53
  buffer_load_dwordx4 v10, s[24:27], s60 offen lds
  s_waitcnt lgkmcnt(2)
  v_mfma_f32_32x32x16_bf16 v[64:79], v[56:59], v[212:215], v[64:79]
  ds_read_b128 v[216:219], v22 offset:32768
  ds_read_b64_tr_b16 v[48:49], v6 offset:53248
  ds_read_b64_tr_b16 v[50:51], v6 offset:53760
  s_waitcnt lgkmcnt(3)
  v_mfma_f32_32x32x16_bf16 v[80:95], v[60:63], v[212:215], v[80:95]
  s_cmp_eq_u32 s6, 1
  s_cbranch_scc1 L_k1E_c32
L_k1E_c32_r:
  ds_read_b64_tr_b16 v[52:53], v6 offset:61440
  ds_read_b64_tr_b16 v[54:55], v6 offset:61952
  s_add_u32 m0, s55, 99328
  s_bfe_u32 s60, s12, 0x4001c
  s_mul_i32 s60, s60, 128
  s_add_u32 s60, s60, s53
  buffer_load_dwordx4 v11, s[24:27], s60 offen lds
  s_cmp_eq_u32 s50, 0
  s_cbranch_scc1 L_k1E_c33
L_k1E_c33_r:
  s_waitcnt lgkmcnt(2)
  v_mfma_f32_32x32x16_bf16 v[64:79], v[48:51], v[216:219], v[64:79]
  ds_read_b128 v[220:223], v23 offset:32768
  ds_read_b64_tr_b16 v[56:57], v6 offset:55296
  ds_read_b64_tr_b16 v[58:59], v6 offset:55808
  s_waitcnt lgkmcnt(3)
  v_mfma_f32_32x32x16_bf16 v[80:95], v[52:55], v[216:219], v[80:95]
  s_cmp_eq_u32 s6, 2
  s_cbranch_scc1 L_k1E_c34
L_k1E_c34_r:
  ds_read_b64_tr_b16 v[60:61], v6 offset:63488
  ds_read_b64_tr_b16 v[62:63], v6 offset:64000
  s_add_u32 m0, s54, 114688
  s_bfe_u32 s60, s12, 0x4001c
  s_mul_i32 s60, s60, 229376
  s_add_u32 s60, s60, s56
  buffer_load_dwordx4 v8, s[32:35], s60 offen lds
  s_waitcnt vmcnt(3)
  s_barrier
  s_waitcnt lgkmcnt(2)
  v_mfma_f32_32x32x16_bf16 v[64:79], v[56:59], v[220:223], v[64:79]
  ds_read_b128 v[224:227], v24 offset:0
  ds_read_b64_tr_b16 v[48:49], v7 offset:16384
  ds_read_b64_tr_b16 v[50:51], v7 offset:16896
  s_waitcnt lgkmcnt(3)
  v_mfma_f32_32x32x16_bf16 v[80:95], v[60:63], v[220:223], v[80:95]
  s_cmp_eq_u32 s6, 3
  s_cbranch_scc1 L_k1E_c35
L_k1E_c35_r:
  ds_read_b64_tr_b16 v[52:53], v7 offset:24576
  ds_read_b64_tr_b16 v[54:55], v7 offset:25088
  s_add_u32 m0, s54, 122880
  s_bfe_u32 s60, s12, 0x4001c
  s_mul_i32 s60, s60, 229376
  s_add_u32 s60, s60, s56
  buffer_load_dwordx4 v8, s[36:39], s60 offen lds
  s_cmp_eq_u32 s50, 1
  s_cbranch_scc1 L_k1E_c36
L_k1E_c36_r:
  s_waitcnt lgkmcnt(2)
  v_mfma_f32_32x32x16_bf16 v[64:79], v[48:51], v[224:227], v[64:79]
  ds_read_b128 v[228:231], v25 offset:0
  ds_read_b64_tr_b16 v[56:57], v7 offset:18432
  ds_read_b64_tr_b16 v[58:59], v7 offset:18944
  s_waitcnt lgkmcnt(3)
  v_mfma_f32_32x32x16_bf16 v[80:95], v[52:55], v[224:227], v[80:95]
  s_cmp_eq_u32 s6, 0
  s_cbranch_scc1 L_k1E_c37
L_k1E_c37_r:
  ds_read_b64_tr_b16 v[60:61], v7 offset:26624
  ds_read_b64_tr_b16 v[62:63], v7 offset:27136
  s_add_u32 m0, s54, 0
  s_bfe_u32 s60, s12, 0x40000
  s_mul_i32 s60, s60, 229376
  s_add_u32 s60, s60, s57
  buffer_load_dwordx4 v8, s[32:35], s60 offen lds
  s_waitcnt lgkmcnt(2)
  v_mfma_f32_32x32x16_bf16 v[64:79], v[56:59], v[228:231], v[64:79]
  ds_read_b128 v[232:235], v26 offset:0
  ds_read_b64_tr_b16 v[48:49], v7 offset:20480
  ds_read_b64_tr_b16 v[50:51], v7 offset:20992
  s_waitcnt lgkmcnt(3)
  v_mfma_f32_32x32x16_bf16 v[80:95], v[60:63], v[228:231], v[80:95]
  s_cmp_eq_u32 s6, 1
  s_cbranch_scc1 L_k1E_c38
L_k1E_c38_r:
  ds_read_b64_tr_b16 v[52:53], v7 offset:28672
  ds_read_b64_tr_b16 v[54:55], v7 offset:29184
  s_add_u32 m0, s54, 8192
  s_bfe_u32 s60, s12, 0x40000
  s_mul_i32 s60, s60, 229376
  s_add_u32 s60, s60, s57
  buffer_load_dwordx4 v8, s[36:39], s60 offen lds
  s_cmp_eq_u32 s50, 0
  s_cbranch_scc1 L_k1E_c39
L_k1E_c39_r:
  v_readfirstlane_b32 s62, v31
  s_cmp_eq_u32 s48, 0
  s_cbranch_scc0 L_rE_ok
  s_mov_b32 s82, 0
L_rE_chk:
  s_cmp_ge_u32 s62, 1
  s_cbranch_scc0 L_rE_spin
  s_branch L_rE_ok
L_rE_spin:
  s_sleep 8
  buffer_load_dword v31, off, s[44:47], s91 sc1
  s_waitcnt vmcnt(0)
  v_readfirstlane_b32 s62, v31
  s_add_u32 s82, s82, 1
  s_cmp_lt_u32 s82, 0x100000
  s_cbranch_scc1 L_rE_chk
L_rE_ok:
  s_nop 1
  s_waitcnt lgkmcnt(2)
  v_mfma_f32_32x32x16_bf16 v[64:79], v[48:51], v[232:235], v[64:79]
  ds_read_b128 v[236:239], v27 offset:0
  ds_read_b64_tr_b16 v[56:57], v7 offset:22528
  ds_read_b64_tr_b16 v[58:59], v7 offset:23040
  s_waitcnt lgkmcnt(3)
  v_mfma_f32_32x32x16_bf16 v[80:95], v[52:55], v[232:235], v[80:95]
  s_cmp_eq_u32 s6, 2
  s_cbranch_scc1 L_k1E_c40
L_k1E_c40_r:
  ds_read_b64_tr_b16 v[60:61], v7 offset:30720
  ds_read_b64_tr_b16 v[62:63], v7 offset:31232
  s_add_u32 m0, s54, 16384
  s_bfe_u32 s60, s12, 0x40004
  s_mul_i32 s60, s60, 229376
  s_add_u32 s60, s60, s57
  buffer_load_dwordx4 v8, s[32:35], s60 offen lds
  s_waitcnt vmcnt(3)
  s_barrier
  s_waitcnt lgkmcnt(2)
  v_mfma_f32_32x32x16_bf16 v[64:79], v[56:59], v[236:239], v[64:79]
  ds_read_b128 v[240:243], v24 offset:32768
  ds_read_b64_tr_b16 v[48:49], v7 offset:49152
  ds_read_b64_tr_b16 v[50:51], v7 offset:49664
  s_waitcnt lgkmcnt(3)
  v_mfma_f32_32x32x16_bf16 v[80:95], v[60:63], v[236:239], v[80:95]
  s_cmp_eq_u32 s6, 3
  s_cbranch_scc1 L_k1E_c41
L_k1E_c41_r:
  ds_read_b64_tr_b16 v[52:53], v7 offset:57344
  ds_read_b64_tr_b16 v[54:55], v7 offset:57856
  s_add_u32 m0, s54, 24576
  s_bfe_u32 s60, s12, 0x40004
  s_mul_i32 s60, s60, 229376
  s_add_u32 s60, s60, s57
  buffer_load_dwordx4 v8, s[36:39], s60 offen lds
  s_cmp_eq_u32 s50, 1
  s_cbranch_scc1 L_k1E_c42
L_k1E_c42_r:
  s_waitcnt lgkmcnt(2)
  v_mfma_f32_32x32x16_bf16 v[64:79], v[48:51], v[240:243], v[64:79]
  ds_read_b128 v[244:247], v25 offset:32768
  ds_read_b64_tr_b16 v[56:57], v7 offset:51200
  ds_read_b64_tr_b16 v[58:59], v7 offset:51712
  s_waitcnt lgkmcnt(3)
  v_mfma_f32_32x32x16_bf16 v[80:95], v[52:55], v[240:243], v[80:95]
  s_cmp_eq_u32 s6, 0
  s_cbranch_scc1 L_k1E_c43
L_k1E_c43_r:
  ds_read_b64_tr_b16 v[60:61], v7 offset:59392
  ds_read_b64_tr_b16 v[62:63], v7 offset:59904
  s_add_u32 m0, s54, 32768
  s_bfe_u32 s60, s12, 0x40008
  s_mul_i32 s60, s60, 229376
  s_add_u32 s60, s60, s57
  buffer_load_dwordx4 v8, s[32:35], s60 offen lds
  s_waitcnt lgkmcnt(2)
  v_mfma_f32_32x32x16_bf16 v[64:79], v[56:59], v[244:247], v[64:79]
  ds_read_b128 v[248:251], v26 offset:32768
  ds_read_b64_tr_b16 v[48:49], v7 offset:53248
  ds_read_b64_tr_b16 v[50:51], v7 offset:53760
  s_waitcnt lgkmcnt(3)
  v_mfma_f32_32x32x16_bf16 v[80:95], v[60:63], v[244:247], v[80:95]
  s_cmp_eq_u32 s6, 1
  s_cbranch_scc1 L_k1E_c44
L_k1E_c44_r:
  ds_read_b64_tr_b16 v[52:53], v7 offset:61440
  ds_read_b64_tr_b16 v[54:55], v7 offset:61952
  s_add_u32 m0, s54, 40960
  s_bfe_u32 s60, s12, 0x40008
  s_mul_i32 s60, s60, 229376
  s_add_u32 s60, s60, s57
  buffer_load_dwordx4 v8, s[36:39], s60 offen lds
  s_cmp_eq_u32 s50, 0
  s_cbranch_scc1 L_k1E_c45
L_k1E_c45_r:
  s_waitcnt lgkmcnt(2)
  v_mfma_f32_32x32x16_bf16 v[64:79], v[48:51], v[248:251], v[64:79]
  ds_read_b128 v[252:255], v27 offset:32768
  ds_read_b64_tr_b16 v[56:57], v7 offset:55296
  ds_read_b64_tr_b16 v[58:59], v7 offset:55808
  s_waitcnt lgkmcnt(3)
  v_mfma_f32_32x32x16_bf16 v[80:95], v[52:55], v[248:251], v[80:95]
  s_cmp_eq_u32 s6, 2
  s_cbranch_scc1 L_k1E_c46
L_k1E_c46_r:
  ds_read_b64_tr_b16 v[60:61], v7 offset:63488
  ds_read_b64_tr_b16 v[62:63], v7 offset:64000
  s_add_u32 m0, s54, 49152
  s_bfe_u32 s60, s12, 0x4000c
  s_mul_i32 s60, s60, 229376
  s_add_u32 s60, s60, s57
  buffer_load_dwordx4 v8, s[32:35], s60 offen lds
  s_waitcnt vmcnt(5)
  s_barrier
  s_waitcnt lgkmcnt(2)
  v_mfma_f32_32x32x16_bf16 v[64:79], v[56:59], v[252:255], v[64:79]
  ds_read_b64_tr_b16 v[48:49], v6 offset:0
  ds_read_b64_tr_b16 v[50:51], v6 offset:512
  s_waitcnt lgkmcnt(2)
  v_mfma_f32_32x32x16_bf16 v[80:95], v[60:63], v[252:255], v[80:95]
  s_cmp_eq_u32 s6, 3
  s_cbranch_scc1 L_k1E_c47
L_k1E_c47_r:
  ds_read_b64_tr_b16 v[52:53], v6 offset:8192
  ds_read_b64_tr_b16 v[54:55], v6 offset:8704
  s_add_u32 m0, s54, 57344
  s_bfe_u32 s60, s12, 0x4000c
  s_mul_i32 s60, s60, 229376
  s_add_u32 s60, s60, s57
  buffer_load_dwordx4 v8, s[36:39], s60 offen lds
  s_cmp_eq_u32 s50, 1
  s_cbranch_scc1 L_k1E_c48
L_k1E_c48_r:
  s_memtime s[14:15]
  v_mov_b32 v29, 0x23c00
  v_add_u32 v28, s5, v1
  v_cmp_gt_u32 vcc, 256, v1
  s_nop 1
  v_cndmask_b32 v28, v29, v28
  ds_write_b32 v28, v36 offset:0
  ds_write_b32 v28, v37 offset:256
  ds_write_b32 v28, v40 offset:512
  ds_write_b32 v28, v41 offset:768
  v_mov_b32 v16, 0
  v_mov_b32 v17, 0
  s_mov_b32 s62, 0x1
  s_mov_b32 s63, 0x10
  v_cndmask_b32 v16, v16, v96, s[62:63]
  s_mov_b32 s98, 0x2
  s_mov_b32 s99, 0x20
  v_cndmask_b32 v17, v17, v97, s[98:99]
  s_mov_b32 s62, 0x4
  s_mov_b32 s63, 0x40
  v_cndmask_b32 v16, v16, v98, s[62:63]
  s_mov_b32 s98, 0x8
  s_mov_b32 s99, 0x80
  v_cndmask_b32 v17, v17, v99, s[98:99]
  s_mov_b32 s62, 0x100
  s_mov_b32 s63, 0x1000
  v_cndmask_b32 v16, v16, v100, s[62:63]
  s_mov_b32 s98, 0x200
  s_mov_b32 s99, 0x2000
  v_cndmask_b32 v17, v17, v101, s[98:99]
  s_mov_b32 s62, 0x400
  s_mov_b32 s63, 0x4000
  v_cndmask_b32 v16, v16, v102, s[62:63]
  s_mov_b32 s98, 0x800
  s_mov_b32 s99, 0x8000
  v_cndmask_b32 v17, v17, v103, s[98:99]
  s_mov_b32 s62, 0x10000
  s_mov_b32 s63, 0x100000
  v_cndmask_b32 v16, v16, v104, s[62:63]
  s_mov_b32 s98, 0x20000
  s_mov_b32 s99, 0x200000
  v_cndmask_b32 v17, v17, v105, s[98:99]
  s_mov_b32 s62, 0x40000
  s_mov_b32 s63, 0x400000
  v_cndmask_b32 v16, v16, v106, s[62:63]
  s_mov_b32 s98, 0x80000
  s_mov_b32 s99, 0x800000
  v_cndmask_b32 v17, v17, v107, s[98:99]
  s_mov_b32 s62, 0x1000000
  s_mov_b32 s63, 0x10000000
  v_cndmask_b32 v16, v16, v108, s[62:63]
  s_mov_b32 s98, 0x2000000
  s_mov_b32 s99, 0x20000000
  v_cndmask_b32 v17, v17, v109, s[98:99]
  s_mov_b32 s62, 0x4000000
  s_mov_b32 s63, 0x40000000
  v_cndmask_b32 v16, v16, v110, s[62:63]
  s_mov_b32 s98, 0x8000000
  s_mov_b32 s99, 0x80000000
  v_cndmask_b32 v17, v17, v111, s[98:99]
  v_add_f32 v16, v16, v17
  s_waitcnt lgkmcnt(6)
  v_mfma_f32_32x32x16_bf16 v[96:111], v[48:51], v[128:131], 0
  ds_read_b64_tr_b16 v[56:57], v6 offset:2048
  ds_read_b64_tr_b16 v[58:59], v6 offset:2560
  v_and_b32 v28, 0x1f0, v1
  v_lshrrev_b32 v29, 9, v1
  v_lshl_add_u32 v28, v29, 2, v28
  s_lshl_b32 s61, s49, 9
  s_waitcnt lgkmcnt(6)
  v_mfma_f32_32x32x16_bf16 v[112:127], v[52:55], v[128:131], 0
  s_cmp_eq_u32 s6, 0
  s_cbranch_scc1 L_k1E_c49
L_k1E_c49_r:
  ds_read_b64_tr_b16 v[60:61], v6 offset:10240
  ds_read_b64_tr_b16 v[62:63], v6 offset:10752
  s_add_u32 m0, s54, 65536
  s_bfe_u32 s60, s12, 0x40010
  s_mul_i32 s60, s60, 229376
  s_add_u32 s60, s60, s57
  buffer_load_dwordx4 v8, s[32:35], s60 offen lds
  s_lshl_b32 s62, s50, 3
  s_add_u32 s61, s61, s62
  s_add_u32 s61, s61, 0x23400
  v_add_u32 v28, s61, v28
  s_waitcnt lgkmcnt(2)
  v_mfma_f32_32x32x16_bf16 v[96:111], v[56:59], v[132:135], v[96:111]
  ds_read_b64_tr_b16 v[48:49], v6 offset:4096
  ds_read_b64_tr_b16 v[50:51], v6 offset:4608
  ds_write_b32 v28, v16
  v_lshrrev_b32 v28, 1, v1
  s_lshl_b32 s61, s49, 8
  s_lshl_b32 s62, s50, 2
  s_waitcnt lgkmcnt(3)
  v_mfma_f32_32x32x16_bf16 v[112:127], v[60:63], v[132:135], v[112:127]
  s_cmp_eq_u32 s6, 1
  s_cbranch_scc1 L_k1E_c50
L_k1E_c50_r:
  ds_read_b64_tr_b16 v[52:53], v6 offset:12288
  ds_read_b64_tr_b16 v[54:55], v6 offset:12800
  s_add_u32 s61, s61, s62
  s_add_u32 s61, s61, 0x23000
  v_add_u32 v28, s61, v28
  v_mov_b32 v29, 0x23c00
  s_waitcnt lgkmcnt(3)
  v_mfma_f32_32x32x16_bf16 v[96:111], v[48:51], v[136:139], v[96:111]
  ds_read_b64_tr_b16 v[56:57], v6 offset:6144
  ds_read_b64_tr_b16 v[58:59], v6 offset:6656
  v_cmp_gt_u32 vcc, 256, v1
  s_nop 1
  v_cndmask_b32 v28, v29, v28
  ds_write_b32 v28, v12
  ds_write_b32 v28, v13 offset:128
  s_waitcnt lgkmcnt(4)
  v_mfma_f32_32x32x16_bf16 v[112:127], v[52:55], v[136:139], v[112:127]
  s_cmp_eq_u32 s6, 2
  s_cbranch_scc1 L_k1E_c51
L_k1E_c51_r:
  ds_read_b64_tr_b16 v[60:61], v6 offset:14336
  ds_read_b64_tr_b16 v[62:63], v6 offset:14848
  s_add_u32 m0, s54, 73728
  s_bfe_u32 s60, s12, 0x40010
  s_mul_i32 s60, s60, 229376
  s_add_u32 s60, s60, s57
  buffer_load_dwordx4 v8, s[36:39], s60 offen lds
  s_waitcnt vmcnt(6)
  s_waitcnt lgkmcnt(2)
  s_barrier
  v_mfma_f32_32x32x16_bf16 v[96:111], v[56:59], v[140:143], v[96:111]
  ds_read_b64_tr_b16 v[48:49], v6 offset:16384
  ds_read_b64_tr_b16 v[50:51], v6 offset:16896
  v_and_b32 v28, 0x1f0, v1
  s_lshl_b32 s61, s49, 9
  s_add_u32 s61, s61, 0x23400
  v_add_u32 v29, s61, v28
  s_waitcnt lgkmcnt(2)
  v_mfma_f32_32x32x16_bf16 v[112:127], v[60:63], v[140:143], v[112:127]
  s_cmp_eq_u32 s6, 3
  s_cbranch_scc1 L_k1E_c52
L_k1E_c52_r:
  ds_read_b64_tr_b16 v[52:53], v6 offset:24576
  ds_read_b64_tr_b16 v[54:55], v6 offset:25088
  ds_read_b128 v[16:19], v29
  v_lshrrev_b32 v28, 1, v28
  s_lshl_b32 s61, s49, 8
  s_add_u32 s61, s61, 0x23000
  s_waitcnt lgkmcnt(3)
  v_mfma_f32_32x32x16_bf16 v[96:111], v[48:51], v[144:147], v[96:111]
  ds_read_b64_tr_b16 v[56:57], v6 offset:18432
  ds_read_b64_tr_b16 v[58:59], v6 offset:18944
  v_add_u32 v29, s61, v28
  ds_read_b64 v[12:13], v29
  s_waitcnt lgkmcnt(4)
  v_mfma_f32_32x32x16_bf16 v[112:127], v[52:55], v[144:147], v[112:127]
  s_cmp_eq_u32 s6, 0
  s_cbranch_scc1 L_k1E_c53
L_k1E_c53_r:
  ds_read_b64_tr_b16 v[60:61], v6 offset:26624
  ds_read_b64_tr_b16 v[62:63], v6 offset:27136
  s_add_u32 m0, s54, 81920
  s_bfe_u32 s60, s12, 0x40014
  s_mul_i32 s60, s60, 229376
  s_add_u32 s60, s60, s57
  buffer_load_dwordx4 v8, s[32:35], s60 offen lds
  s_waitcnt lgkmcnt(5)
  v_add_f32 v16, v16, v17
  v_add_f32 v18, v18, v19
  s_waitcnt lgkmcnt(3)
  v_mfma_f32_32x32x16_bf16 v[96:111], v[56:59], v[148:151], v[96:111]
  ds_read_b64_tr_b16 v[48:49], v6 offset:20480
  ds_read_b64_tr_b16 v[50:51], v6 offset:20992
  s_waitcnt lgkmcnt(4)
  v_add_f32 v12, v12, v13
  v_add_f32 v16, v16, v18
  v_mul_f32 v12, 0x3b000000, v12
  v_mul_f32 v16, 0x3b000000, v16
  s_waitcnt lgkmcnt(2)
  v_mfma_f32_32x32x16_bf16 v[112:127], v[60:63], v[148:151], v[112:127]
  s_cmp_eq_u32 s6, 1
  s_cbranch_scc1 L_k1E_c54
L_k1E_c54_r:
  ds_read_b64_tr_b16 v[52:53], v6 offset:28672
  ds_read_b64_tr_b16 v[54:55], v6 offset:29184
  v_fma_f32 v16, -v12, v12, v16
  v_max_f32 v16, 0, v16
  v_sub_f32 v13, 0, v12
  v_cvt_pk_bf16_f32 v13, v13, v13
  s_waitcnt lgkmcnt(2)
  v_mfma_f32_32x32x16_bf16 v[96:111], v[48:51], v[152:155], v[96:111]
  ds_read_b64_tr_b16 v[56:57], v6 offset:22528
  ds_read_b64_tr_b16 v[58:59], v6 offset:23040
  v_cmp_gt_u32 vcc, 512, v1
  v_mov_b32 v14, 0
  s_nop 0
  v_cndmask_b32 v44, v14, v13
  v_cvt_pk_bf16_f32 v16, v16, v16
  s_waitcnt lgkmcnt(2)
  v_mfma_f32_32x32x16_bf16 v[112:127], v[52:55], v[152:155], v[112:127]
  s_cmp_eq_u32 s6, 2
  s_cbranch_scc1 L_k1E_c55
L_k1E_c55_r:
  ds_read_b64_tr_b16 v[60:61], v6 offset:30720
  ds_read_b64_tr_b16 v[62:63], v6 offset:31232
  s_add_u32 m0, s54, 90112
  s_bfe_u32 s60, s12, 0x40014
  s_mul_i32 s60, s60, 229376
  s_add_u32 s60, s60, s57
  buffer_load_dwordx4 v8, s[36:39], s60 offen lds
  v_lshlrev_b32 v16, 16, v16
  v_add_f32 v16, 0x3727c5ac, v16
  v_cvt_pk_bf16_f32 v16, v16, v16
  v_lshlrev_b32 v16, 16, v16
  s_waitcnt vmcnt(6)
  s_barrier
  s_waitcnt lgkmcnt(2)
  v_mfma_f32_32x32x16_bf16 v[96:111], v[56:59], v[156:159], v[96:111]
  ds_read_b64_tr_b16 v[48:49], v6 offset:32768
  ds_read_b64_tr_b16 v[50:51], v6 offset:33280
  v_sqrt_f32 v16, v16
  s_nop 0
  v_cvt_pk_bf16_f32 v16, v16, v16
  v_lshlrev_b32 v16, 16, v16
  s_waitcnt lgkmcnt(2)
  v_mfma_f32_32x32x16_bf16 v[112:127], v[60:63], v[156:159], v[112:127]
  s_cmp_eq_u32 s6, 3
  s_cbranch_scc1 L_k1E_c56
L_k1E_c56_r:
  ds_read_b64_tr_b16 v[52:53], v6 offset:40960
  ds_read_b64_tr_b16 v[54:55], v6 offset:41472
  v_rcp_f32 v17, v16
  v_mul_f32 v4, v16, v16
  v_mul_f32 v3, 0xc0135761, v17
  v_mul_f32 v18, v17, v17
  s_waitcnt lgkmcnt(2)
  v_mfma_f32_32x32x16_bf16 v[96:111], v[48:51], v[160:163], v[96:111]
  ds_read_b64_tr_b16 v[56:57], v6 offset:34816
  ds_read_b64_tr_b16 v[58:59], v6 offset:35328
  v_mul_f32 v18, v18, v17
  v_mul_f32 v2, 0xbdd2d3e8, v18
  v_mov_b32 v5, v17
  v_and_b32 v28, 0x1f0, v1
  s_waitcnt lgkmcnt(2)
  v_mfma_f32_32x32x16_bf16 v[112:127], v[52:55], v[160:163], v[112:127]
  s_cmp_eq_u32 s6, 0
  s_cbranch_scc1 L_k1E_c57
L_k1E_c57_r:
  ds_read_b64_tr_b16 v[60:61], v6 offset:43008
  ds_read_b64_tr_b16 v[62:63], v6 offset:43520
  s_add_u32 m0, s54, 0
  s_bfe_u32 s60, s12, 0x40018
  s_mul_i32 s60, s60, 229376
  s_add_u32 s60, s60, s57
  buffer_load_dwordx4 v8, s[32:35], s60 offen lds
  v_add_u32 v28, s4, v28
  ds_read_b128 v[20:23], v28 offset:0
  ds_read_b128 v[24:27], v28 offset:512
  s_waitcnt lgkmcnt(1)
  v_add_f32 v20, v20, v21
  v_mfma_f32_32x32x16_bf16 v[96:111], v[56:59], v[164:167], v[96:111]
  ds_read_b64_tr_b16 v[48:49], v6 offset:36864
  ds_read_b64_tr_b16 v[50:51], v6 offset:37376
  v_add_f32 v22, v22, v23
  v_add_f32 v20, v20, v22
  v_cvt_pk_bf16_f32 v21, v20, v20
  v_lshlrev_b32 v21, 16, v21
  v_mfma_f32_32x32x16_bf16 v[112:127], v[60:63], v[164:167], v[112:127]
  s_cmp_eq_u32 s6, 1
  s_cbranch_scc1 L_k1E_c58
L_k1E_c58_r:
  ds_read_b64_tr_b16 v[52:53], v6 offset:45056
  ds_read_b64_tr_b16 v[54:55], v6 offset:45568
  v_sub_f32 v21, v20, v21
  v_cvt_pk_bf16_f32 v46, v20, v21
  s_nop 1
  v_mfma_f32_32x32x8_bf16 v[64:79], v[46:47], v[44:45], v[64:79]
  s_waitcnt lgkmcnt(2)
  v_mfma_f32_32x32x16_bf16 v[96:111], v[48:51], v[168:171], v[96:111]
  ds_read_b64_tr_b16 v[56:57], v6 offset:38912
  ds_read_b64_tr_b16 v[58:59], v6 offset:39424
  v_add_f32 v24, v24, v25
  v_add_f32 v26, v26, v27
  v_add_f32 v24, v24, v26
  v_cvt_pk_bf16_f32 v25, v24, v24
  s_waitcnt lgkmcnt(2)
  v_mfma_f32_32x32x16_bf16 v[112:127], v[52:55], v[168:171], v[112:127]
  s_cmp_eq_u32 s6, 2
  s_cbranch_scc1 L_k1E_c59
L_k1E_c59_r:
  ds_read_b64_tr_b16 v[60:61], v6 offset:47104
  ds_read_b64_tr_b16 v[62:63], v6 offset:47616
  s_add_u32 m0, s54, 8192
  s_bfe_u32 s60, s12, 0x40018
  s_mul_i32 s60, s60, 229376
  s_add_u32 s60, s60, s57
  buffer_load_dwordx4 v8, s[36:39], s60 offen lds
  v_lshlrev_b32 v25, 16, v25
  v_sub_f32 v25, v24, v25
  v_cvt_pk_bf16_f32 v46, v24, v25
  s_waitcnt vmcnt(6)
  s_barrier
  s_waitcnt lgkmcnt(2)
  v_mfma_f32_32x32x16_bf16 v[96:111], v[56:59], v[172:175], v[96:111]
  ds_read_b64_tr_b16 v[48:49], v6 offset:49152
  ds_read_b64_tr_b16 v[50:51], v6 offset:49664
  v_mfma_f32_32x32x8_bf16 v[80:95], v[46:47], v[44:45], v[80:95]
  s_waitcnt lgkmcnt(2)
  v_mfma_f32_32x32x16_bf16 v[112:127], v[60:63], v[172:175], v[112:127]
  s_cmp_eq_u32 s6, 3
  s_cbranch_scc1 L_k1E_c60
L_k1E_c60_r:
  ds_read_b64_tr_b16 v[52:53], v6 offset:57344
  ds_read_b64_tr_b16 v[54:55], v6 offset:57856
  v_mul_f32 v28, v64, v64
  v_mul_f32 v29, v65, v65
  v_mul_f32 v30, v66, v66
  v_mul_f32 v31, v67, v67
  s_waitcnt lgkmcnt(2)
  v_mfma_f32_32x32x16_bf16 v[96:111], v[48:51], v[176:179], v[96:111]
  ds_read_b64_tr_b16 v[56:57], v6 offset:51200
  ds_read_b64_tr_b16 v[58:59], v6 offset:51712
  v_fma_f32 v28, v28, v2, v3
  v_fma_f32 v29, v29, v2, v3
  v_fma_f32 v30, v30, v2, v3
  v_fma_f32 v31, v31, v2, v3
  s_waitcnt lgkmcnt(2)
  v_mfma_f32_32x32x16_bf16 v[112:127], v[52:55], v[176:179], v[112:127]
  s_cmp_eq_u32 s6, 0
  s_cbranch_scc1 L_k1E_c61
L_k1E_c61_r:
  ds_read_b64_tr_b16 v[60:61], v6 offset:59392
  ds_read_b64_tr_b16 v[62:63], v6 offset:59904
  s_add_u32 m0, s54, 16384
  s_bfe_u32 s60, s12, 0x4001c
  s_mul_i32 s60, s60, 229376
  s_add_u32 s60, s60, s57
  buffer_load_dwordx4 v8, s[32:35], s60 offen lds
  v_mul_f32 v28, v64, v28
  v_mul_f32 v29, v65, v29
  v_mul_f32 v30, v66, v30
  v_mul_f32 v31, v67, v31
  s_waitcnt lgkmcnt(2)
  v_mfma_f32_32x32x16_bf16 v[96:111], v[56:59], v[180:183], v[96:111]
  ds_read_b64_tr_b16 v[48:49], v6 offset:53248
  ds_read_b64_tr_b16 v[50:51], v6 offset:53760
  v_exp_f32 v28, v28
  v_exp_f32 v29, v29
  v_exp_f32 v30, v30
  v_exp_f32 v31, v31
  s_waitcnt lgkmcnt(2)
  v_mfma_f32_32x32x16_bf16 v[112:127], v[60:63], v[180:183], v[112:127]
  s_cmp_eq_u32 s6, 1
  s_cbranch_scc1 L_k1E_c62
L_k1E_c62_r:
  ds_read_b64_tr_b16 v[52:53], v6 offset:61440
  ds_read_b64_tr_b16 v[54:55], v6 offset:61952
  v_mul_f32 v80, v64, v80
  v_mul_f32 v81, v65, v81
  v_mul_f32 v82, v66, v82
  v_mul_f32 v83, v67, v83
  s_waitcnt lgkmcnt(2)
  v_mfma_f32_32x32x16_bf16 v[96:111], v[48:51], v[184:187], v[96:111]
  ds_read_b64_tr_b16 v[56:57], v6 offset:55296
  ds_read_b64_tr_b16 v[58:59], v6 offset:55808
  v_fma_f32 v28, v28, v4, v4
  v_fma_f32 v29, v29, v4, v4
  v_fma_f32 v30, v30, v4, v4
  v_fma_f32 v31, v31, v4, v4
  s_waitcnt lgkmcnt(2)
  v_mfma_f32_32x32x16_bf16 v[112:127], v[52:55], v[184:187], v[112:127]
  s_cmp_eq_u32 s6, 2
  s_cbranch_scc1 L_k1E_c63
L_k1E_c63_r:
  ds_read_b64_tr_b16 v[60:61], v6 offset:63488
  ds_read_b64_tr_b16 v[62:63], v6 offset:64000
  s_add_u32 m0, s54, 24576
  s_bfe_u32 s60, s12, 0x4001c
  s_mul_i32 s60, s60, 229376
  s_add_u32 s60, s60, s57
  buffer_load_dwordx4 v8, s[36:39], s60 offen lds
  v_rcp_f32 v28, v28
  v_rcp_f32 v29, v29
  v_rcp_f32 v30, v30
  v_rcp_f32 v31, v31
  s_waitcnt vmcnt(6)
  s_barrier
  s_waitcnt lgkmcnt(2)
  v_mfma_f32_32x32x16_bf16 v[96:111], v[56:59], v[188:191], v[96:111]
  ds_read_b64_tr_b16 v[48:49], v7 offset:0
  ds_read_b64_tr_b16 v[50:51], v7 offset:512
  v_mul_f32 v80, v80, v28
  v_mul_f32 v81, v81, v29
  v_mul_f32 v82, v82, v30
  v_mul_f32 v83, v83, v31
  s_waitcnt lgkmcnt(2)
  v_mfma_f32_32x32x16_bf16 v[112:127], v[60:63], v[188:191], v[112:127]
  s_cmp_eq_u32 s6, 3
  s_cbranch_scc1 L_k1E_c64
L_k1E_c64_r:
  ds_read_b64_tr_b16 v[52:53], v7 offset:8192
  ds_read_b64_tr_b16 v[54:55], v7 offset:8704
  v_cvt_pk_bf16_f32 v20, v80, v81
  v_cvt_pk_bf16_f32 v21, v82, v83
  v_mul_f32 v28, v68, v68
  v_mul_f32 v29, v69, v69
  s_waitcnt lgkmcnt(2)
  v_mfma_f32_32x32x16_bf16 v[96:111], v[48:51], v[192:195], v[96:111]
  ds_read_b64_tr_b16 v[56:57], v7 offset:2048
  ds_read_b64_tr_b16 v[58:59], v7 offset:2560
  v_mul_f32 v30, v70, v70
  v_mul_f32 v31, v71, v71
  v_fma_f32 v28, v28, v2, v3
  v_fma_f32 v29, v29, v2, v3
  s_waitcnt lgkmcnt(2)
  v_mfma_f32_32x32x16_bf16 v[112:127], v[52:55], v[192:195], v[112:127]
  s_cmp_eq_u32 s6, 0
  s_cbranch_scc1 L_k1E_c65
L_k1E_c65_r:
  ds_read_b64_tr_b16 v[60:61], v7 offset:10240
  ds_read_b64_tr_b16 v[62:63], v7 offset:10752
  s_add_u32 m0, s55, 32768
  s_bfe_u32 s60, s13, 0x40000
  s_mul_i32 s60, s60, 196608
  s_add_u32 s60, s60, s58
  buffer_load_dwordx4 v9, s[28:31], s60 offen lds
  v_fma_f32 v30, v30, v2, v3
  v_fma_f32 v31, v31, v2, v3
  v_mul_f32 v28, v68, v28
  v_mul_f32 v29, v69, v29
  s_waitcnt lgkmcnt(2)
  v_mfma_f32_32x32x16_bf16 v[96:111], v[56:59], v[196:199], v[96:111]
  ds_read_b64_tr_b16 v[48:49], v7 offset:4096
  ds_read_b64_tr_b16 v[50:51], v7 offset:4608
  v_mul_f32 v30, v70, v30
  v_mul_f32 v31, v71, v31
  v_exp_f32 v28, v28
  v_exp_f32 v29, v29
  s_waitcnt lgkmcnt(2)
  v_mfma_f32_32x32x16_bf16 v[112:127], v[60:63], v[196:199], v[112:127]
  s_cmp_eq_u32 s6, 1
  s_cbranch_scc1 L_k1E_c66
L_k1E_c66_r:
  ds_read_b64_tr_b16 v[52:53], v7 offset:12288
  ds_read_b64_tr_b16 v[54:55], v7 offset:12800
  v_exp_f32 v30, v30
  v_exp_f32 v31, v31
  v_mul_f32 v84, v68, v84
  v_mul_f32 v85, v69, v85
  s_waitcnt lgkmcnt(2)
  v_mfma_f32_32x32x16_bf16 v[96:111], v[48:51], v[200:203], v[96:111]
  ds_read_b64_tr_b16 v[56:57], v7 offset:6144
  ds_read_b64_tr_b16 v[58:59], v7 offset:6656
  v_mul_f32 v86, v70, v86
  v_mul_f32 v87, v71, v87
  v_fma_f32 v28, v28, v4, v4
  v_fma_f32 v29, v29, v4, v4
  s_waitcnt lgkmcnt(2)
  v_mfma_f32_32x32x16_bf16 v[112:127], v[52:55], v[200:203], v[112:127]
  s_cmp_eq_u32 s6, 2
  s_cbranch_scc1 L_k1E_c67
L_k1E_c67_r:
  ds_read_b64_tr_b16 v[60:61], v7 offset:14336
  ds_read_b64_tr_b16 v[62:63], v7 offset:14848
  s_add_u32 m0, s55, 33792
  s_bfe_u32 s60, s13, 0x40000
  s_mul_i32 s60, s60, 196608
  s_add_u32 s60, s60, s58
  s_add_u32 s60, s60, 24576
  buffer_load_dwordx4 v9, s[28:31], s60 offen lds
  v_fma_f32 v30, v30, v4, v4
  v_fma_f32 v31, v31, v4, v4
  v_rcp_f32 v28, v28
  v_rcp_f32 v29, v29
  s_waitcnt vmcnt(6)
  s_barrier
  s_waitcnt lgkmcnt(2)
  v_mfma_f32_32x32x16_bf16 v[96:111], v[56:59], v[204:207], v[96:111]
  ds_read_b64_tr_b16 v[48:49], v7 offset:16384
  ds_read_b64_tr_b16 v[50:51], v7 offset:16896
  v_rcp_f32 v30, v30
  v_rcp_f32 v31, v31
  v_mul_f32 v84, v84, v28
  v_mul_f32 v85, v85, v29
  s_waitcnt lgkmcnt(2)
  v_mfma_f32_32x32x16_bf16 v[112:127], v[60:63], v[204:207], v[112:127]
  s_cmp_eq_u32 s6, 3
  s_cbranch_scc1 L_k1E_c68
L_k1E_c68_r:
  ds_read_b64_tr_b16 v[52:53], v7 offset:24576
  ds_read_b64_tr_b16 v[54:55], v7 offset:25088
  v_mul_f32 v86, v86, v30
  v_mul_f32 v87, v87, v31
  v_cvt_pk_bf16_f32 v22, v84, v85
  v_cvt_pk_bf16_f32 v23, v86, v87
  s_waitcnt lgkmcnt(2)
  v_mfma_f32_32x32x16_bf16 v[96:111], v[48:51], v[208:211], v[96:111]
  ds_read_b64_tr_b16 v[56:57], v7 offset:18432
  ds_read_b64_tr_b16 v[58:59], v7 offset:18944
  s_add_u32 s61, s66, 0
  buffer_store_dwordx4 v[20:23], v1, s[40:43], s61 offen sc1
  v_mul_f32 v28, v72, v72
  v_mul_f32 v29, v73, v73
  s_waitcnt lgkmcnt(2)
  v_mfma_f32_32x32x16_bf16 v[112:127], v[52:55], v[208:211], v[112:127]
  s_cmp_eq_u32 s6, 0
  s_cbranch_scc1 L_k1E_c69
L_k1E_c69_r:
  ds_read_b64_tr_b16 v[60:61], v7 offset:26624
  ds_read_b64_tr_b16 v[62:63], v7 offset:27136
  s_add_u32 m0, s55, 49152
  s_bfe_u32 s60, s13, 0x40008
  s_mul_i32 s60, s60, 196608
  s_add_u32 s60, s60, s58
  buffer_load_dwordx4 v9, s[28:31], s60 offen lds
  v_mul_f32 v30, v74, v74
  v_mul_f32 v31, v75, v75
  v_fma_f32 v28, v28, v2, v3
  v_fma_f32 v29, v29, v2, v3
  s_waitcnt lgkmcnt(2)
  v_mfma_f32_32x32x16_bf16 v[96:111], v[56:59], v[212:215], v[96:111]
  ds_read_b64_tr_b16 v[48:49], v7 offset:20480
  ds_read_b64_tr_b16 v[50:51], v7 offset:20992
  v_fma_f32 v30, v30, v2, v3
  v_fma_f32 v31, v31, v2, v3
  v_mul_f32 v28, v72, v28
  v_mul_f32 v29, v73, v29
  s_waitcnt lgkmcnt(2)
  v_mfma_f32_32x32x16_bf16 v[112:127], v[60:63], v[212:215], v[112:127]
  s_cmp_eq_u32 s6, 1
  s_cbranch_scc1 L_k1E_c70
L_k1E_c70_r:
  ds_read_b64_tr_b16 v[52:53], v7 offset:28672
  ds_read_b64_tr_b16 v[54:55], v7 offset:29184
  v_mul_f32 v30, v74, v30
  v_mul_f32 v31, v75, v31
  v_exp_f32 v28, v28
  v_exp_f32 v29, v29
  s_waitcnt lgkmcnt(2)
  v_mfma_f32_32x32x16_bf16 v[96:111], v[48:51], v[216:219], v[96:111]
  ds_read_b64_tr_b16 v[56:57], v7 offset:22528
  ds_read_b64_tr_b16 v[58:59], v7 offset:23040
  v_exp_f32 v30, v30
  v_exp_f32 v31, v31
  v_mul_f32 v88, v72, v88
  v_mul_f32 v89, v73, v89
  s_waitcnt lgkmcnt(2)
  v_mfma_f32_32x32x16_bf16 v[112:127], v[52:55], v[216:219], v[112:127]
  s_cmp_eq_u32 s6, 2
  s_cbranch_scc1 L_k1E_c71
L_k1E_c71_r:
  ds_read_b64_tr_b16 v[60:61], v7 offset:30720
  ds_read_b64_tr_b16 v[62:63], v7 offset:31232
  s_add_u32 m0, s55, 50176
  s_bfe_u32 s60, s13, 0x40008
  s_mul_i32 s60, s60, 196608
  s_add_u32 s60, s60, s58
  s_add_u32 s60, s60, 24576
  buffer_load_dwordx4 v9, s[28:31], s60 offen lds
  v_mul_f32 v90, v74, v90
  v_mul_f32 v91, v75, v91
  v_fma_f32 v28, v28, v4, v4
  v_fma_f32 v29, v29, v4, v4
  s_waitcnt vmcnt(7)
  s_barrier
  s_waitcnt lgkmcnt(2)
  v_mfma_f32_32x32x16_bf16 v[96:111], v[56:59], v[220:223], v[96:111]
  ds_read_b64_tr_b16 v[48:49], v6 offset:0
  ds_read_b64_tr_b16 v[50:51], v6 offset:512
  v_fma_f32 v30, v30, v4, v4
  v_fma_f32 v31, v31, v4, v4
  v_rcp_f32 v28, v28
  v_rcp_f32 v29, v29
  s_waitcnt lgkmcnt(2)
  v_mfma_f32_32x32x16_bf16 v[112:127], v[60:63], v[220:223], v[112:127]
  s_cmp_eq_u32 s6, 3
  s_cbranch_scc1 L_k1E_c72
L_k1E_c72_r:
  ds_read_b64_tr_b16 v[52:53], v6 offset:8192
  ds_read_b64_tr_b16 v[54:55], v6 offset:8704
  v_rcp_f32 v30, v30
  v_rcp_f32 v31, v31
  v_mul_f32 v88, v88, v28
  v_mul_f32 v89, v89, v29
  s_waitcnt lgkmcnt(2)
  v_mfma_f32_32x32x16_bf16 v[96:111], v[48:51], v[224:227], v[96:111]
  ds_read_b64_tr_b16 v[56:57], v6 offset:2048
  ds_read_b64_tr_b16 v[58:59], v6 offset:2560
  v_mul_f32 v90, v90, v30
  v_mul_f32 v91, v91, v31
  v_cvt_pk_bf16_f32 v24, v88, v89
  v_cvt_pk_bf16_f32 v25, v90, v91
  s_waitcnt lgkmcnt(2)
  v_mfma_f32_32x32x16_bf16 v[112:127], v[52:55], v[224:227], v[112:127]
  s_cmp_eq_u32 s6, 0
  s_cbranch_scc1 L_k1E_c73
L_k1E_c73_r:
  ds_read_b64_tr_b16 v[60:61], v6 offset:10240
  ds_read_b64_tr_b16 v[62:63], v6 offset:10752
  s_add_u32 m0, s55, 65536
  s_bfe_u32 s60, s13, 0x40010
  s_mul_i32 s60, s60, 196608
  s_add_u32 s60, s60, s58
  buffer_load_dwordx4 v9, s[28:31], s60 offen lds
  v_mul_f32 v28, v76, v76
  v_mul_f32 v29, v77, v77
  v_mul_f32 v30, v78, v78
  v_mul_f32 v31, v79, v79
  s_waitcnt lgkmcnt(2)
  v_mfma_f32_32x32x16_bf16 v[96:111], v[56:59], v[228:231], v[96:111]
  ds_read_b64_tr_b16 v[48:49], v6 offset:4096
  ds_read_b64_tr_b16 v[50:51], v6 offset:4608
  v_fma_f32 v28, v28, v2, v3
  v_fma_f32 v29, v29, v2, v3
  v_fma_f32 v30, v30, v2, v3
  v_fma_f32 v31, v31, v2, v3
  s_waitcnt lgkmcnt(2)
  v_mfma_f32_32x32x16_bf16 v[112:127], v[60:63], v[228:231], v[112:127]
  s_cmp_eq_u32 s6, 1
  s_cbranch_scc1 L_k1E_c74
L_k1E_c74_r:
  ds_read_b64_tr_b16 v[52:53], v6 offset:12288
  ds_read_b64_tr_b16 v[54:55], v6 offset:12800
  v_mul_f32 v28, v76, v28
  v_mul_f32 v29, v77, v29
  v_mul_f32 v30, v78, v30
  v_mul_f32 v31, v79, v31
  s_waitcnt lgkmcnt(2)
  v_mfma_f32_32x32x16_bf16 v[96:111], v[48:51], v[232:235], v[96:111]
  ds_read_b64_tr_b16 v[56:57], v6 offset:6144
  ds_read_b64_tr_b16 v[58:59], v6 offset:6656
  v_exp_f32 v28, v28
  v_exp_f32 v29, v29
  v_exp_f32 v30, v30
  v_exp_f32 v31, v31
  s_waitcnt lgkmcnt(2)
  v_mfma_f32_32x32x16_bf16 v[112:127], v[52:55], v[232:235], v[112:127]
  s_cmp_eq_u32 s6, 2
  s_cbranch_scc1 L_k1E_c75
L_k1E_c75_r:
  ds_read_b64_tr_b16 v[60:61], v6 offset:14336
  ds_read_b64_tr_b16 v[62:63], v6 offset:14848
  s_add_u32 m0, s55, 66560
  s_bfe_u32 s60, s13, 0x40010
  s_mul_i32 s60, s60, 196608
  s_add_u32 s60, s60, s58
  s_add_u32 s60, s60, 24576
  buffer_load_dwordx4 v9, s[28:31], s60 offen lds
  v_mul_f32 v92, v76, v92
  v_mul_f32 v93, v77, v93
  v_mul_f32 v94, v78, v94
  v_mul_f32 v95, v79, v95
  s_waitcnt vmcnt(7)
  s_barrier
  s_waitcnt lgkmcnt(2)
  v_mfma_f32_32x32x16_bf16 v[96:111], v[56:59], v[236:239], v[96:111]
  ds_read_b64_tr_b16 v[48:49], v6 offset:16384
  ds_read_b64_tr_b16 v[50:51], v6 offset:16896
  v_fma_f32 v28, v28, v4, v4
  v_fma_f32 v29, v29, v4, v4
  v_fma_f32 v30, v30, v4, v4
  v_fma_f32 v31, v31, v4, v4
  s_waitcnt lgkmcnt(2)
  v_mfma_f32_32x32x16_bf16 v[112:127], v[60:63], v[236:239], v[112:127]
  s_cmp_eq_u32 s6, 3
  s_cbranch_scc1 L_k1E_c76
L_k1E_c76_r:
  ds_read_b64_tr_b16 v[52:53], v6 offset:24576
  ds_read_b64_tr_b16 v[54:55], v6 offset:25088
  v_rcp_f32 v28, v28
  v_rcp_f32 v29, v29
  v_rcp_f32 v30, v30
  v_rcp_f32 v31, v31
  s_waitcnt lgkmcnt(2)
  v_mfma_f32_32x32x16_bf16 v[96:111], v[48:51], v[240:243], v[96:111]
  ds_read_b64_tr_b16 v[56:57], v6 offset:18432
  ds_read_b64_tr_b16 v[58:59], v6 offset:18944
  v_mul_f32 v92, v92, v28
  v_mul_f32 v93, v93, v29
  v_mul_f32 v94, v94, v30
  v_mul_f32 v95, v95, v31
  s_waitcnt lgkmcnt(2)
  v_mfma_f32_32x32x16_bf16 v[112:127], v[52:55], v[240:243], v[112:127]
  s_cmp_eq_u32 s6, 0
  s_cbranch_scc1 L_k1E_c77
L_k1E_c77_r:
  ds_read_b64_tr_b16 v[60:61], v6 offset:26624
  ds_read_b64_tr_b16 v[62:63], v6 offset:27136
  s_add_u32 m0, s55, 81920
  s_bfe_u32 s60, s13, 0x40018
  s_mul_i32 s60, s60, 196608
  s_add_u32 s60, s60, s58
  buffer_load_dwordx4 v9, s[28:31], s60 offen lds
  v_cvt_pk_bf16_f32 v26, v92, v93
  v_cvt_pk_bf16_f32 v27, v94, v95
  s_add_u32 s61, s66, 1024
  buffer_store_dwordx4 v[24:27], v1, s[40:43], s61 offen sc1
  s_waitcnt lgkmcnt(2)
  v_mfma_f32_32x32x16_bf16 v[96:111], v[56:59], v[244:247], v[96:111]
  ds_read_b64_tr_b16 v[48:49], v6 offset:20480
  ds_read_b64_tr_b16 v[50:51], v6 offset:20992
  s_waitcnt lgkmcnt(2)
  v_mfma_f32_32x32x16_bf16 v[112:127], v[60:63], v[244:247], v[112:127]
  s_cmp_eq_u32 s6, 1
  s_cbranch_scc1 L_k1E_c78
L_k1E_c78_r:
  ds_read_b64_tr_b16 v[52:53], v6 offset:28672
  ds_read_b64_tr_b16 v[54:55], v6 offset:29184
  s_waitcnt lgkmcnt(2)
  v_mfma_f32_32x32x16_bf16 v[96:111], v[48:51], v[248:251], v[96:111]
  ds_read_b64_tr_b16 v[56:57], v6 offset:22528
  ds_read_b64_tr_b16 v[58:59], v6 offset:23040
  s_waitcnt lgkmcnt(2)
  v_mfma_f32_32x32x16_bf16 v[112:127], v[52:55], v[248:251], v[112:127]
  s_cmp_eq_u32 s6, 2
  s_cbranch_scc1 L_k1E_c79
L_k1E_c79_r:
  ds_read_b64_tr_b16 v[60:61], v6 offset:30720
  ds_read_b64_tr_b16 v[62:63], v6 offset:31232
  s_add_u32 m0, s55, 82944
  s_bfe_u32 s60, s13, 0x40018
  s_mul_i32 s60, s60, 196608
  s_add_u32 s60, s60, s58
  s_add_u32 s60, s60, 24576
  buffer_load_dwordx4 v9, s[28:31], s60 offen lds
  s_waitcnt vmcnt(8)
  s_barrier
  s_waitcnt lgkmcnt(2)
  v_mfma_f32_32x32x16_bf16 v[96:111], v[56:59], v[252:255], v[96:111]
  s_waitcnt lgkmcnt(0)
  v_mfma_f32_32x32x16_bf16 v[112:127], v[60:63], v[252:255], v[112:127]
  s_cmp_eq_u32 s6, 3
  s_cbranch_scc1 L_k1E_c80
L_k1E_c80_r:
  ds_read_b64_tr_b16 v[48:49], v6 offset:32768
  ds_read_b64_tr_b16 v[50:51], v6 offset:33280
  ds_read_b64_tr_b16 v[52:53], v6 offset:34816
  ds_read_b64_tr_b16 v[54:55], v6 offset:35328
  s_memtime s[20:21]
  v_mov_b32 v29, 0x23c00
  v_add_u32 v28, s5, v1
  v_cmp_gt_u32 vcc, 256, v1
  s_nop 1
  v_cndmask_b32 v28, v29, v28
  ds_write_b32 v28, v36 offset:2048
  ds_write_b32 v28, v37 offset:2304
  ds_write_b32 v28, v40 offset:2560
  ds_write_b32 v28, v41 offset:2816
  s_waitcnt lgkmcnt(6)
  v_mfma_f32_32x32x16_bf16 v[64:79], v[48:51], v[128:131], 0
  ds_read_b64_tr_b16 v[56:57], v6 offset:36864
  ds_read_b64_tr_b16 v[58:59], v6 offset:37376
  s_mov_b32 s68, s16
  s_mov_b32 s69, s17
  s_mov_b32 s70, 0x1c0000
  s_mov_b32 s71, 0x20000
  s_mov_b32 s72, s8
  s_mov_b32 s73, s9
  s_mov_b32 s74, 0x80000
  s_mov_b32 s75, 0x20000
  s_mul_i32 s62, s77, 72
  s_mul_i32 s63, s48, 9
  s_add_u32 s62, s62, s63
  v_lshrrev_b32 v12, 6, v1
  v_add_u32 v12, s62, v12
  v_lshlrev_b32 v12, 10, v12
  v_and_b32 v13, 48, v1
  v_lshlrev_b32 v13, 3, v13
  v_add_u32 v12, v12, v13
  s_lshl_b32 s62, s78, 9
  v_add_u32 v12, s62, v12
  v_mov_b32 v13, 0x7ffffff0
  v_cmp_gt_u32 vcc, 576, v1
  s_nop 1
  v_cndmask_b32 v12, v13, v12
  buffer_load_dword v14, v12, s[68:71], 0 offen
  v_subrev_u32 v13, 1835008, v12
  buffer_load_dword v15, v13, s[72:75], 0 offen
  s_getpc_b64 s[80:81]
L_k1_pc2E:
  s_add_u32 s80, s80, L_p2_startE-L_k1_pc2E
  s_addc_u32 s81, s81, 0
  v_add_u32 v16, s54, v1
  global_load_dword v17, v16, s[80:81]
  v_add_u32 v16, 0x2000, v16
  global_load_dword v18, v16, s[80:81]
  s_waitcnt lgkmcnt(6)
  v_mfma_f32_32x32x16_bf16 v[64:79], v[52:55], v[132:135], v[64:79]
  s_cmp_eq_u32 s6, 0
  s_cbranch_scc1 L_k1E_c81
L_k1E_c81_r:
  ds_read_b64_tr_b16 v[60:61], v6 offset:38912
  ds_read_b64_tr_b16 v[62:63], v6 offset:39424
  s_waitcnt lgkmcnt(2)
  v_mfma_f32_32x32x16_bf16 v[64:79], v[56:59], v[136:139], v[64:79]
  ds_read_b64_tr_b16 v[48:49], v6 offset:40960
  ds_read_b64_tr_b16 v[50:51], v6 offset:41472
  s_waitcnt lgkmcnt(2)
  v_mfma_f32_32x32x16_bf16 v[64:79], v[60:63], v[140:143], v[64:79]
  s_cmp_eq_u32 s6, 1
  s_cbranch_scc1 L_k1E_c82
L_k1E_c82_r:
  ds_read_b64_tr_b16 v[52:53], v6 offset:43008
  ds_read_b64_tr_b16 v[54:55], v6 offset:43520
  s_waitcnt lgkmcnt(2)
  v_mfma_f32_32x32x16_bf16 v[64:79], v[48:51], v[144:147], v[64:79]
  ds_read_b64_tr_b16 v[56:57], v6 offset:45056
  ds_read_b64_tr_b16 v[58:59], v6 offset:45568
  s_waitcnt lgkmcnt(2)
  v_mfma_f32_32x32x16_bf16 v[64:79], v[52:55], v[148:151], v[64:79]
  s_cmp_eq_u32 s6, 2
  s_cbranch_scc1 L_k1E_c83
L_k1E_c83_r:
  ds_read_b64_tr_b16 v[60:61], v6 offset:47104
  ds_read_b64_tr_b16 v[62:63], v6 offset:47616
  s_waitcnt vmcnt(9)
  s_waitcnt vmcnt(5)
  s_barrier
  s_waitcnt vmcnt(2)
  v_add_u32 v15, s54, v1
  v_mov_b32 v16, 0x7ffffff0
  v_cmp_ne_u32 vcc, 0, v15
  s_nop 1
  v_cndmask_b32 v15, v15, v16
  v_mov_b32 v16, 1
  buffer_atomic_add v16, v15, s[40:43], s87 offen
  s_waitcnt lgkmcnt(2)
  v_mfma_f32_32x32x16_bf16 v[64:79], v[56:59], v[152:155], v[64:79]
  ds_read_b64_tr_b16 v[48:49], v6 offset:49152
  ds_read_b64_tr_b16 v[50:51], v6 offset:49664
  v_and_b32 v28, 0x1f0, v1
  v_add_u32 v28, s4, v28
  ds_read_b128 v[20:23], v28 offset:2048
  ds_read_b128 v[24:27], v28 offset:2560
  s_waitcnt lgkmcnt(1)
  v_add_f32 v20, v20, v21
  v_add_f32 v22, v22, v23
  v_mfma_f32_32x32x16_bf16 v[64:79], v[60:63], v[156:159], v[64:79]
  s_cmp_eq_u32 s6, 3
  s_cbranch_scc1 L_k1E_c84
L_k1E_c84_r:
  ds_read_b64_tr_b16 v[52:53], v6 offset:51200
  ds_read_b64_tr_b16 v[54:55], v6 offset:51712
  v_add_f32 v20, v20, v22
  v_cvt_pk_bf16_f32 v21, v20, v20
  v_lshlrev_b32 v21, 16, v21
  v_sub_f32 v21, v20, v21
  v_cvt_pk_bf16_f32 v46, v20, v21
  v_mfma_f32_32x32x16_bf16 v[64:79], v[48:51], v[160:163], v[64:79]
  ds_read_b64_tr_b16 v[56:57], v6 offset:53248
  ds_read_b64_tr_b16 v[58:59], v6 offset:53760
  v_mfma_f32_32x32x8_bf16 v[96:111], v[46:47], v[44:45], v[96:111]
  s_waitcnt lgkmcnt(4)
  v_add_f32 v24, v24, v25
  v_add_f32 v26, v26, v27
  v_add_f32 v24, v24, v26
  v_cvt_pk_bf16_f32 v25, v24, v24
  v_lshlrev_b32 v25, 16, v25
  s_waitcnt lgkmcnt(2)
  v_mfma_f32_32x32x16_bf16 v[64:79], v[52:55], v[164:167], v[64:79]
  s_cmp_eq_u32 s6, 0
  s_cbranch_scc1 L_k1E_c85
L_k1E_c85_r:
  ds_read_b64_tr_b16 v[60:61], v6 offset:55296
  ds_read_b64_tr_b16 v[62:63], v6 offset:55808
  v_sub_f32 v25, v24, v25
  v_cvt_pk_bf16_f32 v46, v24, v25
  s_nop 1
  v_mfma_f32_32x32x8_bf16 v[112:127], v[46:47], v[44:45], v[112:127]
  s_waitcnt lgkmcnt(2)
  v_mfma_f32_32x32x16_bf16 v[64:79], v[56:59], v[168:171], v[64:79]
  ds_read_b64_tr_b16 v[48:49], v6 offset:57344
  ds_read_b64_tr_b16 v[50:51], v6 offset:57856
  v_mul_f32 v28, v96, v96
  v_mul_f32 v29, v97, v97
  v_mul_f32 v30, v98, v98
  v_mul_f32 v31, v99, v99
  v_fma_f32 v28, v28, v2, v3
  s_waitcnt lgkmcnt(2)
  v_mfma_f32_32x32x16_bf16 v[64:79], v[60:63], v[172:175], v[64:79]
  s_cmp_eq_u32 s6, 1
  s_cbranch_scc1 L_k1E_c86
L_k1E_c86_r:
  ds_read_b64_tr_b16 v[52:53], v6 offset:59392
  ds_read_b64_tr_b16 v[54:55], v6 offset:59904
  v_fma_f32 v29, v29, v2, v3
  v_fma_f32 v30, v30, v2, v3
  v_fma_f32 v31, v31, v2, v3
  v_mul_f32 v28, v96, v28
  v_mul_f32 v29, v97, v29
  v_mul_f32 v30, v98, v30
  s_waitcnt lgkmcnt(2)
  v_mfma_f32_32x32x16_bf16 v[64:79], v[48:51], v[176:179], v[64:79]
  ds_read_b64_tr_b16 v[56:57], v6 offset:61440
  ds_read_b64_tr_b16 v[58:59], v6 offset:61952
  v_mul_f32 v31, v99, v31
  v_exp_f32 v28, v28
  v_exp_f32 v29, v29
  v_exp_f32 v30, v30
  v_exp_f32 v31, v31
  v_mul_f32 v112, v96, v112
  s_waitcnt lgkmcnt(2)
  v_mfma_f32_32x32x16_bf16 v[64:79], v[52:55], v[180:183], v[64:79]
  s_cmp_eq_u32 s6, 2
  s_cbranch_scc1 L_k1E_c87
L_k1E_c87_r:
  ds_read_b64_tr_b16 v[60:61], v6 offset:63488
  ds_read_b64_tr_b16 v[62:63], v6 offset:64000
  v_mul_f32 v113, v97, v113
  v_mul_f32 v114, v98, v114
  v_mul_f32 v115, v99, v115
  v_fma_f32 v28, v28, v4, v4
  v_fma_f32 v29, v29, v4, v4
  v_fma_f32 v30, v30, v4, v4
  s_barrier
  s_waitcnt lgkmcnt(2)
  v_mfma_f32_32x32x16_bf16 v[64:79], v[56:59], v[184:187], v[64:79]
  ds_read_b64_tr_b16 v[48:49], v7 offset:0
  ds_read_b64_tr_b16 v[50:51], v7 offset:512
  v_fma_f32 v31, v31, v4, v4
  v_rcp_f32 v28, v28
  v_rcp_f32 v29, v29
  v_rcp_f32 v30, v30
  v_rcp_f32 v31, v31
  v_mul_f32 v112, v112, v28
  s_waitcnt lgkmcnt(2)
  v_mfma_f32_32x32x16_bf16 v[64:79], v[60:63], v[188:191], v[64:79]
  s_cmp_eq_u32 s6, 3
  s_cbranch_scc1 L_k1E_c88
L_k1E_c88_r:
  ds_read_b64_tr_b16 v[52:53], v7 offset:2048
  ds_read_b64_tr_b16 v[54:55], v7 offset:2560
  v_mul_f32 v113, v113, v29
  v_mul_f32 v114, v114, v30
  v_mul_f32 v115, v115, v31
  v_cvt_pk_bf16_f32 v20, v112, v113
  v_cvt_pk_bf16_f32 v21, v114, v115
  v_mul_f32 v28, v100, v100
  s_waitcnt lgkmcnt(2)
  v_mfma_f32_32x32x16_bf16 v[64:79], v[48:51], v[192:195], v[64:79]
  ds_read_b64_tr_b16 v[56:57], v7 offset:4096
  ds_read_b64_tr_b16 v[58:59], v7 offset:4608
  v_mul_f32 v29, v101, v101
  v_mul_f32 v30, v102, v102
  v_mul_f32 v31, v103, v103
  v_fma_f32 v28, v28, v2, v3
  v_fma_f32 v29, v29, v2, v3
  v_fma_f32 v30, v30, v2, v3
  s_waitcnt lgkmcnt(2)
  v_mfma_f32_32x32x16_bf16 v[64:79], v[52:55], v[196:199], v[64:79]
  s_cmp_eq_u32 s6, 0
  s_cbranch_scc1 L_k1E_c89
L_k1E_c89_r:
  ds_read_b64_tr_b16 v[60:61], v7 offset:6144
  ds_read_b64_tr_b16 v[62:63], v7 offset:6656
  v_fma_f32 v31, v31, v2, v3
  v_mul_f32 v28, v100, v28
  v_mul_f32 v29, v101, v29
  v_mul_f32 v30, v102, v30
  v_mul_f32 v31, v103, v31
  v_exp_f32 v28, v28
  s_waitcnt lgkmcnt(2)
  v_mfma_f32_32x32x16_bf16 v[64:79], v[56:59], v[200:203], v[64:79]
  ds_read_b64_tr_b16 v[48:49], v7 offset:8192
  ds_read_b64_tr_b16 v[50:51], v7 offset:8704
  v_exp_f32 v29, v29
  v_exp_f32 v30, v30
  v_exp_f32 v31, v31
  v_mul_f32 v116, v100, v116
  v_mul_f32 v117, v101, v117
  v_mul_f32 v118, v102, v118
  s_waitcnt lgkmcnt(2)
  v_mfma_f32_32x32x16_bf16 v[64:79], v[60:63], v[204:207], v[64:79]
  s_cmp_eq_u32 s6, 1
  s_cbranch_scc1 L_k1E_c90
L_k1E_c90_r:
  ds_read_b64_tr_b16 v[52:53], v7 offset:10240
  ds_read_b64_tr_b16 v[54:55], v7 offset:10752
  v_mul_f32 v119, v103, v119
  v_fma_f32 v28, v28, v4, v4
  v_fma_f32 v29, v29, v4, v4
  v_fma_f32 v30, v30, v4, v4
  v_fma_f32 v31, v31, v4, v4
  v_rcp_f32 v28, v28
  s_waitcnt lgkmcnt(2)
  v_mfma_f32_32x32x16_bf16 v[64:79], v[48:51], v[208:211], v[64:79]
  ds_read_b64_tr_b16 v[56:57], v7 offset:12288
  ds_read_b64_tr_b16 v[58:59], v7 offset:12800
  v_rcp_f32 v29, v29
  v_rcp_f32 v30, v30
  v_rcp_f32 v31, v31
  v_mul_f32 v116, v116, v28
  v_mul_f32 v117, v117, v29
  v_mul_f32 v118, v118, v30
  s_waitcnt lgkmcnt(2)
  v_mfma_f32_32x32x16_bf16 v[64:79], v[52:55], v[212:215], v[64:79]
  s_cmp_eq_u32 s6, 2
  s_cbranch_scc1 L_k1E_c91
L_k1E_c91_r:
  ds_read_b64_tr_b16 v[60:61], v7 offset:14336
  ds_read_b64_tr_b16 v[62:63], v7 offset:14848
  v_mul_f32 v119, v119, v31
  v_cvt_pk_bf16_f32 v22, v116, v117
  v_cvt_pk_bf16_f32 v23, v118, v119
  s_add_u32 s61, s67, 0
  buffer_store_dwordx4 v[20:23], v1, s[40:43], s61 offen sc1
  v_mul_f32 v28, v104, v104
  s_barrier
  s_waitcnt lgkmcnt(2)
  v_mfma_f32_32x32x16_bf16 v[64:79], v[56:59], v[216:219], v[64:79]
  ds_read_b64_tr_b16 v[48:49], v7 offset:16384
  ds_read_b64_tr_b16 v[50:51], v7 offset:16896
  v_mul_f32 v29, v105, v105
  v_mul_f32 v30, v106, v106
  v_mul_f32 v31, v107, v107
  v_fma_f32 v28, v28, v2, v3
  v_fma_f32 v29, v29, v2, v3
  v_fma_f32 v30, v30, v2, v3
  s_waitcnt lgkmcnt(2)
  v_mfma_f32_32x32x16_bf16 v[64:79], v[60:63], v[220:223], v[64:79]
  s_cmp_eq_u32 s6, 3
  s_cbranch_scc1 L_k1E_c92
L_k1E_c92_r:
  ds_read_b64_tr_b16 v[52:53], v7 offset:18432
  ds_read_b64_tr_b16 v[54:55], v7 offset:18944
  v_fma_f32 v31, v31, v2, v3
  v_mul_f32 v28, v104, v28
  v_mul_f32 v29, v105, v29
  v_mul_f32 v30, v106, v30
  v_mul_f32 v31, v107, v31
  v_exp_f32 v28, v28
  s_waitcnt lgkmcnt(2)
  v_mfma_f32_32x32x16_bf16 v[64:79], v[48:51], v[224:227], v[64:79]
  ds_read_b64_tr_b16 v[56:57], v7 offset:20480
  ds_read_b64_tr_b16 v[58:59], v7 offset:20992
  v_exp_f32 v29, v29
  v_exp_f32 v30, v30
  v_exp_f32 v31, v31
  v_mul_f32 v120, v104, v120
  v_mul_f32 v121, v105, v121
  v_mul_f32 v122, v106, v122
  s_waitcnt lgkmcnt(2)
  v_mfma_f32_32x32x16_bf16 v[64:79], v[52:55], v[228:231], v[64:79]
  s_cmp_eq_u32 s6, 0
  s_cbranch_scc1 L_k1E_c93
L_k1E_c93_r:
  ds_read_b64_tr_b16 v[60:61], v7 offset:22528
  ds_read_b64_tr_b16 v[62:63], v7 offset:23040
  v_mul_f32 v123, v107, v123
  v_fma_f32 v28, v28, v4, v4
  v_fma_f32 v29, v29, v4, v4
  v_fma_f32 v30, v30, v4, v4
  v_fma_f32 v31, v31, v4, v4
  v_rcp_f32 v28, v28
  s_waitcnt lgkmcnt(2)
  v_mfma_f32_32x32x16_bf16 v[64:79], v[56:59], v[232:235], v[64:79]
  ds_read_b64_tr_b16 v[48:49], v7 offset:24576
  ds_read_b64_tr_b16 v[50:51], v7 offset:25088
  v_rcp_f32 v29, v29
  v_rcp_f32 v30, v30
  v_rcp_f32 v31, v31
  v_mul_f32 v120, v120, v28
  v_mul_f32 v121, v121, v29
  v_mul_f32 v122, v122, v30
  buffer_load_dword v0, off, s[40:43], s87 sc1
  s_waitcnt lgkmcnt(2)
  v_mfma_f32_32x32x16_bf16 v[64:79], v[60:63], v[236:239], v[64:79]
  s_cmp_eq_u32 s6, 1
  s_cbranch_scc1 L_k1E_c94
L_k1E_c94_r:
  ds_read_b64_tr_b16 v[52:53], v7 offset:26624
  ds_read_b64_tr_b16 v[54:55], v7 offset:27136
  v_mul_f32 v123, v123, v31
  v_cvt_pk_bf16_f32 v24, v120, v121
  v_cvt_pk_bf16_f32 v25, v122, v123
  v_mul_f32 v28, v108, v108
  v_mul_f32 v29, v109, v109
  v_mul_f32 v30, v110, v110
  s_waitcnt lgkmcnt(2)
  v_mfma_f32_32x32x16_bf16 v[64:79], v[48:51], v[240:243], v[64:79]
  ds_read_b64_tr_b16 v[56:57], v7 offset:28672
  ds_read_b64_tr_b16 v[58:59], v7 offset:29184
  v_mul_f32 v31, v111, v111
  v_fma_f32 v28, v28, v2, v3
  v_fma_f32 v29, v29, v2, v3
  v_fma_f32 v30, v30, v2, v3
  v_fma_f32 v31, v31, v2, v3
  v_mul_f32 v28, v108, v28
  s_waitcnt lgkmcnt(2)
  v_mfma_f32_32x32x16_bf16 v[64:79], v[52:55], v[244:247], v[64:79]
  s_cmp_eq_u32 s6, 2
  s_cbranch_scc1 L_k1E_c95
L_k1E_c95_r:
  ds_read_b64_tr_b16 v[60:61], v7 offset:30720
  ds_read_b64_tr_b16 v[62:63], v7 offset:31232
  v_mul_f32 v29, v109, v29
  v_mul_f32 v30, v110, v30
  v_mul_f32 v31, v111, v31
  v_exp_f32 v28, v28
  v_exp_f32 v29, v29
  v_exp_f32 v30, v30
  s_waitcnt lgkmcnt(2)
  v_mfma_f32_32x32x16_bf16 v[64:79], v[56:59], v[248:251], v[64:79]
  v_exp_f32 v31, v31
  v_mul_f32 v124, v108, v124
  v_mul_f32 v125, v109, v125
  v_mul_f32 v126, v110, v126
  v_mul_f32 v127, v111, v127
  v_fma_f32 v28, v28, v4, v4
  s_waitcnt lgkmcnt(0)
  v_mfma_f32_32x32x16_bf16 v[64:79], v[60:63], v[252:255], v[64:79]
  s_cmp_eq_u32 s6, 3
  s_cbranch_scc1 L_k1E_c96
L_k1E_c96_r:
  v_fma_f32 v29, v29, v4, v4
  v_fma_f32 v30, v30, v4, v4
  v_fma_f32 v31, v31, v4, v4
  v_rcp_f32 v28, v28
  v_rcp_f32 v29, v29
  v_rcp_f32 v30, v30
  v_rcp_f32 v31, v31
  v_mul_f32 v124, v124, v28
  v_mul_f32 v125, v125, v29
  v_mul_f32 v126, v126, v30
  v_mul_f32 v127, v127, v31
  v_cvt_pk_bf16_f32 v26, v124, v125
  v_cvt_pk_bf16_f32 v27, v126, v127
  s_add_u32 s61, s67, 1024
  buffer_store_dwordx4 v[24:27], v1, s[40:43], s61 offen sc1
  v_mov_b32 v29, 0x23c00
  v_add_u32 v28, s5, v1
  v_cmp_gt_u32 vcc, 256, v1
  s_nop 1
  v_cndmask_b32 v28, v29, v28
  ds_write_b32 v28, v36 offset:0
  ds_write_b32 v28, v37 offset:256
  s_waitcnt lgkmcnt(0)
  s_barrier
L_p2_startE:
  s_memtime s[44:45]
  s_load_dwordx2 s[28:29], s[0:1], 56
  v_lshrrev_b32 v176, 4, v1
  s_lshr_b32 s60, s83, 3
  s_lshl_b32 s60, s60, 2
  s_and_b32 s61, s83, 3
  s_add_u32 s33, s60, s61
  s_lshr_b32 s60, s83, 2
  s_and_b32 s60, s60, 1
  s_lshl_b32 s61, s51, 1
  s_add_u32 s32, s61, s60
  s_lshl_b32 s39, s51, 8
  s_add_u32 s39, s39, 0x972800
  s_cmp_ge_u32 s48, 4
  s_cbranch_scc1 L_p2_loaderE
  s_and_b32 s60, s48, 1
  s_lshr_b32 s61, s48, 1
  v_lshlrev_b32 v177, 4, v176
  s_lshl_b32 s62, s60, 12
  v_add_u32 v177, s62, v177
  v_add_u32 v178, 0x10000, v177
  v_add_u32 v179, 0x20000, v177
  v_lshrrev_b32 v192, 5, v176
  v_lshlrev_b32 v192, 2, v192
  v_bfe_u32 v193, v176, 2, 2
  v_add_u32 v192, v192, v193
  v_bfe_u32 v194, v176, 4, 1
  v_bfe_u32 v195, v176, 1, 1
  v_and_b32 v196, 1, v176
  v_lshlrev_b32 v196, 3, v196
  v_lshl_add_u32 v197, v194, 1, v195
  s_lshl_b32 s62, s61, 2
  v_add_u32 v197, s62, v197
  v_bfe_u32 v198, v176, 3, 1
  v_lshlrev_b32 v198, 2, v198
  v_xor_b32 v197, v197, v198
  v_lshlrev_b32 v197, 4, v197
  v_lshl_add_u32 v180, v192, 7, v197
  v_add_u32 v180, v180, v196
  v_add_u32 v180, 0x2000, v180
  v_add_u32 v181, 0x10000, v180
  v_add_u32 v182, 0x20000, v180
  s_lshl_b32 s62, s32, 6
  s_lshl_b32 s63, s60, 5
  s_add_u32 s62, s62, s63
  v_and_b32 v192, 31, v176
  v_add_u32 v192, s62, v192
  v_lshlrev_b32 v183, 10, v192
  s_lshl_b32 s62, s33, 7
  s_lshl_b32 s63, s61, 6
  s_add_u32 s62, s62, s63
  v_lshrrev_b32 v192, 5, v176
  v_lshlrev_b32 v192, 3, v192
  v_add_u32 v192, s62, v192
  v_add_u32 v183, v183, v192
  buffer_load_dwordx2 v[184:185], v183, s[24:27], 0 offen offset:0
  buffer_load_dwordx2 v[186:187], v183, s[24:27], 0 offen offset:16
  buffer_load_dwordx2 v[188:189], v183, s[24:27], 0 offen offset:32
  buffer_load_dwordx2 v[190:191], v183, s[24:27], 0 offen offset:48
  s_waitcnt lgkmcnt(0)
  s_mov_b32 s30, 0x200000
  s_mov_b32 s31, 0x20000
  v_and_b32 v28, 0x1f0, v1
  v_add_u32 v28, s4, v28
  ds_read_b128 v[20:23], v28 offset:0
  s_waitcnt lgkmcnt(0)
  v_add_f32 v20, v20, v21
  v_add_f32 v22, v22, v23
  v_add_f32 v20, v20, v22
  v_cvt_pk_bf16_f32 v21, v20, v20
  v_lshlrev_b32 v21, 16, v21
  v_sub_f32 v21, v20, v21
  v_cvt_pk_bf16_f32 v46, v20, v21
  s_nop 1
  v_mfma_f32_32x32x8_bf16 v[64:79], v[46:47], v[44:45], v[64:79]
  buffer_load_dword v19, off, s[40:43], s88 sc1
  s_nop 10
  v_mul_f32 v64, v64, v5
  v_mul_f32 v65, v65, v5
  v_mul_f32 v66, v66, v5
  v_mul_f32 v67, v67, v5
  v_min_f32 v28, 0, v64
  v_min_f32 v29, 0, v65
  v_min_f32 v30, 0, v66
  v_min_f32 v31, 0, v67
  v_mul_f32 v28, 0x3fb8aa3b, v28
  v_mul_f32 v29, 0x3fb8aa3b, v29
  v_mul_f32 v30, 0x3fb8aa3b, v30
  v_mul_f32 v31, 0x3fb8aa3b, v31
  v_exp_f32 v28, v28
  v_exp_f32 v29, v29
  v_exp_f32 v30, v30
  s_barrier
  ds_read_b128 v[192:195], v177 offset:0
  ds_read_b64_tr_b16 v[196:197], v180 offset:0
  ds_read_b64_tr_b16 v[198:199], v180 offset:1024
  ds_read_b128 v[200:203], v177 offset:1024
  ds_read_b64_tr_b16 v[204:205], v180 offset:2048
  ds_read_b64_tr_b16 v[206:207], v180 offset:3072
  ds_read_b128 v[208:211], v177 offset:2048
  ds_read_b64_tr_b16 v[212:213], v180 offset:4096
  ds_read_b64_tr_b16 v[214:215], v180 offset:5120
  s_waitcnt lgkmcnt(6)
  v_mfma_f32_32x32x16_bf16 v[224:239], v[196:199], v[192:195], 0
  v_exp_f32 v31, v31
  v_max_f32 v64, 0, v64
  v_max_f32 v65, 0, v65
  ds_read_b128 v[216:219], v177 offset:3072
  ds_read_b64_tr_b16 v[220:221], v180 offset:6144
  ds_read_b64_tr_b16 v[222:223], v180 offset:7168
  s_waitcnt lgkmcnt(6)
  v_mfma_f32_32x32x16_bf16 v[224:239], v[204:207], v[200:203], v[224:239]
  v_max_f32 v66, 0, v66
  v_max_f32 v67, 0, v67
  v_add_f32 v28, 0x358637bd, v28
  s_waitcnt vmcnt(5)
  s_barrier
  v_add_u32 v15, s54, v1
  v_mov_b32 v16, 0x7ffffff0
  v_cmp_ne_u32 vcc, 0, v15
  s_nop 1
  v_cndmask_b32 v15, v15, v16
  v_mov_b32 v16, 1
  buffer_atomic_add v16, v15, s[40:43], s39 offen
  ds_read_b128 v[192:195], v177 offset:16384
  ds_read_b64_tr_b16 v[196:197], v180 offset:16384
  ds_read_b64_tr_b16 v[198:199], v180 offset:17408
  s_waitcnt lgkmcnt(6)
  v_mfma_f32_32x32x16_bf16 v[224:239], v[212:215], v[208:211], v[224:239]
  v_add_f32 v29, 0x358637bd, v29
  v_add_f32 v30, 0x358637bd, v30
  v_add_f32 v31, 0x358637bd, v31
  ds_read_b128 v[200:203], v177 offset:17408
  ds_read_b64_tr_b16 v[204:205], v180 offset:18432
  ds_read_b64_tr_b16 v[206:207], v180 offset:19456
  s_waitcnt lgkmcnt(6)
  v_mfma_f32_32x32x16_bf16 v[224:239], v[220:223], v[216:219], v[224:239]
  v_add_f32 v64, v64, v28
  v_add_f32 v65, v65, v29
  v_add_f32 v66, v66, v30
  ds_read_b128 v[208:211], v177 offset:18432
  ds_read_b64_tr_b16 v[212:213], v180 offset:20480
  ds_read_b64_tr_b16 v[214:215], v180 offset:21504
  s_waitcnt lgkmcnt(6)
  v_mfma_f32_32x32x16_bf16 v[224:239], v[196:199], v[192:195], v[224:239]
  v_add_f32 v67, v67, v31
  v_cvt_pk_bf16_f32 v64, v64, v65
  v_cvt_pk_bf16_f32 v65, v66, v67
  ds_read_b128 v[216:219], v177 offset:19456
  ds_read_b64_tr_b16 v[220:221], v180 offset:22528
  ds_read_b64_tr_b16 v[222:223], v180 offset:23552
  s_waitcnt lgkmcnt(6)
  v_mfma_f32_32x32x16_bf16 v[224:239], v[204:207], v[200:203], v[224:239]
  v_mul_f32 v68, v68, v5
  v_mul_f32 v69, v69, v5
  v_mul_f32 v70, v70, v5
  s_barrier
  ds_read_b128 v[192:195], v177 offset:32768
  ds_read_b64_tr_b16 v[196:197], v180 offset:32768
  ds_read_b64_tr_b16 v[198:199], v180 offset:33792
  s_waitcnt lgkmcnt(6)
  v_mfma_f32_32x32x16_bf16 v[224:239], v[212:215], v[208:211], v[224:239]
  v_mul_f32 v71, v71, v5
  v_min_f32 v28, 0, v68
  v_min_f32 v29, 0, v69
  ds_read_b128 v[200:203], v177 offset:33792
  ds_read_b64_tr_b16 v[204:205], v180 offset:34816
  ds_read_b64_tr_b16 v[206:207], v180 offset:35840
  s_waitcnt lgkmcnt(6)
  v_mfma_f32_32x32x16_bf16 v[224:239], v[220:223], v[216:219], v[224:239]
  v_min_f32 v30, 0, v70
  v_min_f32 v31, 0, v71
  v_mul_f32 v28, 0x3fb8aa3b, v28
  ds_read_b128 v[208:211], v177 offset:34816
  ds_read_b64_tr_b16 v[212:213], v180 offset:36864
  ds_read_b64_tr_b16 v[214:215], v180 offset:37888
  s_waitcnt lgkmcnt(6)
  v_mfma_f32_32x32x16_bf16 v[224:239], v[196:199], v[192:195], v[224:239]
  v_mul_f32 v29, 0x3fb8aa3b, v29
  v_mul_f32 v30, 0x3fb8aa3b, v30
  v_mul_f32 v31, 0x3fb8aa3b, v31
  ds_read_b128 v[216:219], v177 offset:35840
  ds_read_b64_tr_b16 v[220:221], v180 offset:38912
  ds_read_b64_tr_b16 v[222:223], v180 offset:39936
  s_waitcnt lgkmcnt(6)
  v_mfma_f32_32x32x16_bf16 v[224:239], v[204:207], v[200:203], v[224:239]
  v_exp_f32 v28, v28
  v_exp_f32 v29, v29
  v_exp_f32 v30, v30
  s_barrier
  ds_read_b128 v[192:195], v177 offset:49152
  ds_read_b64_tr_b16 v[196:197], v180 offset:49152
  ds_read_b64_tr_b16 v[198:199], v180 offset:50176
  s_waitcnt lgkmcnt(6)
  v_mfma_f32_32x32x16_bf16 v[224:239], v[212:215], v[208:211], v[224:239]
  v_exp_f32 v31, v31
  v_max_f32 v68, 0, v68
  v_max_f32 v69, 0, v69
  ds_read_b128 v[200:203], v177 offset:50176
  ds_read_b64_tr_b16 v[204:205], v180 offset:51200
  ds_read_b64_tr_b16 v[206:207], v180 offset:52224
  s_waitcnt lgkmcnt(6)
  v_mfma_f32_32x32x16_bf16 v[224:239], v[220:223], v[216:219], v[224:239]
  v_max_f32 v70, 0, v70
  v_max_f32 v71, 0, v71
  v_add_f32 v28, 0x358637bd, v28
  ds_read_b128 v[208:211], v177 offset:51200
  ds_read_b64_tr_b16 v[212:213], v180 offset:53248
  ds_read_b64_tr_b16 v[214:215], v180 offset:54272
  s_waitcnt lgkmcnt(6)
  v_mfma_f32_32x32x16_bf16 v[224:239], v[196:199], v[192:195], v[224:239]
  v_add_f32 v29, 0x358637bd, v29
  v_add_f32 v30, 0x358637bd, v30
  v_add_f32 v31, 0x358637bd, v31
  ds_read_b128 v[216:219], v177 offset:52224
  ds_read_b64_tr_b16 v[220:221], v180 offset:55296
  ds_read_b64_tr_b16 v[222:223], v180 offset:56320
  s_waitcnt lgkmcnt(6)
  v_mfma_f32_32x32x16_bf16 v[224:239], v[204:207], v[200:203], v[224:239]
  v_add_f32 v68, v68, v28
  v_add_f32 v69, v69, v29
  v_add_f32 v70, v70, v30
  s_barrier
  ds_read_b128 v[192:195], v178 offset:0
  ds_read_b64_tr_b16 v[196:197], v181 offset:0
  ds_read_b64_tr_b16 v[198:199], v181 offset:1024
  s_waitcnt lgkmcnt(6)
  v_mfma_f32_32x32x16_bf16 v[224:239], v[212:215], v[208:211], v[224:239]
  v_add_f32 v71, v71, v31
  v_cvt_pk_bf16_f32 v66, v68, v69
  v_cvt_pk_bf16_f32 v67, v70, v71
  ds_read_b128 v[200:203], v178 offset:1024
  ds_read_b64_tr_b16 v[204:205], v181 offset:2048
  ds_read_b64_tr_b16 v[206:207], v181 offset:3072
  s_waitcnt lgkmcnt(6)
  v_mfma_f32_32x32x16_bf16 v[224:239], v[220:223], v[216:219], v[224:239]
  s_waitcnt vmcnt(1)
  v_readfirstlane_b32 s62, v19
  s_nop 1
  s_cmp_ge_u32 s62, 16
  s_cbranch_scc1 L_dcE_ok
  s_mov_b32 s82, 0
L_dcE_spin:
  s_sleep 16
  buffer_load_dword v19, off, s[40:43], s88 sc1
  s_waitcnt vmcnt(0)
  v_readfirstlane_b32 s62, v19
  s_add_u32 s82, s82, 1
  s_cmp_ge_u32 s82, 0x100000
  s_cbranch_scc1 L_dcE_ok
  s_cmp_ge_u32 s62, 16
  s_cbranch_scc0 L_dcE_spin
L_dcE_ok:
  s_nop 1
  v_lshrrev_b32 v12, 2, v1
  v_xor_b32 v13, 64, v12
  buffer_load_dword v80, v12, s[40:43], s85 offen offset:0 sc1
  buffer_load_dword v81, v12, s[40:43], s85 offen offset:256 sc1
  buffer_load_dword v82, v12, s[40:43], s85 offen offset:512 sc1
  buffer_load_dword v83, v12, s[40:43], s85 offen offset:768 sc1
  buffer_load_dword v84, v12, s[40:43], s85 offen offset:1024 sc1
  buffer_load_dword v85, v12, s[40:43], s85 offen offset:1280 sc1
  buffer_load_dword v86, v12, s[40:43], s85 offen offset:1536 sc1
  buffer_load_dword v87, v12, s[40:43], s85 offen offset:1792 sc1
  buffer_load_dword v88, v13, s[40:43], s85 offen offset:2048 sc1
  buffer_load_dword v89, v13, s[40:43], s85 offen offset:2304 sc1
  buffer_load_dword v90, v13, s[40:43], s85 offen offset:2560 sc1
  buffer_load_dword v91, v13, s[40:43], s85 offen offset:2816 sc1
  buffer_load_dword v92, v13, s[40:43], s85 offen offset:3072 sc1
  buffer_load_dword v93, v13, s[40:43], s85 offen offset:3328 sc1
  buffer_load_dword v94, v13, s[40:43], s85 offen offset:3584 sc1
  buffer_load_dword v95, v13, s[40:43], s85 offen offset:3840 sc1
  v_mul_f32 v72, v72, v5
  v_mul_f32 v73, v73, v5
  v_mul_f32 v74, v74, v5
  ds_read_b128 v[208:211], v178 offset:2048
  ds_read_b64_tr_b16 v[212:213], v181 offset:4096
  ds_read_b64_tr_b16 v[214:215], v181 offset:5120
  s_waitcnt lgkmcnt(6)
  v_mfma_f32_32x32x16_bf16 v[224:239], v[196:199], v[192:195], v[224:239]
  v_mul_f32 v75, v75, v5
  v_min_f32 v28, 0, v72
  v_min_f32 v29, 0, v73
  ds_read_b128 v[216:219], v178 offset:3072
  ds_read_b64_tr_b16 v[220:221], v181 offset:6144
  ds_read_b64_tr_b16 v[222:223], v181 offset:7168
  s_waitcnt lgkmcnt(6)
  v_mfma_f32_32x32x16_bf16 v[224:239], v[204:207], v[200:203], v[224:239]
  v_min_f32 v30, 0, v74
  v_min_f32 v31, 0, v75
  v_mul_f32 v28, 0x3fb8aa3b, v28
  s_barrier
  ds_read_b128 v[192:195], v178 offset:16384
  ds_read_b64_tr_b16 v[196:197], v181 offset:16384
  ds_read_b64_tr_b16 v[198:199], v181 offset:17408
  s_waitcnt lgkmcnt(6)
  v_mfma_f32_32x32x16_bf16 v[224:239], v[212:215], v[208:211], v[224:239]
  v_mul_f32 v29, 0x3fb8aa3b, v29
  v_mul_f32 v30, 0x3fb8aa3b, v30
  v_mul_f32 v31, 0x3fb8aa3b, v31
  ds_read_b128 v[200:203], v178 offset:17408
  ds_read_b64_tr_b16 v[204:205], v181 offset:18432
  ds_read_b64_tr_b16 v[206:207], v181 offset:19456
  s_waitcnt lgkmcnt(6)
  v_mfma_f32_32x32x16_bf16 v[224:239], v[220:223], v[216:219], v[224:239]
  v_exp_f32 v28, v28
  v_exp_f32 v29, v29
  v_exp_f32 v30, v30
  ds_read_b128 v[208:211], v178 offset:18432
  ds_read_b64_tr_b16 v[212:213], v181 offset:20480
  ds_read_b64_tr_b16 v[214:215], v181 offset:21504
  s_waitcnt lgkmcnt(6)
  v_mfma_f32_32x32x16_bf16 v[224:239], v[196:199], v[192:195], v[224:239]
  v_exp_f32 v31, v31
  v_max_f32 v72, 0, v72
  v_max_f32 v73, 0, v73
  ds_read_b128 v[216:219], v178 offset:19456
  ds_read_b64_tr_b16 v[220:221], v181 offset:22528
  ds_read_b64_tr_b16 v[222:223], v181 offset:23552
  s_waitcnt lgkmcnt(6)
  v_mfma_f32_32x32x16_bf16 v[224:239], v[204:207], v[200:203], v[224:239]
  v_max_f32 v74, 0, v74
  v_max_f32 v75, 0, v75
  v_add_f32 v28, 0x358637bd, v28
  v_add_f32 v29, 0x358637bd, v29
  v_add_f32 v30, 0x358637bd, v30
  v_add_f32 v31, 0x358637bd, v31
  v_add_f32 v72, v72, v28
  v_add_f32 v73, v73, v29
  v_add_f32 v74, v74, v30
  v_add_f32 v75, v75, v31
  v_cvt_pk_bf16_f32 v68, v72, v73
  v_cvt_pk_bf16_f32 v69, v74, v75
  v_mul_f32 v76, v76, v5
  v_mul_f32 v77, v77, v5
  v_mul_f32 v78, v78, v5
  v_mul_f32 v79, v79, v5
  v_min_f32 v28, 0, v76
  v_min_f32 v29, 0, v77
  v_min_f32 v30, 0, v78
  v_min_f32 v31, 0, v79
  v_mul_f32 v28, 0x3fb8aa3b, v28
  v_mul_f32 v29, 0x3fb8aa3b, v29
  v_mul_f32 v30, 0x3fb8aa3b, v30
  v_mul_f32 v31, 0x3fb8aa3b, v31
  v_exp_f32 v28, v28
  v_exp_f32 v29, v29
  v_exp_f32 v30, v30
  v_exp_f32 v31, v31
  v_max_f32 v76, 0, v76
  v_max_f32 v77, 0, v77
  v_max_f32 v78, 0, v78
  v_max_f32 v79, 0, v79
  v_add_f32 v28, 0x358637bd, v28
  v_add_f32 v29, 0x358637bd, v29
  v_add_f32 v30, 0x358637bd, v30
  v_add_f32 v31, 0x358637bd, v31
  v_add_f32 v76, v76, v28
  v_add_f32 v77, v77, v29
  v_add_f32 v78, v78, v30
  v_add_f32 v79, v79, v31
  v_cvt_pk_bf16_f32 v70, v76, v77
  v_cvt_pk_bf16_f32 v71, v78, v79
  s_waitcnt vmcnt(14)
  v_cvt_pk_bf16_f32 v80, v80, v81
  s_waitcnt vmcnt(12)
  v_cvt_pk_bf16_f32 v81, v82, v83
  s_waitcnt vmcnt(10)
  v_cvt_pk_bf16_f32 v82, v84, v85
  s_waitcnt vmcnt(8)
  v_cvt_pk_bf16_f32 v83, v86, v87
  s_waitcnt vmcnt(6)
  v_cvt_pk_bf16_f32 v84, v88, v89
  s_waitcnt vmcnt(4)
  v_cvt_pk_bf16_f32 v85, v90, v91
  s_waitcnt vmcnt(2)
  v_cvt_pk_bf16_f32 v86, v92, v93
  s_waitcnt vmcnt(0)
  v_cvt_pk_bf16_f32 v87, v94, v95
  v_mfma_f32_32x32x16_bf16 v[128:143], v[80:83], v[64:67], 0
  s_nop 0
  v_mfma_f32_32x32x16_bf16 v[144:159], v[84:87], v[68:71], 0
  s_nop 9
  v_add_f32 v160, 0x358637bd, v136
  s_nop 0
  v_add_f32 v161, 0x358637bd, v152
  v_rcp_f32 v160, v160
  v_rcp_f32 v161, v161
  v_mul_f32 v128, v128, v160
  v_mul_f32 v129, v129, v160
  v_mul_f32 v130, v130, v160
  v_mul_f32 v131, v131, v160
  v_mul_f32 v132, v132, v160
  v_mul_f32 v133, v133, v160
  v_mul_f32 v134, v134, v160
  v_mul_f32 v135, v135, v160
  v_cvt_pk_bf16_f32 v164, v128, v129
  v_cvt_pk_bf16_f32 v165, v130, v131
  v_cvt_pk_bf16_f32 v166, v132, v133
  v_cvt_pk_bf16_f32 v167, v134, v135
  s_add_u32 s62, s76, 0
  buffer_store_dwordx4 v[164:167], v1, s[40:43], s62 offen sc1
  v_mul_f32 v144, v144, v161
  v_mul_f32 v145, v145, v161
  v_mul_f32 v146, v146, v161
  v_mul_f32 v147, v147, v161
  v_mul_f32 v148, v148, v161
  v_mul_f32 v149, v149, v161
  v_mul_f32 v150, v150, v161
  v_mul_f32 v151, v151, v161
  v_cvt_pk_bf16_f32 v168, v144, v145
  v_cvt_pk_bf16_f32 v169, v146, v147
  v_cvt_pk_bf16_f32 v170, v148, v149
  v_cvt_pk_bf16_f32 v171, v150, v151
  s_add_u32 s62, s76, 1024
  buffer_store_dwordx4 v[168:171], v1, s[40:43], s62 offen sc1
  s_barrier
  ds_read_b128 v[192:195], v178 offset:32768
  ds_read_b64_tr_b16 v[196:197], v181 offset:32768
  ds_read_b64_tr_b16 v[198:199], v181 offset:33792
  s_waitcnt lgkmcnt(6)
  v_mfma_f32_32x32x16_bf16 v[224:239], v[212:215], v[208:211], v[224:239]
  ds_read_b128 v[200:203], v178 offset:33792
  ds_read_b64_tr_b16 v[204:205], v181 offset:34816
  ds_read_b64_tr_b16 v[206:207], v181 offset:35840
  s_waitcnt lgkmcnt(6)
  v_mfma_f32_32x32x16_bf16 v[224:239], v[220:223], v[216:219], v[224:239]
  ds_read_b128 v[208:211], v178 offset:34816
  ds_read_b64_tr_b16 v[212:213], v181 offset:36864
  ds_read_b64_tr_b16 v[214:215], v181 offset:37888
  s_waitcnt lgkmcnt(6)
  v_mfma_f32_32x32x16_bf16 v[224:239], v[196:199], v[192:195], v[224:239]
  ds_read_b128 v[216:219], v178 offset:35840
  ds_read_b64_tr_b16 v[220:221], v181 offset:38912
  ds_read_b64_tr_b16 v[222:223], v181 offset:39936
  s_waitcnt lgkmcnt(6)
  v_mfma_f32_32x32x16_bf16 v[224:239], v[204:207], v[200:203], v[224:239]
  s_barrier
  ds_read_b128 v[192:195], v178 offset:49152
  ds_read_b64_tr_b16 v[196:197], v181 offset:49152
  ds_read_b64_tr_b16 v[198:199], v181 offset:50176
  s_waitcnt lgkmcnt(6)
  v_mfma_f32_32x32x16_bf16 v[224:239], v[212:215], v[208:211], v[224:239]
  ds_read_b128 v[200:203], v178 offset:50176
  ds_read_b64_tr_b16 v[204:205], v181 offset:51200
  ds_read_b64_tr_b16 v[206:207], v181 offset:52224
  s_waitcnt lgkmcnt(6)
  v_mfma_f32_32x32x16_bf16 v[224:239], v[220:223], v[216:219], v[224:239]
  ds_read_b128 v[208:211], v178 offset:51200
  ds_read_b64_tr_b16 v[212:213], v181 offset:53248
  ds_read_b64_tr_b16 v[214:215], v181 offset:54272
  s_waitcnt lgkmcnt(6)
  v_mfma_f32_32x32x16_bf16 v[224:239], v[196:199], v[192:195], v[224:239]
  ds_read_b128 v[216:219], v178 offset:52224
  ds_read_b64_tr_b16 v[220:221], v181 offset:55296
  ds_read_b64_tr_b16 v[222:223], v181 offset:56320
  s_waitcnt lgkmcnt(6)
  v_mfma_f32_32x32x16_bf16 v[224:239], v[204:207], v[200:203], v[224:239]
  s_waitcnt vmcnt(0)
  s_barrier
  s_memtime s[46:47]
  v_add_u32 v15, s54, v1
  v_mov_b32 v16, 0x7ffffff0
  v_cmp_ne_u32 vcc, 0, v15
  s_nop 1
  v_cndmask_b32 v15, v15, v16
  v_mov_b32 v16, 1
  buffer_atomic_add v16, v15, s[40:43], s86 offen
  ds_read_b128 v[192:195], v179 offset:0
  ds_read_b64_tr_b16 v[196:197], v182 offset:0
  ds_read_b64_tr_b16 v[198:199], v182 offset:1024
  s_waitcnt lgkmcnt(6)
  v_mfma_f32_32x32x16_bf16 v[224:239], v[212:215], v[208:211], v[224:239]
  ds_read_b128 v[200:203], v179 offset:1024
  ds_read_b64_tr_b16 v[204:205], v182 offset:2048
  ds_read_b64_tr_b16 v[206:207], v182 offset:3072
  s_waitcnt lgkmcnt(6)
  v_mfma_f32_32x32x16_bf16 v[224:239], v[220:223], v[216:219], v[224:239]
  ds_read_b128 v[208:211], v179 offset:2048
  ds_read_b64_tr_b16 v[212:213], v182 offset:4096
  ds_read_b64_tr_b16 v[214:215], v182 offset:5120
  s_waitcnt lgkmcnt(6)
  v_mfma_f32_32x32x16_bf16 v[224:239], v[196:199], v[192:195], v[224:239]
  ds_read_b128 v[216:219], v179 offset:3072
  ds_read_b64_tr_b16 v[220:221], v182 offset:6144
  ds_read_b64_tr_b16 v[222:223], v182 offset:7168
  s_waitcnt lgkmcnt(6)
  v_mfma_f32_32x32x16_bf16 v[224:239], v[204:207], v[200:203], v[224:239]
  s_barrier
  ds_read_b128 v[192:195], v179 offset:16384
  ds_read_b64_tr_b16 v[196:197], v182 offset:16384
  ds_read_b64_tr_b16 v[198:199], v182 offset:17408
  s_waitcnt lgkmcnt(6)
  v_mfma_f32_32x32x16_bf16 v[224:239], v[212:215], v[208:211], v[224:239]
  ds_read_b128 v[200:203], v179 offset:17408
  ds_read_b64_tr_b16 v[204:205], v182 offset:18432
  ds_read_b64_tr_b16 v[206:207], v182 offset:19456
  s_waitcnt lgkmcnt(6)
  v_mfma_f32_32x32x16_bf16 v[224:239], v[220:223], v[216:219], v[224:239]
  ds_read_b128 v[208:211], v179 offset:18432
  ds_read_b64_tr_b16 v[212:213], v182 offset:20480
  ds_read_b64_tr_b16 v[214:215], v182 offset:21504
  s_waitcnt lgkmcnt(6)
  v_mfma_f32_32x32x16_bf16 v[224:239], v[196:199], v[192:195], v[224:239]
  ds_read_b128 v[216:219], v179 offset:19456
  ds_read_b64_tr_b16 v[220:221], v182 offset:22528
  ds_read_b64_tr_b16 v[222:223], v182 offset:23552
  s_waitcnt lgkmcnt(6)
  v_mfma_f32_32x32x16_bf16 v[224:239], v[204:207], v[200:203], v[224:239]
  s_barrier
  ds_read_b128 v[192:195], v177 offset:0
  ds_read_b64_tr_b16 v[196:197], v180 offset:0
  ds_read_b64_tr_b16 v[198:199], v180 offset:1024
  s_waitcnt lgkmcnt(6)
  v_mfma_f32_32x32x16_bf16 v[224:239], v[212:215], v[208:211], v[224:239]
  ds_read_b128 v[200:203], v177 offset:1024
  ds_read_b64_tr_b16 v[204:205], v180 offset:2048
  ds_read_b64_tr_b16 v[206:207], v180 offset:3072
  s_waitcnt lgkmcnt(6)
  v_mfma_f32_32x32x16_bf16 v[224:239], v[220:223], v[216:219], v[224:239]
  ds_read_b128 v[208:211], v177 offset:2048
  ds_read_b64_tr_b16 v[212:213], v180 offset:4096
  ds_read_b64_tr_b16 v[214:215], v180 offset:5120
  s_waitcnt lgkmcnt(6)
  v_mfma_f32_32x32x16_bf16 v[224:239], v[196:199], v[192:195], v[224:239]
  ds_read_b128 v[216:219], v177 offset:3072
  ds_read_b64_tr_b16 v[220:221], v180 offset:6144
  ds_read_b64_tr_b16 v[222:223], v180 offset:7168
  s_waitcnt lgkmcnt(6)
  v_mfma_f32_32x32x16_bf16 v[224:239], v[204:207], v[200:203], v[224:239]
  s_barrier
  ds_read_b128 v[192:195], v177 offset:16384
  ds_read_b64_tr_b16 v[196:197], v180 offset:16384
  ds_read_b64_tr_b16 v[198:199], v180 offset:17408
  s_waitcnt lgkmcnt(6)
  v_mfma_f32_32x32x16_bf16 v[224:239], v[212:215], v[208:211], v[224:239]
  ds_read_b128 v[200:203], v177 offset:17408
  ds_read_b64_tr_b16 v[204:205], v180 offset:18432
  ds_read_b64_tr_b16 v[206:207], v180 offset:19456
  s_waitcnt lgkmcnt(6)
  v_mfma_f32_32x32x16_bf16 v[224:239], v[220:223], v[216:219], v[224:239]
  ds_read_b128 v[208:211], v177 offset:18432
  ds_read_b64_tr_b16 v[212:213], v180 offset:20480
  ds_read_b64_tr_b16 v[214:215], v180 offset:21504
  s_waitcnt lgkmcnt(6)
  v_mfma_f32_32x32x16_bf16 v[224:239], v[196:199], v[192:195], v[224:239]
  ds_read_b128 v[216:219], v177 offset:19456
  ds_read_b64_tr_b16 v[220:221], v180 offset:22528
  ds_read_b64_tr_b16 v[222:223], v180 offset:23552
  s_waitcnt lgkmcnt(6)
  v_mfma_f32_32x32x16_bf16 v[224:239], v[204:207], v[200:203], v[224:239]
  s_barrier
  ds_read_b128 v[192:195], v177 offset:32768
  ds_read_b64_tr_b16 v[196:197], v180 offset:32768
  ds_read_b64_tr_b16 v[198:199], v180 offset:33792
  s_waitcnt lgkmcnt(6)
  v_mfma_f32_32x32x16_bf16 v[224:239], v[212:215], v[208:211], v[224:239]
  ds_read_b128 v[200:203], v177 offset:33792
  ds_read_b64_tr_b16 v[204:205], v180 offset:34816
  ds_read_b64_tr_b16 v[206:207], v180 offset:35840
  s_waitcnt lgkmcnt(6)
  v_mfma_f32_32x32x16_bf16 v[224:239], v[220:223], v[216:219], v[224:239]
  ds_read_b128 v[208:211], v177 offset:34816
  ds_read_b64_tr_b16 v[212:213], v180 offset:36864
  ds_read_b64_tr_b16 v[214:215], v180 offset:37888
  s_waitcnt lgkmcnt(6)
  v_mfma_f32_32x32x16_bf16 v[224:239], v[196:199], v[192:195], v[224:239]
  ds_read_b128 v[216:219], v177 offset:35840
  ds_read_b64_tr_b16 v[220:221], v180 offset:38912
  ds_read_b64_tr_b16 v[222:223], v180 offset:39936
  s_waitcnt lgkmcnt(6)
  v_mfma_f32_32x32x16_bf16 v[224:239], v[204:207], v[200:203], v[224:239]
  s_barrier
  ds_read_b128 v[192:195], v177 offset:49152
  ds_read_b64_tr_b16 v[196:197], v180 offset:49152
  ds_read_b64_tr_b16 v[198:199], v180 offset:50176
  s_waitcnt lgkmcnt(6)
  v_mfma_f32_32x32x16_bf16 v[224:239], v[212:215], v[208:211], v[224:239]
  ds_read_b128 v[200:203], v177 offset:50176
  ds_read_b64_tr_b16 v[204:205], v180 offset:51200
  ds_read_b64_tr_b16 v[206:207], v180 offset:52224
  s_waitcnt lgkmcnt(6)
  v_mfma_f32_32x32x16_bf16 v[224:239], v[220:223], v[216:219], v[224:239]
  ds_read_b128 v[208:211], v177 offset:51200
  ds_read_b64_tr_b16 v[212:213], v180 offset:53248
  ds_read_b64_tr_b16 v[214:215], v180 offset:54272
  s_waitcnt lgkmcnt(6)
  v_mfma_f32_32x32x16_bf16 v[224:239], v[196:199], v[192:195], v[224:239]
  ds_read_b128 v[216:219], v177 offset:52224
  ds_read_b64_tr_b16 v[220:221], v180 offset:55296
  ds_read_b64_tr_b16 v[222:223], v180 offset:56320
  s_waitcnt lgkmcnt(6)
  v_mfma_f32_32x32x16_bf16 v[224:239], v[204:207], v[200:203], v[224:239]
  s_barrier
  ds_read_b128 v[192:195], v178 offset:0
  ds_read_b64_tr_b16 v[196:197], v181 offset:0
  ds_read_b64_tr_b16 v[198:199], v181 offset:1024
  s_waitcnt lgkmcnt(6)
  v_mfma_f32_32x32x16_bf16 v[224:239], v[212:215], v[208:211], v[224:239]
  ds_read_b128 v[200:203], v178 offset:1024
  ds_read_b64_tr_b16 v[204:205], v181 offset:2048
  ds_read_b64_tr_b16 v[206:207], v181 offset:3072
  s_waitcnt lgkmcnt(6)
  v_mfma_f32_32x32x16_bf16 v[224:239], v[220:223], v[216:219], v[224:239]
  ds_read_b128 v[208:211], v178 offset:2048
  ds_read_b64_tr_b16 v[212:213], v181 offset:4096
  ds_read_b64_tr_b16 v[214:215], v181 offset:5120
  s_waitcnt lgkmcnt(6)
  v_mfma_f32_32x32x16_bf16 v[224:239], v[196:199], v[192:195], v[224:239]
  ds_read_b128 v[216:219], v178 offset:3072
  ds_read_b64_tr_b16 v[220:221], v181 offset:6144
  ds_read_b64_tr_b16 v[222:223], v181 offset:7168
  s_waitcnt lgkmcnt(6)
  v_mfma_f32_32x32x16_bf16 v[224:239], v[204:207], v[200:203], v[224:239]
  s_barrier
  ds_read_b128 v[192:195], v178 offset:16384
  ds_read_b64_tr_b16 v[196:197], v181 offset:16384
  ds_read_b64_tr_b16 v[198:199], v181 offset:17408
  s_waitcnt lgkmcnt(6)
  v_mfma_f32_32x32x16_bf16 v[224:239], v[212:215], v[208:211], v[224:239]
  ds_read_b128 v[200:203], v178 offset:17408
  ds_read_b64_tr_b16 v[204:205], v181 offset:18432
  ds_read_b64_tr_b16 v[206:207], v181 offset:19456
  s_waitcnt lgkmcnt(6)
  v_mfma_f32_32x32x16_bf16 v[224:239], v[220:223], v[216:219], v[224:239]
  ds_read_b128 v[208:211], v178 offset:18432
  ds_read_b64_tr_b16 v[212:213], v181 offset:20480
  ds_read_b64_tr_b16 v[214:215], v181 offset:21504
  s_waitcnt lgkmcnt(6)
  v_mfma_f32_32x32x16_bf16 v[224:239], v[196:199], v[192:195], v[224:239]
  ds_read_b128 v[216:219], v178 offset:19456
  ds_read_b64_tr_b16 v[220:221], v181 offset:22528
  ds_read_b64_tr_b16 v[222:223], v181 offset:23552
  s_waitcnt lgkmcnt(6)
  v_mfma_f32_32x32x16_bf16 v[224:239], v[204:207], v[200:203], v[224:239]
  s_barrier
  s_memtime s[78:79]
  ds_read_b128 v[192:195], v178 offset:32768
  ds_read_b64_tr_b16 v[196:197], v181 offset:32768
  ds_read_b64_tr_b16 v[198:199], v181 offset:33792
  s_waitcnt lgkmcnt(6)
  v_mfma_f32_32x32x16_bf16 v[224:239], v[212:215], v[208:211], v[224:239]
  ds_read_b128 v[200:203], v178 offset:33792
  ds_read_b64_tr_b16 v[204:205], v181 offset:34816
  ds_read_b64_tr_b16 v[206:207], v181 offset:35840
  s_waitcnt lgkmcnt(6)
  v_mfma_f32_32x32x16_bf16 v[224:239], v[220:223], v[216:219], v[224:239]
  ds_read_b128 v[208:211], v178 offset:34816
  ds_read_b64_tr_b16 v[212:213], v181 offset:36864
  ds_read_b64_tr_b16 v[214:215], v181 offset:37888
  s_waitcnt lgkmcnt(6)
  v_mfma_f32_32x32x16_bf16 v[224:239], v[196:199], v[192:195], v[224:239]
  ds_read_b128 v[216:219], v178 offset:35840
  ds_read_b64_tr_b16 v[220:221], v181 offset:38912
  ds_read_b64_tr_b16 v[222:223], v181 offset:39936
  s_waitcnt lgkmcnt(6)
  v_mfma_f32_32x32x16_bf16 v[224:239], v[204:207], v[200:203], v[224:239]
  s_barrier
  ds_read_b128 v[192:195], v178 offset:49152
  ds_read_b64_tr_b16 v[196:197], v181 offset:49152
  ds_read_b64_tr_b16 v[198:199], v181 offset:50176
  s_waitcnt lgkmcnt(6)
  v_mfma_f32_32x32x16_bf16 v[224:239], v[212:215], v[208:211], v[224:239]
  ds_read_b128 v[200:203], v178 offset:50176
  ds_read_b64_tr_b16 v[204:205], v181 offset:51200
  ds_read_b64_tr_b16 v[206:207], v181 offset:52224
  s_waitcnt lgkmcnt(6)
  v_mfma_f32_32x32x16_bf16 v[224:239], v[220:223], v[216:219], v[224:239]
  ds_read_b128 v[208:211], v178 offset:51200
  ds_read_b64_tr_b16 v[212:213], v181 offset:53248
  ds_read_b64_tr_b16 v[214:215], v181 offset:54272
  s_waitcnt lgkmcnt(6)
  v_mfma_f32_32x32x16_bf16 v[224:239], v[196:199], v[192:195], v[224:239]
  ds_read_b128 v[216:219], v178 offset:52224
  ds_read_b64_tr_b16 v[220:221], v181 offset:55296
  ds_read_b64_tr_b16 v[222:223], v181 offset:56320
  s_waitcnt lgkmcnt(6)
  v_mfma_f32_32x32x16_bf16 v[224:239], v[204:207], v[200:203], v[224:239]
  s_barrier
  ds_read_b128 v[192:195], v179 offset:0
  ds_read_b64_tr_b16 v[196:197], v182 offset:0
  ds_read_b64_tr_b16 v[198:199], v182 offset:1024
  s_waitcnt lgkmcnt(6)
  v_mfma_f32_32x32x16_bf16 v[224:239], v[212:215], v[208:211], v[224:239]
  ds_read_b128 v[200:203], v179 offset:1024
  ds_read_b64_tr_b16 v[204:205], v182 offset:2048
  ds_read_b64_tr_b16 v[206:207], v182 offset:3072
  s_waitcnt lgkmcnt(6)
  v_mfma_f32_32x32x16_bf16 v[224:239], v[220:223], v[216:219], v[224:239]
  ds_read_b128 v[208:211], v179 offset:2048
  ds_read_b64_tr_b16 v[212:213], v182 offset:4096
  ds_read_b64_tr_b16 v[214:215], v182 offset:5120
  s_waitcnt lgkmcnt(6)
  v_mfma_f32_32x32x16_bf16 v[224:239], v[196:199], v[192:195], v[224:239]
  ds_read_b128 v[216:219], v179 offset:3072
  ds_read_b64_tr_b16 v[220:221], v182 offset:6144
  ds_read_b64_tr_b16 v[222:223], v182 offset:7168
  s_waitcnt lgkmcnt(6)
  v_mfma_f32_32x32x16_bf16 v[224:239], v[204:207], v[200:203], v[224:239]
  s_barrier
  ds_read_b128 v[192:195], v179 offset:16384
  ds_read_b64_tr_b16 v[196:197], v182 offset:16384
  ds_read_b64_tr_b16 v[198:199], v182 offset:17408
  s_waitcnt lgkmcnt(6)
  v_mfma_f32_32x32x16_bf16 v[224:239], v[212:215], v[208:211], v[224:239]
  ds_read_b128 v[200:203], v179 offset:17408
  ds_read_b64_tr_b16 v[204:205], v182 offset:18432
  ds_read_b64_tr_b16 v[206:207], v182 offset:19456
  s_waitcnt lgkmcnt(6)
  v_mfma_f32_32x32x16_bf16 v[224:239], v[220:223], v[216:219], v[224:239]
  ds_read_b128 v[208:211], v179 offset:18432
  ds_read_b64_tr_b16 v[212:213], v182 offset:20480
  ds_read_b64_tr_b16 v[214:215], v182 offset:21504
  s_waitcnt lgkmcnt(6)
  v_mfma_f32_32x32x16_bf16 v[224:239], v[196:199], v[192:195], v[224:239]
  ds_read_b128 v[216:219], v179 offset:19456
  ds_read_b64_tr_b16 v[220:221], v182 offset:22528
  ds_read_b64_tr_b16 v[222:223], v182 offset:23552
  s_waitcnt lgkmcnt(6)
  v_mfma_f32_32x32x16_bf16 v[224:239], v[204:207], v[200:203], v[224:239]
  s_barrier
  ds_read_b128 v[192:195], v177 offset:0
  ds_read_b64_tr_b16 v[196:197], v180 offset:0
  ds_read_b64_tr_b16 v[198:199], v180 offset:1024
  s_waitcnt lgkmcnt(6)
  v_mfma_f32_32x32x16_bf16 v[224:239], v[212:215], v[208:211], v[224:239]
  ds_read_b128 v[200:203], v177 offset:1024
  ds_read_b64_tr_b16 v[204:205], v180 offset:2048
  ds_read_b64_tr_b16 v[206:207], v180 offset:3072
  s_waitcnt lgkmcnt(6)
  v_mfma_f32_32x32x16_bf16 v[224:239], v[220:223], v[216:219], v[224:239]
  ds_read_b128 v[208:211], v177 offset:2048
  ds_read_b64_tr_b16 v[212:213], v180 offset:4096
  ds_read_b64_tr_b16 v[214:215], v180 offset:5120
  s_waitcnt lgkmcnt(6)
  v_mfma_f32_32x32x16_bf16 v[224:239], v[196:199], v[192:195], v[224:239]
  ds_read_b128 v[216:219], v177 offset:3072
  ds_read_b64_tr_b16 v[220:221], v180 offset:6144
  ds_read_b64_tr_b16 v[222:223], v180 offset:7168
  s_waitcnt lgkmcnt(6)
  v_mfma_f32_32x32x16_bf16 v[224:239], v[204:207], v[200:203], v[224:239]
  s_barrier
  ds_read_b128 v[192:195], v177 offset:16384
  ds_read_b64_tr_b16 v[196:197], v180 offset:16384
  ds_read_b64_tr_b16 v[198:199], v180 offset:17408
  s_waitcnt lgkmcnt(6)
  v_mfma_f32_32x32x16_bf16 v[224:239], v[212:215], v[208:211], v[224:239]
  ds_read_b128 v[200:203], v177 offset:17408
  ds_read_b64_tr_b16 v[204:205], v180 offset:18432
  ds_read_b64_tr_b16 v[206:207], v180 offset:19456
  s_waitcnt lgkmcnt(6)
  v_mfma_f32_32x32x16_bf16 v[224:239], v[220:223], v[216:219], v[224:239]
  ds_read_b128 v[208:211], v177 offset:18432
  ds_read_b64_tr_b16 v[212:213], v180 offset:20480
  ds_read_b64_tr_b16 v[214:215], v180 offset:21504
  s_waitcnt lgkmcnt(6)
  v_mfma_f32_32x32x16_bf16 v[224:239], v[196:199], v[192:195], v[224:239]
  ds_read_b128 v[216:219], v177 offset:19456
  ds_read_b64_tr_b16 v[220:221], v180 offset:22528
  ds_read_b64_tr_b16 v[222:223], v180 offset:23552
  s_waitcnt lgkmcnt(6)
  v_mfma_f32_32x32x16_bf16 v[224:239], v[204:207], v[200:203], v[224:239]
  s_barrier
  ds_read_b128 v[192:195], v177 offset:32768
  ds_read_b64_tr_b16 v[196:197], v180 offset:32768
  ds_read_b64_tr_b16 v[198:199], v180 offset:33792
  s_waitcnt lgkmcnt(6)
  v_mfma_f32_32x32x16_bf16 v[224:239], v[212:215], v[208:211], v[224:239]
  ds_read_b128 v[200:203], v177 offset:33792
  ds_read_b64_tr_b16 v[204:205], v180 offset:34816
  ds_read_b64_tr_b16 v[206:207], v180 offset:35840
  s_waitcnt lgkmcnt(6)
  v_mfma_f32_32x32x16_bf16 v[224:239], v[220:223], v[216:219], v[224:239]
  ds_read_b128 v[208:211], v177 offset:34816
  ds_read_b64_tr_b16 v[212:213], v180 offset:36864
  ds_read_b64_tr_b16 v[214:215], v180 offset:37888
  s_waitcnt lgkmcnt(6)
  v_mfma_f32_32x32x16_bf16 v[224:239], v[196:199], v[192:195], v[224:239]
  ds_read_b128 v[216:219], v177 offset:35840
  ds_read_b64_tr_b16 v[220:221], v180 offset:38912
  ds_read_b64_tr_b16 v[222:223], v180 offset:39936
  s_waitcnt lgkmcnt(6)
  v_mfma_f32_32x32x16_bf16 v[224:239], v[204:207], v[200:203], v[224:239]
  s_barrier
  ds_read_b128 v[192:195], v177 offset:49152
  ds_read_b64_tr_b16 v[196:197], v180 offset:49152
  ds_read_b64_tr_b16 v[198:199], v180 offset:50176
  s_waitcnt lgkmcnt(6)
  v_mfma_f32_32x32x16_bf16 v[224:239], v[212:215], v[208:211], v[224:239]
  ds_read_b128 v[200:203], v177 offset:50176
  ds_read_b64_tr_b16 v[204:205], v180 offset:51200
  ds_read_b64_tr_b16 v[206:207], v180 offset:52224
  s_waitcnt lgkmcnt(6)
  v_mfma_f32_32x32x16_bf16 v[224:239], v[220:223], v[216:219], v[224:239]
  ds_read_b128 v[208:211], v177 offset:51200
  ds_read_b64_tr_b16 v[212:213], v180 offset:53248
  ds_read_b64_tr_b16 v[214:215], v180 offset:54272
  s_waitcnt lgkmcnt(6)
  v_mfma_f32_32x32x16_bf16 v[224:239], v[196:199], v[192:195], v[224:239]
  ds_read_b128 v[216:219], v177 offset:52224
  ds_read_b64_tr_b16 v[220:221], v180 offset:55296
  ds_read_b64_tr_b16 v[222:223], v180 offset:56320
  s_waitcnt lgkmcnt(6)
  v_mfma_f32_32x32x16_bf16 v[224:239], v[204:207], v[200:203], v[224:239]
  s_barrier
  ds_read_b128 v[192:195], v178 offset:0
  ds_read_b64_tr_b16 v[196:197], v181 offset:0
  ds_read_b64_tr_b16 v[198:199], v181 offset:1024
  s_waitcnt lgkmcnt(6)
  v_mfma_f32_32x32x16_bf16 v[224:239], v[212:215], v[208:211], v[224:239]
  ds_read_b128 v[200:203], v178 offset:1024
  ds_read_b64_tr_b16 v[204:205], v181 offset:2048
  ds_read_b64_tr_b16 v[206:207], v181 offset:3072
  s_waitcnt lgkmcnt(6)
  v_mfma_f32_32x32x16_bf16 v[224:239], v[220:223], v[216:219], v[224:239]
  ds_read_b128 v[208:211], v178 offset:2048
  ds_read_b64_tr_b16 v[212:213], v181 offset:4096
  ds_read_b64_tr_b16 v[214:215], v181 offset:5120
  s_waitcnt lgkmcnt(6)
  v_mfma_f32_32x32x16_bf16 v[224:239], v[196:199], v[192:195], v[224:239]
  ds_read_b128 v[216:219], v178 offset:3072
  ds_read_b64_tr_b16 v[220:221], v181 offset:6144
  ds_read_b64_tr_b16 v[222:223], v181 offset:7168
  s_waitcnt lgkmcnt(6)
  v_mfma_f32_32x32x16_bf16 v[224:239], v[204:207], v[200:203], v[224:239]
  s_barrier
  ds_read_b128 v[192:195], v178 offset:16384
  ds_read_b64_tr_b16 v[196:197], v181 offset:16384
  ds_read_b64_tr_b16 v[198:199], v181 offset:17408
  s_waitcnt lgkmcnt(6)
  v_mfma_f32_32x32x16_bf16 v[224:239], v[212:215], v[208:211], v[224:239]
  ds_read_b128 v[200:203], v178 offset:17408
  ds_read_b64_tr_b16 v[204:205], v181 offset:18432
  ds_read_b64_tr_b16 v[206:207], v181 offset:19456
  s_waitcnt lgkmcnt(6)
  v_mfma_f32_32x32x16_bf16 v[224:239], v[220:223], v[216:219], v[224:239]
  ds_read_b128 v[208:211], v178 offset:18432
  ds_read_b64_tr_b16 v[212:213], v181 offset:20480
  ds_read_b64_tr_b16 v[214:215], v181 offset:21504
  s_waitcnt lgkmcnt(6)
  v_mfma_f32_32x32x16_bf16 v[224:239], v[196:199], v[192:195], v[224:239]
  ds_read_b128 v[216:219], v178 offset:19456
  ds_read_b64_tr_b16 v[220:221], v181 offset:22528
  ds_read_b64_tr_b16 v[222:223], v181 offset:23552
  s_waitcnt lgkmcnt(6)
  v_mfma_f32_32x32x16_bf16 v[224:239], v[204:207], v[200:203], v[224:239]
  s_barrier
  ds_read_b128 v[192:195], v178 offset:32768
  ds_read_b64_tr_b16 v[196:197], v181 offset:32768
  ds_read_b64_tr_b16 v[198:199], v181 offset:33792
  s_waitcnt lgkmcnt(6)
  v_mfma_f32_32x32x16_bf16 v[224:239], v[212:215], v[208:211], v[224:239]
  ds_read_b128 v[200:203], v178 offset:33792
  ds_read_b64_tr_b16 v[204:205], v181 offset:34816
  ds_read_b64_tr_b16 v[206:207], v181 offset:35840
  s_waitcnt lgkmcnt(6)
  v_mfma_f32_32x32x16_bf16 v[224:239], v[220:223], v[216:219], v[224:239]
  ds_read_b128 v[208:211], v178 offset:34816
  ds_read_b64_tr_b16 v[212:213], v181 offset:36864
  ds_read_b64_tr_b16 v[214:215], v181 offset:37888
  s_waitcnt lgkmcnt(6)
  v_mfma_f32_32x32x16_bf16 v[224:239], v[196:199], v[192:195], v[224:239]
  ds_read_b128 v[216:219], v178 offset:35840
  ds_read_b64_tr_b16 v[220:221], v181 offset:38912
  ds_read_b64_tr_b16 v[222:223], v181 offset:39936
  s_waitcnt lgkmcnt(6)
  v_mfma_f32_32x32x16_bf16 v[224:239], v[204:207], v[200:203], v[224:239]
  s_barrier
  ds_read_b128 v[192:195], v178 offset:49152
  ds_read_b64_tr_b16 v[196:197], v181 offset:49152
  ds_read_b64_tr_b16 v[198:199], v181 offset:50176
  s_waitcnt lgkmcnt(6)
  v_mfma_f32_32x32x16_bf16 v[224:239], v[212:215], v[208:211], v[224:239]
  ds_read_b128 v[200:203], v178 offset:50176
  ds_read_b64_tr_b16 v[204:205], v181 offset:51200
  ds_read_b64_tr_b16 v[206:207], v181 offset:52224
  s_waitcnt lgkmcnt(6)
  v_mfma_f32_32x32x16_bf16 v[224:239], v[220:223], v[216:219], v[224:239]
  ds_read_b128 v[208:211], v178 offset:51200
  ds_read_b64_tr_b16 v[212:213], v181 offset:53248
  ds_read_b64_tr_b16 v[214:215], v181 offset:54272
  s_waitcnt lgkmcnt(6)
  v_mfma_f32_32x32x16_bf16 v[224:239], v[196:199], v[192:195], v[224:239]
  ds_read_b128 v[216:219], v178 offset:52224
  ds_read_b64_tr_b16 v[220:221], v181 offset:55296
  ds_read_b64_tr_b16 v[222:223], v181 offset:56320
  s_waitcnt lgkmcnt(6)
  v_mfma_f32_32x32x16_bf16 v[224:239], v[204:207], v[200:203], v[224:239]
  s_barrier
  ds_read_b128 v[192:195], v179 offset:0
  ds_read_b64_tr_b16 v[196:197], v182 offset:0
  ds_read_b64_tr_b16 v[198:199], v182 offset:1024
  s_waitcnt lgkmcnt(6)
  v_mfma_f32_32x32x16_bf16 v[224:239], v[212:215], v[208:211], v[224:239]
  ds_read_b128 v[200:203], v179 offset:1024
  ds_read_b64_tr_b16 v[204:205], v182 offset:2048
  ds_read_b64_tr_b16 v[206:207], v182 offset:3072
  s_waitcnt lgkmcnt(6)
  v_mfma_f32_32x32x16_bf16 v[224:239], v[220:223], v[216:219], v[224:239]
  ds_read_b128 v[208:211], v179 offset:2048
  ds_read_b64_tr_b16 v[212:213], v182 offset:4096
  ds_read_b64_tr_b16 v[214:215], v182 offset:5120
  s_waitcnt lgkmcnt(6)
  v_mfma_f32_32x32x16_bf16 v[240:255], v[196:199], v[192:195], 0
  ds_read_b128 v[216:219], v179 offset:3072
  ds_read_b64_tr_b16 v[220:221], v182 offset:6144
  ds_read_b64_tr_b16 v[222:223], v182 offset:7168
  s_waitcnt lgkmcnt(6)
  v_mfma_f32_32x32x16_bf16 v[240:255], v[204:207], v[200:203], v[240:255]
  s_barrier
  ds_read_b128 v[192:195], v179 offset:16384
  ds_read_b64_tr_b16 v[196:197], v182 offset:16384
  ds_read_b64_tr_b16 v[198:199], v182 offset:17408
  s_waitcnt lgkmcnt(6)
  v_mfma_f32_32x32x16_bf16 v[240:255], v[212:215], v[208:211], v[240:255]
  ds_read_b128 v[200:203], v179 offset:17408
  ds_read_b64_tr_b16 v[204:205], v182 offset:18432
  ds_read_b64_tr_b16 v[206:207], v182 offset:19456
  s_waitcnt lgkmcnt(6)
  v_mfma_f32_32x32x16_bf16 v[240:255], v[220:223], v[216:219], v[240:255]
  ds_read_b128 v[208:211], v179 offset:18432
  ds_read_b64_tr_b16 v[212:213], v182 offset:20480
  ds_read_b64_tr_b16 v[214:215], v182 offset:21504
  s_waitcnt lgkmcnt(6)
  v_mfma_f32_32x32x16_bf16 v[240:255], v[196:199], v[192:195], v[240:255]
  ds_read_b128 v[216:219], v179 offset:19456
  ds_read_b64_tr_b16 v[220:221], v182 offset:22528
  ds_read_b64_tr_b16 v[222:223], v182 offset:23552
  s_waitcnt lgkmcnt(6)
  v_mfma_f32_32x32x16_bf16 v[240:255], v[204:207], v[200:203], v[240:255]
  s_barrier
  ds_read_b128 v[192:195], v177 offset:0
  ds_read_b64_tr_b16 v[196:197], v180 offset:0
  ds_read_b64_tr_b16 v[198:199], v180 offset:1024
  s_waitcnt lgkmcnt(6)
  v_mfma_f32_32x32x16_bf16 v[240:255], v[212:215], v[208:211], v[240:255]
  ds_read_b128 v[200:203], v177 offset:1024
  ds_read_b64_tr_b16 v[204:205], v180 offset:2048
  ds_read_b64_tr_b16 v[206:207], v180 offset:3072
  s_waitcnt lgkmcnt(6)
  v_mfma_f32_32x32x16_bf16 v[240:255], v[220:223], v[216:219], v[240:255]
  ds_read_b128 v[208:211], v177 offset:2048
  ds_read_b64_tr_b16 v[212:213], v180 offset:4096
  ds_read_b64_tr_b16 v[214:215], v180 offset:5120
  s_waitcnt lgkmcnt(6)
  v_mfma_f32_32x32x16_bf16 v[240:255], v[196:199], v[192:195], v[240:255]
  ds_read_b128 v[216:219], v177 offset:3072
  ds_read_b64_tr_b16 v[220:221], v180 offset:6144
  ds_read_b64_tr_b16 v[222:223], v180 offset:7168
  s_waitcnt lgkmcnt(6)
  v_mfma_f32_32x32x16_bf16 v[240:255], v[204:207], v[200:203], v[240:255]
  s_barrier
  ds_read_b128 v[192:195], v177 offset:16384
  ds_read_b64_tr_b16 v[196:197], v180 offset:16384
  ds_read_b64_tr_b16 v[198:199], v180 offset:17408
  s_waitcnt lgkmcnt(6)
  v_mfma_f32_32x32x16_bf16 v[240:255], v[212:215], v[208:211], v[240:255]
  ds_read_b128 v[200:203], v177 offset:17408
  ds_read_b64_tr_b16 v[204:205], v180 offset:18432
  ds_read_b64_tr_b16 v[206:207], v180 offset:19456
  s_waitcnt lgkmcnt(6)
  v_mfma_f32_32x32x16_bf16 v[240:255], v[220:223], v[216:219], v[240:255]
  ds_read_b128 v[208:211], v177 offset:18432
  ds_read_b64_tr_b16 v[212:213], v180 offset:20480
  ds_read_b64_tr_b16 v[214:215], v180 offset:21504
  s_waitcnt lgkmcnt(6)
  v_mfma_f32_32x32x16_bf16 v[240:255], v[196:199], v[192:195], v[240:255]
  ds_read_b128 v[216:219], v177 offset:19456
  ds_read_b64_tr_b16 v[220:221], v180 offset:22528
  ds_read_b64_tr_b16 v[222:223], v180 offset:23552
  s_waitcnt lgkmcnt(6)
  v_mfma_f32_32x32x16_bf16 v[240:255], v[204:207], v[200:203], v[240:255]
  s_barrier
  ds_read_b128 v[192:195], v177 offset:32768
  ds_read_b64_tr_b16 v[196:197], v180 offset:32768
  ds_read_b64_tr_b16 v[198:199], v180 offset:33792
  s_waitcnt lgkmcnt(6)
  v_mfma_f32_32x32x16_bf16 v[240:255], v[212:215], v[208:211], v[240:255]
  ds_read_b128 v[200:203], v177 offset:33792
  ds_read_b64_tr_b16 v[204:205], v180 offset:34816
  ds_read_b64_tr_b16 v[206:207], v180 offset:35840
  s_waitcnt lgkmcnt(6)
  v_mfma_f32_32x32x16_bf16 v[240:255], v[220:223], v[216:219], v[240:255]
  ds_read_b128 v[208:211], v177 offset:34816
  ds_read_b64_tr_b16 v[212:213], v180 offset:36864
  ds_read_b64_tr_b16 v[214:215], v180 offset:37888
  s_waitcnt lgkmcnt(6)
  v_mfma_f32_32x32x16_bf16 v[240:255], v[196:199], v[192:195], v[240:255]
  ds_read_b128 v[216:219], v177 offset:35840
  ds_read_b64_tr_b16 v[220:221], v180 offset:38912
  ds_read_b64_tr_b16 v[222:223], v180 offset:39936
  s_waitcnt lgkmcnt(6)
  v_mfma_f32_32x32x16_bf16 v[240:255], v[204:207], v[200:203], v[240:255]
  s_barrier
  ds_read_b128 v[192:195], v177 offset:49152
  ds_read_b64_tr_b16 v[196:197], v180 offset:49152
  ds_read_b64_tr_b16 v[198:199], v180 offset:50176
  s_waitcnt lgkmcnt(6)
  v_mfma_f32_32x32x16_bf16 v[240:255], v[212:215], v[208:211], v[240:255]
  ds_read_b128 v[200:203], v177 offset:50176
  ds_read_b64_tr_b16 v[204:205], v180 offset:51200
  ds_read_b64_tr_b16 v[206:207], v180 offset:52224
  s_waitcnt lgkmcnt(6)
  v_mfma_f32_32x32x16_bf16 v[240:255], v[220:223], v[216:219], v[240:255]
  ds_read_b128 v[208:211], v177 offset:51200
  ds_read_b64_tr_b16 v[212:213], v180 offset:53248
  ds_read_b64_tr_b16 v[214:215], v180 offset:54272
  s_waitcnt lgkmcnt(6)
  v_mfma_f32_32x32x16_bf16 v[240:255], v[196:199], v[192:195], v[240:255]
  ds_read_b128 v[216:219], v177 offset:52224
  ds_read_b64_tr_b16 v[220:221], v180 offset:55296
  ds_read_b64_tr_b16 v[222:223], v180 offset:56320
  s_waitcnt lgkmcnt(6)
  v_mfma_f32_32x32x16_bf16 v[240:255], v[204:207], v[200:203], v[240:255]
  s_barrier
  ds_read_b128 v[192:195], v178 offset:0
  ds_read_b64_tr_b16 v[196:197], v181 offset:0
  ds_read_b64_tr_b16 v[198:199], v181 offset:1024
  s_waitcnt lgkmcnt(6)
  v_mfma_f32_32x32x16_bf16 v[240:255], v[212:215], v[208:211], v[240:255]
  ds_read_b128 v[200:203], v178 offset:1024
  ds_read_b64_tr_b16 v[204:205], v181 offset:2048
  ds_read_b64_tr_b16 v[206:207], v181 offset:3072
  s_waitcnt lgkmcnt(6)
  v_mfma_f32_32x32x16_bf16 v[240:255], v[220:223], v[216:219], v[240:255]
  ds_read_b128 v[208:211], v178 offset:2048
  ds_read_b64_tr_b16 v[212:213], v181 offset:4096
  ds_read_b64_tr_b16 v[214:215], v181 offset:5120
  s_waitcnt lgkmcnt(6)
  v_mfma_f32_32x32x16_bf16 v[240:255], v[196:199], v[192:195], v[240:255]
  ds_read_b128 v[216:219], v178 offset:3072
  ds_read_b64_tr_b16 v[220:221], v181 offset:6144
  ds_read_b64_tr_b16 v[222:223], v181 offset:7168
  s_waitcnt lgkmcnt(6)
  v_mfma_f32_32x32x16_bf16 v[240:255], v[204:207], v[200:203], v[240:255]
  s_barrier
  ds_read_b128 v[192:195], v178 offset:16384
  ds_read_b64_tr_b16 v[196:197], v181 offset:16384
  ds_read_b64_tr_b16 v[198:199], v181 offset:17408
  s_waitcnt lgkmcnt(6)
  v_mfma_f32_32x32x16_bf16 v[240:255], v[212:215], v[208:211], v[240:255]
  ds_read_b128 v[200:203], v178 offset:17408
  ds_read_b64_tr_b16 v[204:205], v181 offset:18432
  ds_read_b64_tr_b16 v[206:207], v181 offset:19456
  s_waitcnt lgkmcnt(6)
  v_mfma_f32_32x32x16_bf16 v[240:255], v[220:223], v[216:219], v[240:255]
  ds_read_b128 v[208:211], v178 offset:18432
  ds_read_b64_tr_b16 v[212:213], v181 offset:20480
  ds_read_b64_tr_b16 v[214:215], v181 offset:21504
  s_waitcnt lgkmcnt(6)
  v_mfma_f32_32x32x16_bf16 v[240:255], v[196:199], v[192:195], v[240:255]
  ds_read_b128 v[216:219], v178 offset:19456
  ds_read_b64_tr_b16 v[220:221], v181 offset:22528
  ds_read_b64_tr_b16 v[222:223], v181 offset:23552
  s_waitcnt lgkmcnt(6)
  v_mfma_f32_32x32x16_bf16 v[240:255], v[204:207], v[200:203], v[240:255]
  s_waitcnt lgkmcnt(3)
  v_mfma_f32_32x32x16_bf16 v[240:255], v[212:215], v[208:211], v[240:255]
  s_waitcnt lgkmcnt(0)
  v_mfma_f32_32x32x16_bf16 v[240:255], v[220:223], v[216:219], v[240:255]
  v_mul_f32 v12, 0xbfb8aa3b, v224
  v_mul_f32 v13, 0xbfb8aa3b, v225
  v_mul_f32 v14, 0xbfb8aa3b, v226
  v_mul_f32 v15, 0xbfb8aa3b, v227
  v_exp_f32 v12, v12
  v_exp_f32 v13, v13
  v_exp_f32 v14, v14
  v_exp_f32 v15, v15
  s_nop 3
  v_mul_f32 v240, v240, v224
  v_mul_f32 v241, v241, v225
  v_mul_f32 v242, v242, v226
  v_mul_f32 v243, v243, v227
  v_add_f32 v12, 1.0, v12
  v_add_f32 v13, 1.0, v13
  v_add_f32 v14, 1.0, v14
  v_add_f32 v15, 1.0, v15
  v_rcp_f32 v12, v12
  v_rcp_f32 v13, v13
  v_rcp_f32 v14, v14
  v_rcp_f32 v15, v15
  v_lshlrev_b32 v16, 16, v184
  v_and_b32 v17, 0xffff0000, v184
  v_lshlrev_b32 v18, 16, v185
  v_and_b32 v19, 0xffff0000, v185
  v_fma_f32 v16, v240, v12, v16
  v_fma_f32 v17, v241, v13, v17
  v_fma_f32 v18, v242, v14, v18
  v_fma_f32 v19, v243, v15, v19
  v_cvt_pk_bf16_f32 v20, v16, v17
  v_cvt_pk_bf16_f32 v21, v18, v19
  buffer_store_dwordx2 v[20:21], v183, s[28:31], 0 offen offset:0
  v_mul_f32 v12, 0xbfb8aa3b, v228
  v_mul_f32 v13, 0xbfb8aa3b, v229
  v_mul_f32 v14, 0xbfb8aa3b, v230
  v_mul_f32 v15, 0xbfb8aa3b, v231
  v_exp_f32 v12, v12
  v_exp_f32 v13, v13
  v_exp_f32 v14, v14
  v_exp_f32 v15, v15
  v_mul_f32 v244, v244, v228
  v_mul_f32 v245, v245, v229
  v_mul_f32 v246, v246, v230
  v_mul_f32 v247, v247, v231
  v_add_f32 v12, 1.0, v12
  v_add_f32 v13, 1.0, v13
  v_add_f32 v14, 1.0, v14
  v_add_f32 v15, 1.0, v15
  v_rcp_f32 v12, v12
  v_rcp_f32 v13, v13
  v_rcp_f32 v14, v14
  v_rcp_f32 v15, v15
  v_lshlrev_b32 v16, 16, v186
  v_and_b32 v17, 0xffff0000, v186
  v_lshlrev_b32 v18, 16, v187
  v_and_b32 v19, 0xffff0000, v187
  v_fma_f32 v16, v244, v12, v16
  v_fma_f32 v17, v245, v13, v17
  v_fma_f32 v18, v246, v14, v18
  v_fma_f32 v19, v247, v15, v19
  v_cvt_pk_bf16_f32 v22, v16, v17
  v_cvt_pk_bf16_f32 v23, v18, v19
  buffer_store_dwordx2 v[22:23], v183, s[28:31], 0 offen offset:16
  v_mul_f32 v12, 0xbfb8aa3b, v232
  v_mul_f32 v13, 0xbfb8aa3b, v233
  v_mul_f32 v14, 0xbfb8aa3b, v234
  v_mul_f32 v15, 0xbfb8aa3b, v235
  v_exp_f32 v12, v12
  v_exp_f32 v13, v13
  v_exp_f32 v14, v14
  v_exp_f32 v15, v15
  v_mul_f32 v248, v248, v232
  v_mul_f32 v249, v249, v233
  v_mul_f32 v250, v250, v234
  v_mul_f32 v251, v251, v235
  v_add_f32 v12, 1.0, v12
  v_add_f32 v13, 1.0, v13
  v_add_f32 v14, 1.0, v14
  v_add_f32 v15, 1.0, v15
  v_rcp_f32 v12, v12
  v_rcp_f32 v13, v13
  v_rcp_f32 v14, v14
  v_rcp_f32 v15, v15
  v_lshlrev_b32 v16, 16, v188
  v_and_b32 v17, 0xffff0000, v188
  v_lshlrev_b32 v18, 16, v189
  v_and_b32 v19, 0xffff0000, v189
  v_fma_f32 v16, v248, v12, v16
  v_fma_f32 v17, v249, v13, v17
  v_fma_f32 v18, v250, v14, v18
  v_fma_f32 v19, v251, v15, v19
  v_cvt_pk_bf16_f32 v24, v16, v17
  v_cvt_pk_bf16_f32 v25, v18, v19
  buffer_store_dwordx2 v[24:25], v183, s[28:31], 0 offen offset:32
  v_mul_f32 v12, 0xbfb8aa3b, v236
  v_mul_f32 v13, 0xbfb8aa3b, v237
  v_mul_f32 v14, 0xbfb8aa3b, v238
  v_mul_f32 v15, 0xbfb8aa3b, v239
  v_exp_f32 v12, v12
  v_exp_f32 v13, v13
  v_exp_f32 v14, v14
  v_exp_f32 v15, v15
  v_mul_f32 v252, v252, v236
  v_mul_f32 v253, v253, v237
  v_mul_f32 v254, v254, v238
  v_mul_f32 v255, v255, v239
  v_add_f32 v12, 1.0, v12
  v_add_f32 v13, 1.0, v13
  v_add_f32 v14, 1.0, v14
  v_add_f32 v15, 1.0, v15
  v_rcp_f32 v12, v12
  v_rcp_f32 v13, v13
  v_rcp_f32 v14, v14
  v_rcp_f32 v15, v15
  v_lshlrev_b32 v16, 16, v190
  v_and_b32 v17, 0xffff0000, v190
  v_lshlrev_b32 v18, 16, v191
  v_and_b32 v19, 0xffff0000, v191
  v_fma_f32 v16, v252, v12, v16
  v_fma_f32 v17, v253, v13, v17
  v_fma_f32 v18, v254, v14, v18
  v_fma_f32 v19, v255, v15, v19
  v_cvt_pk_bf16_f32 v26, v16, v17
  v_cvt_pk_bf16_f32 v27, v18, v19
  buffer_store_dwordx2 v[26:27], v183, s[28:31], 0 offen offset:48
  s_memtime s[80:81]
  s_waitcnt lgkmcnt(0)
  v_writelane_b32 v40, s96, 0
  v_writelane_b32 v40, s44, 1
  v_writelane_b32 v40, s46, 2
  v_writelane_b32 v40, s78, 3
  v_writelane_b32 v40, s80, 4
  v_writelane_b32 v40, s22, 5
  v_writelane_b32 v40, s14, 6
  v_writelane_b32 v40, s20, 7
  s_lshl_b32 s60, s2, 2
  s_add_u32 s60, s60, s48
  s_lshl_b32 s60, s60, 5
  s_add_u32 s60, s60, 0x978000
  v_lshlrev_b32 v41, 2, v176
  v_mov_b32 v42, 0x7ffffff0
  v_cmp_gt_u32 vcc, 8, v176
  s_nop 1
  v_cndmask_b32 v41, v42, v41, vcc
  buffer_store_dword v40, v41, s[40:43], s60 offen
  s_endpgm
L_p2_loaderE:
  s_nop 1
  s_sub_u32 s38, s48, 4
  s_and_b32 s60, s38, 1
  s_lshr_b32 s61, s38, 1
  s_lshl_b32 s62, s32, 1
  s_add_u32 s62, s62, s60
  s_mul_i32 s62, s62, 144
  s_lshl_b32 s63, s61, 1
  s_add_u32 s62, s62, s63
  s_lshl_b32 s34, s62, 10
  s_lshl_b32 s62, s60, 2
  s_add_u32 s62, s62, s63
  s_lshl_b32 s35, s62, 10
  s_lshl_b32 s36, s38, 11
  s_add_u32 s36, s36, 8192
  s_lshl_b32 s37, s33, 7
  v_lshlrev_b32 v177, 4, v176
  v_lshrrev_b32 v192, 3, v176
  s_lshl_b32 s62, s38, 4
  v_add_u32 v192, s62, v192
  v_lshlrev_b32 v192, 10, v192
  v_and_b32 v193, 7, v176
  v_lshrrev_b32 v194, 2, v176
  v_and_b32 v194, 4, v194
  v_xor_b32 v193, v193, v194
  v_lshl_add_u32 v180, v193, 4, v192
  s_waitcnt lgkmcnt(0)
  s_add_u32 m0, s36, 0
  s_add_u32 s60, s37, 0
  buffer_load_dwordx4 v180, s[68:71], s60 offen lds
  s_add_u32 m0, s36, 1024
  s_add_u32 s60, s37, 8192
  buffer_load_dwordx4 v180, s[68:71], s60 offen lds
  s_waitcnt vmcnt(3)
  v_readfirstlane_b32 s63, v0
  s_nop 1
  s_cmp_ge_u32 s63, 16
  s_cbranch_scc1 L_p2E_a_go
  s_mov_b32 s82, 0
L_p2E_a_spin:
  buffer_load_dword v184, off, s[40:43], s87 sc1
  s_waitcnt vmcnt(0)
  v_readfirstlane_b32 s63, v184
  s_add_u32 s82, s82, 1
  s_cmp_ge_u32 s63, 16
  s_cbranch_scc1 L_p2E_a_go
  s_cmp_ge_u32 s82, 0x200000
  s_cbranch_scc1 L_p2E_a_go
  s_sleep 3
  s_branch L_p2E_a_spin
L_p2E_a_go:
  s_nop 1
  s_add_u32 m0, s35, 0
  s_add_u32 s60, s34, 0
  buffer_load_dwordx4 v177, s[40:43], s60 offen lds
  s_add_u32 m0, s35, 1024
  s_add_u32 s60, s34, 1024
  buffer_load_dwordx4 v177, s[40:43], s60 offen lds
  s_add_u32 m0, s36, 16384
  s_add_u32 s60, s37, 327680
  buffer_load_dwordx4 v180, s[68:71], s60 offen lds
  s_add_u32 m0, s36, 17408
  s_add_u32 s60, s37, 335872
  buffer_load_dwordx4 v180, s[68:71], s60 offen lds
  s_add_u32 m0, s35, 16384
  s_add_u32 s60, s34, 20480
  buffer_load_dwordx4 v177, s[40:43], s60 offen lds
  s_add_u32 m0, s35, 17408
  s_add_u32 s60, s34, 21504
  buffer_load_dwordx4 v177, s[40:43], s60 offen lds
  s_add_u32 m0, s36, 32768
  s_add_u32 s60, s37, 458752
  buffer_load_dwordx4 v180, s[68:71], s60 offen lds
  s_add_u32 m0, s36, 33792
  s_add_u32 s60, s37, 466944
  buffer_load_dwordx4 v180, s[68:71], s60 offen lds
  s_add_u32 m0, s35, 32768
  s_add_u32 s60, s34, 28672
  buffer_load_dwordx4 v177, s[40:43], s60 offen lds
  s_add_u32 m0, s35, 33792
  s_add_u32 s60, s34, 29696
  buffer_load_dwordx4 v177, s[40:43], s60 offen lds
  s_add_u32 m0, s36, 49152
  s_add_u32 s60, s37, 786432
  buffer_load_dwordx4 v180, s[68:71], s60 offen lds
  s_add_u32 m0, s36, 50176
  s_add_u32 s60, s37, 794624
  buffer_load_dwordx4 v180, s[68:71], s60 offen lds
  s_add_u32 m0, s35, 49152
  s_add_u32 s60, s34, 49152
  buffer_load_dwordx4 v177, s[40:43], s60 offen lds
  s_add_u32 m0, s35, 50176
  s_add_u32 s60, s34, 50176
  buffer_load_dwordx4 v177, s[40:43], s60 offen lds
  v_and_b32 v28, 0x1f0, v1
  v_add_u32 v28, s4, v28
  ds_read_b128 v[20:23], v28 offset:0
  s_waitcnt lgkmcnt(0)
  v_add_f32 v20, v20, v21
  v_add_f32 v22, v22, v23
  v_add_f32 v20, v20, v22
  v_cvt_pk_bf16_f32 v21, v20, v20
  v_lshlrev_b32 v21, 16, v21
  v_sub_f32 v21, v20, v21
  v_cvt_pk_bf16_f32 v46, v20, v21
  s_nop 1
  v_mfma_f32_32x32x8_bf16 v[64:79], v[46:47], v[44:45], v[64:79]
  buffer_load_dword v19, off, s[40:43], s88 sc1
  s_nop 10
  v_mul_f32 v64, v64, v5
  v_mul_f32 v65, v65, v5
  v_mul_f32 v66, v66, v5
  v_mul_f32 v67, v67, v5
  v_min_f32 v28, 0, v64
  s_waitcnt vmcnt(13)
  s_barrier
  s_add_u32 m0, s36, 65536
  s_add_u32 s60, s37, 917504
  buffer_load_dwordx4 v180, s[68:71], s60 offen lds
  s_add_u32 m0, s36, 66560
  s_add_u32 s60, s37, 925696
  buffer_load_dwordx4 v180, s[68:71], s60 offen lds
  s_add_u32 m0, s35, 65536
  s_add_u32 s60, s34, 57344
  buffer_load_dwordx4 v177, s[40:43], s60 offen lds
  s_add_u32 m0, s35, 66560
  s_add_u32 s60, s34, 58368
  buffer_load_dwordx4 v177, s[40:43], s60 offen lds
  s_add_u32 m0, s36, 81920
  s_add_u32 s60, s37, 1245184
  buffer_load_dwordx4 v180, s[68:71], s60 offen lds
  s_add_u32 m0, s36, 82944
  s_add_u32 s60, s37, 1253376
  buffer_load_dwordx4 v180, s[68:71], s60 offen lds
  s_add_u32 m0, s35, 81920
  s_add_u32 s60, s34, 77824
  buffer_load_dwordx4 v177, s[40:43], s60 offen lds
  s_add_u32 m0, s35, 82944
  s_add_u32 s60, s34, 78848
  buffer_load_dwordx4 v177, s[40:43], s60 offen lds
  v_min_f32 v29, 0, v65
  v_min_f32 v30, 0, v66
  v_min_f32 v31, 0, v67
  v_mul_f32 v28, 0x3fb8aa3b, v28
  v_mul_f32 v29, 0x3fb8aa3b, v29
  v_mul_f32 v30, 0x3fb8aa3b, v30
  v_mul_f32 v31, 0x3fb8aa3b, v31
  v_exp_f32 v28, v28
  v_exp_f32 v29, v29
  v_exp_f32 v30, v30
  v_exp_f32 v31, v31
  v_max_f32 v64, 0, v64
  v_max_f32 v65, 0, v65
  v_max_f32 v66, 0, v66
  v_max_f32 v67, 0, v67
  v_add_f32 v28, 0x358637bd, v28
  s_waitcnt vmcnt(17)
  s_barrier
  s_add_u32 m0, s36, 98304
  s_add_u32 s60, s37, 1376256
  buffer_load_dwordx4 v180, s[68:71], s60 offen lds
  s_add_u32 m0, s36, 99328
  s_add_u32 s60, s37, 1384448
  buffer_load_dwordx4 v180, s[68:71], s60 offen lds
  s_add_u32 m0, s35, 98304
  s_add_u32 s60, s34, 86016
  buffer_load_dwordx4 v177, s[40:43], s60 offen lds
  s_add_u32 m0, s35, 99328
  s_add_u32 s60, s34, 87040
  buffer_load_dwordx4 v177, s[40:43], s60 offen lds
  v_add_f32 v29, 0x358637bd, v29
  v_add_f32 v30, 0x358637bd, v30
  v_add_f32 v31, 0x358637bd, v31
  v_add_f32 v64, v64, v28
  v_add_f32 v65, v65, v29
  v_add_f32 v66, v66, v30
  v_add_f32 v67, v67, v31
  v_cvt_pk_bf16_f32 v64, v64, v65
  v_cvt_pk_bf16_f32 v65, v66, v67
  v_mul_f32 v68, v68, v5
  v_mul_f32 v69, v69, v5
  v_mul_f32 v70, v70, v5
  v_mul_f32 v71, v71, v5
  v_min_f32 v28, 0, v68
  v_min_f32 v29, 0, v69
  v_min_f32 v30, 0, v70
  s_waitcnt vmcnt(17)
  s_barrier
  s_add_u32 m0, s36, 114688
  s_add_u32 s60, s37, 1703936
  buffer_load_dwordx4 v180, s[68:71], s60 offen lds
  s_add_u32 m0, s36, 115712
  s_add_u32 s60, s37, 1712128
  buffer_load_dwordx4 v180, s[68:71], s60 offen lds
  s_add_u32 m0, s35, 114688
  s_add_u32 s60, s34, 106496
  buffer_load_dwordx4 v177, s[40:43], s60 offen lds
  s_add_u32 m0, s35, 115712
  s_add_u32 s60, s34, 107520
  buffer_load_dwordx4 v177, s[40:43], s60 offen lds
  v_min_f32 v31, 0, v71
  v_mul_f32 v28, 0x3fb8aa3b, v28
  v_mul_f32 v29, 0x3fb8aa3b, v29
  v_mul_f32 v30, 0x3fb8aa3b, v30
  v_mul_f32 v31, 0x3fb8aa3b, v31
  v_exp_f32 v28, v28
  v_exp_f32 v29, v29
  v_exp_f32 v30, v30
  v_exp_f32 v31, v31
  v_max_f32 v68, 0, v68
  v_max_f32 v69, 0, v69
  v_max_f32 v70, 0, v70
  v_max_f32 v71, 0, v71
  v_add_f32 v28, 0x358637bd, v28
  v_add_f32 v29, 0x358637bd, v29
  v_add_f32 v30, 0x358637bd, v30
  s_waitcnt vmcnt(17)
  s_barrier
  s_add_u32 m0, s36, 131072
  s_add_u32 s60, s37, 196608
  buffer_load_dwordx4 v180, s[68:71], s60 offen lds
  s_add_u32 m0, s36, 132096
  s_add_u32 s60, s37, 204800
  buffer_load_dwordx4 v180, s[68:71], s60 offen lds
  s_add_u32 m0, s35, 131072
  s_add_u32 s60, s34, 12288
  buffer_load_dwordx4 v177, s[40:43], s60 offen lds
  s_add_u32 m0, s35, 132096
  s_add_u32 s60, s34, 13312
  buffer_load_dwordx4 v177, s[40:43], s60 offen lds
  v_add_f32 v31, 0x358637bd, v31
  v_add_f32 v68, v68, v28
  v_add_f32 v69, v69, v29
  v_add_f32 v70, v70, v30
  v_add_f32 v71, v71, v31
  v_cvt_pk_bf16_f32 v66, v68, v69
  v_cvt_pk_bf16_f32 v67, v70, v71
  s_waitcnt vmcnt(20)
  v_readfirstlane_b32 s62, v19
  s_nop 1
  s_cmp_ge_u32 s62, 16
  s_cbranch_scc1 L_dlE_ok
  s_mov_b32 s82, 0
L_dlE_spin:
  s_sleep 16
  buffer_load_dword v19, off, s[40:43], s88 sc1
  s_waitcnt vmcnt(0)
  v_readfirstlane_b32 s62, v19
  s_add_u32 s82, s82, 1
  s_cmp_ge_u32 s82, 0x100000
  s_cbranch_scc1 L_dlE_ok
  s_cmp_ge_u32 s62, 16
  s_cbranch_scc0 L_dlE_spin
L_dlE_ok:
  s_nop 1
  v_lshrrev_b32 v12, 2, v1
  v_xor_b32 v13, 64, v12
  buffer_load_dword v80, v12, s[40:43], s85 offen offset:0 sc1
  buffer_load_dword v81, v12, s[40:43], s85 offen offset:256 sc1
  buffer_load_dword v82, v12, s[40:43], s85 offen offset:512 sc1
  buffer_load_dword v83, v12, s[40:43], s85 offen offset:768 sc1
  buffer_load_dword v84, v12, s[40:43], s85 offen offset:1024 sc1
  buffer_load_dword v85, v12, s[40:43], s85 offen offset:1280 sc1
  buffer_load_dword v86, v12, s[40:43], s85 offen offset:1536 sc1
  buffer_load_dword v87, v12, s[40:43], s85 offen offset:1792 sc1
  buffer_load_dword v88, v13, s[40:43], s85 offen offset:2048 sc1
  buffer_load_dword v89, v13, s[40:43], s85 offen offset:2304 sc1
  buffer_load_dword v90, v13, s[40:43], s85 offen offset:2560 sc1
  buffer_load_dword v91, v13, s[40:43], s85 offen offset:2816 sc1
  buffer_load_dword v92, v13, s[40:43], s85 offen offset:3072 sc1
  buffer_load_dword v93, v13, s[40:43], s85 offen offset:3328 sc1
  buffer_load_dword v94, v13, s[40:43], s85 offen offset:3584 sc1
  buffer_load_dword v95, v13, s[40:43], s85 offen offset:3840 sc1
  v_mul_f32 v72, v72, v5
  v_mul_f32 v73, v73, v5
  v_mul_f32 v74, v74, v5
  v_mul_f32 v75, v75, v5
  v_min_f32 v28, 0, v72
  v_min_f32 v29, 0, v73
  v_min_f32 v30, 0, v74
  v_min_f32 v31, 0, v75
  v_mul_f32 v28, 0x3fb8aa3b, v28
  s_waitcnt vmcnt(32)
  s_barrier
  s_add_u32 m0, s36, 147456
  s_add_u32 s60, s37, 655360
  buffer_load_dwordx4 v180, s[68:71], s60 offen lds
  s_add_u32 m0, s36, 148480
  s_add_u32 s60, s37, 663552
  buffer_load_dwordx4 v180, s[68:71], s60 offen lds
  s_add_u32 m0, s35, 147456
  s_add_u32 s60, s34, 40960
  buffer_load_dwordx4 v177, s[40:43], s60 offen lds
  s_add_u32 m0, s35, 148480
  s_add_u32 s60, s34, 41984
  buffer_load_dwordx4 v177, s[40:43], s60 offen lds
  v_mul_f32 v29, 0x3fb8aa3b, v29
  v_mul_f32 v30, 0x3fb8aa3b, v30
  v_mul_f32 v31, 0x3fb8aa3b, v31
  v_exp_f32 v28, v28
  v_exp_f32 v29, v29
  v_exp_f32 v30, v30
  v_exp_f32 v31, v31
  v_max_f32 v72, 0, v72
  v_max_f32 v73, 0, v73
  v_max_f32 v74, 0, v74
  v_max_f32 v75, 0, v75
  v_add_f32 v28, 0x358637bd, v28
  v_add_f32 v29, 0x358637bd, v29
  v_add_f32 v30, 0x358637bd, v30
  v_add_f32 v31, 0x358637bd, v31
  v_add_f32 v72, v72, v28
  s_waitcnt vmcnt(32)
  s_barrier
  s_add_u32 m0, s36, 0
  s_add_u32 s60, s37, 1114112
  buffer_load_dwordx4 v180, s[68:71], s60 offen lds
  s_add_u32 m0, s36, 1024
  s_add_u32 s60, s37, 1122304
  buffer_load_dwordx4 v180, s[68:71], s60 offen lds
  s_add_u32 m0, s35, 0
  s_add_u32 s60, s34, 69632
  buffer_load_dwordx4 v177, s[40:43], s60 offen lds
  s_add_u32 m0, s35, 1024
  s_add_u32 s60, s34, 70656
  buffer_load_dwordx4 v177, s[40:43], s60 offen lds
  v_add_f32 v73, v73, v29
  v_add_f32 v74, v74, v30
  v_add_f32 v75, v75, v31
  v_cvt_pk_bf16_f32 v68, v72, v73
  v_cvt_pk_bf16_f32 v69, v74, v75
  v_mul_f32 v76, v76, v5
  v_mul_f32 v77, v77, v5
  v_mul_f32 v78, v78, v5
  v_mul_f32 v79, v79, v5
  v_min_f32 v28, 0, v76
  v_min_f32 v29, 0, v77
  v_min_f32 v30, 0, v78
  v_min_f32 v31, 0, v79
  v_mul_f32 v28, 0x3fb8aa3b, v28
  v_mul_f32 v29, 0x3fb8aa3b, v29
  v_mul_f32 v30, 0x3fb8aa3b, v30
  s_waitcnt vmcnt(32)
  v_mul_f32 v31, 0x3fb8aa3b, v31
  v_exp_f32 v28, v28
  v_exp_f32 v29, v29
  v_exp_f32 v30, v30
  v_exp_f32 v31, v31
  v_max_f32 v76, 0, v76
  v_max_f32 v77, 0, v77
  v_max_f32 v78, 0, v78
  v_max_f32 v79, 0, v79
  v_add_f32 v28, 0x358637bd, v28
  v_add_f32 v29, 0x358637bd, v29
  v_add_f32 v30, 0x358637bd, v30
  v_add_f32 v31, 0x358637bd, v31
  v_add_f32 v76, v76, v28
  v_add_f32 v77, v77, v29
  v_add_f32 v78, v78, v30
  v_add_f32 v79, v79, v31
  v_cvt_pk_bf16_f32 v70, v76, v77
  v_cvt_pk_bf16_f32 v71, v78, v79
  s_waitcnt vmcnt(22)
  v_cvt_pk_bf16_f32 v80, v80, v81
  s_waitcnt vmcnt(20)
  v_cvt_pk_bf16_f32 v81, v82, v83
  s_waitcnt vmcnt(18)
  v_cvt_pk_bf16_f32 v82, v84, v85
  s_waitcnt vmcnt(16)
  v_cvt_pk_bf16_f32 v83, v86, v87
  s_waitcnt vmcnt(14)
  v_cvt_pk_bf16_f32 v84, v88, v89
  s_waitcnt vmcnt(12)
  v_cvt_pk_bf16_f32 v85, v90, v91
  s_waitcnt vmcnt(10)
  v_cvt_pk_bf16_f32 v86, v92, v93
  s_waitcnt vmcnt(8)
  v_cvt_pk_bf16_f32 v87, v94, v95
  v_mfma_f32_32x32x16_bf16 v[128:143], v[80:83], v[64:67], 0
  s_nop 0
  v_mfma_f32_32x32x16_bf16 v[144:159], v[84:87], v[68:71], 0
  s_nop 9
  v_add_f32 v160, 0x358637bd, v136
  s_nop 0
  v_add_f32 v161, 0x358637bd, v152
  v_rcp_f32 v160, v160
  v_rcp_f32 v161, v161
  v_mul_f32 v128, v128, v160
  v_mul_f32 v129, v129, v160
  v_mul_f32 v130, v130, v160
  v_mul_f32 v131, v131, v160
  v_mul_f32 v132, v132, v160
  v_mul_f32 v133, v133, v160
  v_mul_f32 v134, v134, v160
  v_mul_f32 v135, v135, v160
  v_cvt_pk_bf16_f32 v164, v128, v129
  v_cvt_pk_bf16_f32 v165, v130, v131
  v_cvt_pk_bf16_f32 v166, v132, v133
  v_cvt_pk_bf16_f32 v167, v134, v135
  s_add_u32 s62, s76, 0
  buffer_store_dwordx4 v[164:167], v1, s[40:43], s62 offen sc1
  v_mul_f32 v144, v144, v161
  v_mul_f32 v145, v145, v161
  v_mul_f32 v146, v146, v161
  v_mul_f32 v147, v147, v161
  v_mul_f32 v148, v148, v161
  v_mul_f32 v149, v149, v161
  v_mul_f32 v150, v150, v161
  v_mul_f32 v151, v151, v161
  v_cvt_pk_bf16_f32 v168, v144, v145
  v_cvt_pk_bf16_f32 v169, v146, v147
  v_cvt_pk_bf16_f32 v170, v148, v149
  v_cvt_pk_bf16_f32 v171, v150, v151
  s_add_u32 s62, s76, 1024
  buffer_store_dwordx4 v[168:171], v1, s[40:43], s62 offen sc1
  s_barrier
  s_add_u32 m0, s36, 16384
  s_add_u32 s60, s37, 1572864
  buffer_load_dwordx4 v180, s[68:71], s60 offen lds
  s_add_u32 m0, s36, 17408
  s_add_u32 s60, s37, 1581056
  buffer_load_dwordx4 v180, s[68:71], s60 offen lds
  s_add_u32 m0, s35, 16384
  s_add_u32 s60, s34, 98304
  buffer_load_dwordx4 v177, s[40:43], s60 offen lds
  s_add_u32 m0, s35, 17408
  s_add_u32 s60, s34, 99328
  buffer_load_dwordx4 v177, s[40:43], s60 offen lds
  s_barrier
  s_add_u32 m0, s36, 32768
  s_add_u32 s60, s37, 65536
  buffer_load_dwordx4 v180, s[68:71], s60 offen lds
  s_add_u32 m0, s36, 33792
  s_add_u32 s60, s37, 73728
  buffer_load_dwordx4 v180, s[68:71], s60 offen lds
  s_mov_b32 s82, 0
L_p2E_b_spin:
  buffer_load_dword v184, off, s[40:43], s39 sc1
  s_waitcnt vmcnt(0)
  v_readfirstlane_b32 s63, v184
  s_add_u32 s82, s82, 1
  s_cmp_ge_u32 s63, 8
  s_cbranch_scc1 L_p2E_b_go
  s_cmp_ge_u32 s82, 0x200000
  s_cbranch_scc1 L_p2E_b_go
  s_sleep 3
  s_branch L_p2E_b_spin
L_p2E_b_go:
  s_nop 1
  s_add_u32 m0, s35, 32768
  s_add_u32 s60, s34, 4096
  buffer_load_dwordx4 v177, s[40:43], s60 offen lds
  s_add_u32 m0, s35, 33792
  s_add_u32 s60, s34, 5120
  buffer_load_dwordx4 v177, s[40:43], s60 offen lds
  s_barrier
  s_add_u32 m0, s36, 49152
  s_add_u32 s60, s37, 393216
  buffer_load_dwordx4 v180, s[68:71], s60 offen lds
  s_add_u32 m0, s36, 50176
  s_add_u32 s60, s37, 401408
  buffer_load_dwordx4 v180, s[68:71], s60 offen lds
  s_add_u32 m0, s35, 49152
  s_add_u32 s60, s34, 24576
  buffer_load_dwordx4 v177, s[40:43], s60 offen lds
  s_add_u32 m0, s35, 50176
  s_add_u32 s60, s34, 25600
  buffer_load_dwordx4 v177, s[40:43], s60 offen lds
  s_barrier
  s_add_u32 m0, s36, 65536
  s_add_u32 s60, s37, 524288
  buffer_load_dwordx4 v180, s[68:71], s60 offen lds
  s_add_u32 m0, s36, 66560
  s_add_u32 s60, s37, 532480
  buffer_load_dwordx4 v180, s[68:71], s60 offen lds
  s_add_u32 m0, s35, 65536
  s_add_u32 s60, s34, 32768
  buffer_load_dwordx4 v177, s[40:43], s60 offen lds
  s_add_u32 m0, s35, 66560
  s_add_u32 s60, s34, 33792
  buffer_load_dwordx4 v177, s[40:43], s60 offen lds
  s_barrier
  s_add_u32 m0, s36, 81920
  s_add_u32 s60, s37, 851968
  buffer_load_dwordx4 v180, s[68:71], s60 offen lds
  s_add_u32 m0, s36, 82944
  s_add_u32 s60, s37, 860160
  buffer_load_dwordx4 v180, s[68:71], s60 offen lds
  s_add_u32 m0, s35, 81920
  s_add_u32 s60, s34, 53248
  buffer_load_dwordx4 v177, s[40:43], s60 offen lds
  s_add_u32 m0, s35, 82944
  s_add_u32 s60, s34, 54272
  buffer_load_dwordx4 v177, s[40:43], s60 offen lds
  s_barrier
  s_add_u32 m0, s36, 98304
  s_add_u32 s60, s37, 983040
  buffer_load_dwordx4 v180, s[68:71], s60 offen lds
  s_add_u32 m0, s36, 99328
  s_add_u32 s60, s37, 991232
  buffer_load_dwordx4 v180, s[68:71], s60 offen lds
  s_add_u32 m0, s35, 98304
  s_add_u32 s60, s34, 61440
  buffer_load_dwordx4 v177, s[40:43], s60 offen lds
  s_add_u32 m0, s35, 99328
  s_add_u32 s60, s34, 62464
  buffer_load_dwordx4 v177, s[40:43], s60 offen lds
  s_waitcnt vmcnt(16)
  s_barrier
  s_add_u32 m0, s36, 114688
  s_add_u32 s60, s37, 1310720
  buffer_load_dwordx4 v180, s[68:71], s60 offen lds
  s_add_u32 m0, s36, 115712
  s_add_u32 s60, s37, 1318912
  buffer_load_dwordx4 v180, s[68:71], s60 offen lds
  s_add_u32 m0, s35, 114688
  s_add_u32 s60, s34, 81920
  buffer_load_dwordx4 v177, s[40:43], s60 offen lds
  s_add_u32 m0, s35, 115712
  s_add_u32 s60, s34, 82944
  buffer_load_dwordx4 v177, s[40:43], s60 offen lds
  s_waitcnt vmcnt(16)
  s_barrier
  s_add_u32 m0, s36, 131072
  s_add_u32 s60, s37, 1441792
  buffer_load_dwordx4 v180, s[68:71], s60 offen lds
  s_add_u32 m0, s36, 132096
  s_add_u32 s60, s37, 1449984
  buffer_load_dwordx4 v180, s[68:71], s60 offen lds
  s_add_u32 m0, s35, 131072
  s_add_u32 s60, s34, 90112
  buffer_load_dwordx4 v177, s[40:43], s60 offen lds
  s_add_u32 m0, s35, 132096
  s_add_u32 s60, s34, 91136
  buffer_load_dwordx4 v177, s[40:43], s60 offen lds
  s_waitcnt vmcnt(16)
  s_barrier
  s_add_u32 m0, s36, 147456
  s_add_u32 s60, s37, 1769472
  buffer_load_dwordx4 v180, s[68:71], s60 offen lds
  s_add_u32 m0, s36, 148480
  s_add_u32 s60, s37, 1777664
  buffer_load_dwordx4 v180, s[68:71], s60 offen lds
  s_add_u32 m0, s35, 147456
  s_add_u32 s60, s34, 110592
  buffer_load_dwordx4 v177, s[40:43], s60 offen lds
  s_add_u32 m0, s35, 148480
  s_add_u32 s60, s34, 111616
  buffer_load_dwordx4 v177, s[40:43], s60 offen lds
  s_waitcnt vmcnt(16)
  s_barrier
  s_add_u32 m0, s36, 0
  s_add_u32 s60, s37, 131072
  buffer_load_dwordx4 v180, s[68:71], s60 offen lds
  s_add_u32 m0, s36, 1024
  s_add_u32 s60, s37, 139264
  buffer_load_dwordx4 v180, s[68:71], s60 offen lds
  s_mov_b32 s82, 0
L_p2E_c_spin:
  buffer_load_dword v184, off, s[40:43], s86 sc1
  s_waitcnt vmcnt(0)
  v_readfirstlane_b32 s63, v184
  s_add_u32 s82, s82, 1
  s_cmp_ge_u32 s63, 16
  s_cbranch_scc1 L_p2E_c_go
  s_cmp_ge_u32 s82, 0x200000
  s_cbranch_scc1 L_p2E_c_go
  s_sleep 3
  s_branch L_p2E_c_spin
L_p2E_c_go:
  s_nop 1
  s_add_u32 m0, s35, 0
  s_add_u32 s60, s34, 8192
  buffer_load_dwordx4 v177, s[40:43], s60 offen lds
  s_add_u32 m0, s35, 1024
  s_add_u32 s60, s34, 9216
  buffer_load_dwordx4 v177, s[40:43], s60 offen lds
  s_barrier
  s_add_u32 m0, s36, 16384
  s_add_u32 s60, s37, 589824
  buffer_load_dwordx4 v180, s[68:71], s60 offen lds
  s_add_u32 m0, s36, 17408
  s_add_u32 s60, s37, 598016
  buffer_load_dwordx4 v180, s[68:71], s60 offen lds
  s_add_u32 m0, s35, 16384
  s_add_u32 s60, s34, 36864
  buffer_load_dwordx4 v177, s[40:43], s60 offen lds
  s_add_u32 m0, s35, 17408
  s_add_u32 s60, s34, 37888
  buffer_load_dwordx4 v177, s[40:43], s60 offen lds
  s_barrier
  s_add_u32 m0, s36, 32768
  s_add_u32 s60, s37, 1048576
  buffer_load_dwordx4 v180, s[68:71], s60 offen lds
  s_add_u32 m0, s36, 33792
  s_add_u32 s60, s37, 1056768
  buffer_load_dwordx4 v180, s[68:71], s60 offen lds
  s_add_u32 m0, s35, 32768
  s_add_u32 s60, s34, 65536
  buffer_load_dwordx4 v177, s[40:43], s60 offen lds
  s_add_u32 m0, s35, 33792
  s_add_u32 s60, s34, 66560
  buffer_load_dwordx4 v177, s[40:43], s60 offen lds
  s_barrier
  s_add_u32 m0, s36, 49152
  s_add_u32 s60, s37, 1507328
  buffer_load_dwordx4 v180, s[68:71], s60 offen lds
  s_add_u32 m0, s36, 50176
  s_add_u32 s60, s37, 1515520
  buffer_load_dwordx4 v180, s[68:71], s60 offen lds
  s_add_u32 m0, s35, 49152
  s_add_u32 s60, s34, 94208
  buffer_load_dwordx4 v177, s[40:43], s60 offen lds
  s_add_u32 m0, s35, 50176
  s_add_u32 s60, s34, 95232
  buffer_load_dwordx4 v177, s[40:43], s60 offen lds
  s_barrier
  s_add_u32 m0, s36, 65536
  s_add_u32 s60, s37, 262144
  buffer_load_dwordx4 v180, s[68:71], s60 offen lds
  s_add_u32 m0, s36, 66560
  s_add_u32 s60, s37, 270336
  buffer_load_dwordx4 v180, s[68:71], s60 offen lds
  s_add_u32 m0, s35, 65536
  s_add_u32 s60, s34, 16384
  buffer_load_dwordx4 v177, s[40:43], s60 offen lds
  s_add_u32 m0, s35, 66560
  s_add_u32 s60, s34, 17408
  buffer_load_dwordx4 v177, s[40:43], s60 offen lds
  s_waitcnt vmcnt(16)
  s_barrier
  s_add_u32 m0, s36, 81920
  s_add_u32 s60, s37, 720896
  buffer_load_dwordx4 v180, s[68:71], s60 offen lds
  s_add_u32 m0, s36, 82944
  s_add_u32 s60, s37, 729088
  buffer_load_dwordx4 v180, s[68:71], s60 offen lds
  s_add_u32 m0, s35, 81920
  s_add_u32 s60, s34, 45056
  buffer_load_dwordx4 v177, s[40:43], s60 offen lds
  s_add_u32 m0, s35, 82944
  s_add_u32 s60, s34, 46080
  buffer_load_dwordx4 v177, s[40:43], s60 offen lds
  s_waitcnt vmcnt(16)
  s_barrier
  s_add_u32 m0, s36, 98304
  s_add_u32 s60, s37, 1179648
  buffer_load_dwordx4 v180, s[68:71], s60 offen lds
  s_add_u32 m0, s36, 99328
  s_add_u32 s60, s37, 1187840
  buffer_load_dwordx4 v180, s[68:71], s60 offen lds
  s_add_u32 m0, s35, 98304
  s_add_u32 s60, s34, 73728
  buffer_load_dwordx4 v177, s[40:43], s60 offen lds
  s_add_u32 m0, s35, 99328
  s_add_u32 s60, s34, 74752
  buffer_load_dwordx4 v177, s[40:43], s60 offen lds
  s_waitcnt vmcnt(16)
  s_barrier
  s_add_u32 m0, s36, 114688
  s_add_u32 s60, s37, 1638400
  buffer_load_dwordx4 v180, s[68:71], s60 offen lds
  s_add_u32 m0, s36, 115712
  s_add_u32 s60, s37, 1646592
  buffer_load_dwordx4 v180, s[68:71], s60 offen lds
  s_add_u32 m0, s35, 114688
  s_add_u32 s60, s34, 102400
  buffer_load_dwordx4 v177, s[40:43], s60 offen lds
  s_add_u32 m0, s35, 115712
  s_add_u32 s60, s34, 103424
  buffer_load_dwordx4 v177, s[40:43], s60 offen lds
  s_waitcnt vmcnt(16)
  s_barrier
  s_add_u32 m0, s36, 131072
  s_add_u32 s60, s37, 0
  buffer_load_dwordx4 v180, s[72:75], s60 offen lds
  s_add_u32 m0, s36, 132096
  s_add_u32 s60, s37, 8192
  buffer_load_dwordx4 v180, s[72:75], s60 offen lds
  s_add_u32 m0, s35, 131072
  s_add_u32 s60, s34, 114688
  buffer_load_dwordx4 v177, s[40:43], s60 offen lds
  s_add_u32 m0, s35, 132096
  s_add_u32 s60, s34, 115712
  buffer_load_dwordx4 v177, s[40:43], s60 offen lds
  s_waitcnt vmcnt(16)
  s_barrier
  s_add_u32 m0, s36, 147456
  s_add_u32 s60, s37, 65536
  buffer_load_dwordx4 v180, s[72:75], s60 offen lds
  s_add_u32 m0, s36, 148480
  s_add_u32 s60, s37, 73728
  buffer_load_dwordx4 v180, s[72:75], s60 offen lds
  s_add_u32 m0, s35, 147456
  s_add_u32 s60, s34, 118784
  buffer_load_dwordx4 v177, s[40:43], s60 offen lds
  s_add_u32 m0, s35, 148480
  s_add_u32 s60, s34, 119808
  buffer_load_dwordx4 v177, s[40:43], s60 offen lds
  s_waitcnt vmcnt(16)
  s_barrier
  s_add_u32 m0, s36, 0
  s_add_u32 s60, s37, 131072
  buffer_load_dwordx4 v180, s[72:75], s60 offen lds
  s_add_u32 m0, s36, 1024
  s_add_u32 s60, s37, 139264
  buffer_load_dwordx4 v180, s[72:75], s60 offen lds
  s_add_u32 m0, s35, 0
  s_add_u32 s60, s34, 122880
  buffer_load_dwordx4 v177, s[40:43], s60 offen lds
  s_add_u32 m0, s35, 1024
  s_add_u32 s60, s34, 123904
  buffer_load_dwordx4 v177, s[40:43], s60 offen lds
  s_waitcnt vmcnt(16)
  s_barrier
  s_add_u32 m0, s36, 16384
  s_add_u32 s60, s37, 196608
  buffer_load_dwordx4 v180, s[72:75], s60 offen lds
  s_add_u32 m0, s36, 17408
  s_add_u32 s60, s37, 204800
  buffer_load_dwordx4 v180, s[72:75], s60 offen lds
  s_add_u32 m0, s35, 16384
  s_add_u32 s60, s34, 126976
  buffer_load_dwordx4 v177, s[40:43], s60 offen lds
  s_add_u32 m0, s35, 17408
  s_add_u32 s60, s34, 128000
  buffer_load_dwordx4 v177, s[40:43], s60 offen lds
  s_waitcnt vmcnt(16)
  s_barrier
  s_add_u32 m0, s36, 32768
  s_add_u32 s60, s37, 262144
  buffer_load_dwordx4 v180, s[72:75], s60 offen lds
  s_add_u32 m0, s36, 33792
  s_add_u32 s60, s37, 270336
  buffer_load_dwordx4 v180, s[72:75], s60 offen lds
  s_add_u32 m0, s35, 32768
  s_add_u32 s60, s34, 131072
  buffer_load_dwordx4 v177, s[40:43], s60 offen lds
  s_add_u32 m0, s35, 33792
  s_add_u32 s60, s34, 132096
  buffer_load_dwordx4 v177, s[40:43], s60 offen lds
  s_waitcnt vmcnt(16)
  s_barrier
  s_add_u32 m0, s36, 49152
  s_add_u32 s60, s37, 327680
  buffer_load_dwordx4 v180, s[72:75], s60 offen lds
  s_add_u32 m0, s36, 50176
  s_add_u32 s60, s37, 335872
  buffer_load_dwordx4 v180, s[72:75], s60 offen lds
  s_add_u32 m0, s35, 49152
  s_add_u32 s60, s34, 135168
  buffer_load_dwordx4 v177, s[40:43], s60 offen lds
  s_add_u32 m0, s35, 50176
  s_add_u32 s60, s34, 136192
  buffer_load_dwordx4 v177, s[40:43], s60 offen lds
  s_waitcnt vmcnt(16)
  s_barrier
  s_add_u32 m0, s36, 65536
  s_add_u32 s60, s37, 393216
  buffer_load_dwordx4 v180, s[72:75], s60 offen lds
  s_add_u32 m0, s36, 66560
  s_add_u32 s60, s37, 401408
  buffer_load_dwordx4 v180, s[72:75], s60 offen lds
  s_add_u32 m0, s35, 65536
  s_add_u32 s60, s34, 139264
  buffer_load_dwordx4 v177, s[40:43], s60 offen lds
  s_add_u32 m0, s35, 66560
  s_add_u32 s60, s34, 140288
  buffer_load_dwordx4 v177, s[40:43], s60 offen lds
  s_waitcnt vmcnt(16)
  s_barrier
  s_add_u32 m0, s36, 81920
  s_add_u32 s60, s37, 458752
  buffer_load_dwordx4 v180, s[72:75], s60 offen lds
  s_add_u32 m0, s36, 82944
  s_add_u32 s60, s37, 466944
  buffer_load_dwordx4 v180, s[72:75], s60 offen lds
  s_add_u32 m0, s35, 81920
  s_add_u32 s60, s34, 143360
  buffer_load_dwordx4 v177, s[40:43], s60 offen lds
  s_add_u32 m0, s35, 82944
  s_add_u32 s60, s34, 144384
  buffer_load_dwordx4 v177, s[40:43], s60 offen lds
  s_waitcnt vmcnt(16)
  s_barrier
  s_waitcnt vmcnt(12)
  s_barrier
  s_waitcnt vmcnt(8)
  s_barrier
  s_waitcnt vmcnt(4)
  s_barrier
  s_waitcnt vmcnt(0)
  s_barrier
  s_endpgm
L_k1E_c1:
  v_mfma_f32_16x16x32_bf16 v[36:39], v[32:35], v[48:51], 0
  v_mfma_f32_16x16x32_bf16 v[40:43], v[32:35], v[52:55], 0
  s_branch L_k1E_c1_r
L_k1E_c2:
  v_mfma_f32_16x16x32_bf16 v[36:39], v[32:35], v[56:59], 0
  v_mfma_f32_16x16x32_bf16 v[40:43], v[32:35], v[60:63], 0
  s_branch L_k1E_c2_r
L_k1E_c3:
  v_mfma_f32_16x16x32_bf16 v[12:15], v[32:35], v[128:131], v[12:15]
  v_mfma_f32_16x16x32_bf16 v[12:15], v[32:35], v[132:135], v[12:15]
  v_mfma_f32_32x32x16_bf16 v[96:111], v[128:131], v[128:131], 0
  v_mfma_f32_32x32x16_bf16 v[96:111], v[132:135], v[132:135], v[96:111]
  s_branch L_k1E_c3_r
L_k1E_c4:
  v_mfma_f32_16x16x32_bf16 v[36:39], v[32:35], v[48:51], 0
  v_mfma_f32_16x16x32_bf16 v[40:43], v[32:35], v[52:55], 0
  s_branch L_k1E_c4_r
L_k1E_c5:
  v_mfma_f32_16x16x32_bf16 v[36:39], v[32:35], v[56:59], 0
  v_mfma_f32_16x16x32_bf16 v[40:43], v[32:35], v[60:63], 0
  s_branch L_k1E_c5_r
L_k1E_c6:
  v_mfma_f32_16x16x32_bf16 v[12:15], v[32:35], v[136:139], v[12:15]
  v_mfma_f32_16x16x32_bf16 v[12:15], v[32:35], v[140:143], v[12:15]
  v_mfma_f32_32x32x16_bf16 v[96:111], v[136:139], v[136:139], 0
  v_mfma_f32_32x32x16_bf16 v[96:111], v[140:143], v[140:143], v[96:111]
  s_branch L_k1E_c6_r
L_k1E_c7:
  v_mfma_f32_16x16x32_bf16 v[36:39], v[32:35], v[48:51], v[36:39]
  v_mfma_f32_16x16x32_bf16 v[40:43], v[32:35], v[52:55], v[40:43]
  s_branch L_k1E_c7_r
L_k1E_c8:
  v_mfma_f32_16x16x32_bf16 v[36:39], v[32:35], v[56:59], v[36:39]
  v_mfma_f32_16x16x32_bf16 v[40:43], v[32:35], v[60:63], v[40:43]
  s_branch L_k1E_c8_r
L_k1E_c9:
  v_mfma_f32_16x16x32_bf16 v[12:15], v[32:35], v[144:147], v[12:15]
  v_mfma_f32_16x16x32_bf16 v[12:15], v[32:35], v[148:151], v[12:15]
  v_mfma_f32_32x32x16_bf16 v[96:111], v[144:147], v[144:147], v[96:111]
  v_mfma_f32_32x32x16_bf16 v[96:111], v[148:151], v[148:151], v[96:111]
  s_branch L_k1E_c9_r
L_k1E_c10:
  v_mfma_f32_16x16x32_bf16 v[36:39], v[32:35], v[48:51], v[36:39]
  v_mfma_f32_16x16x32_bf16 v[40:43], v[32:35], v[52:55], v[40:43]
  s_branch L_k1E_c10_r
L_k1E_c11:
  v_mfma_f32_16x16x32_bf16 v[36:39], v[32:35], v[56:59], v[36:39]
  v_mfma_f32_16x16x32_bf16 v[40:43], v[32:35], v[60:63], v[40:43]
  s_branch L_k1E_c11_r
L_k1E_c12:
  v_mfma_f32_16x16x32_bf16 v[12:15], v[32:35], v[152:155], v[12:15]
  v_mfma_f32_16x16x32_bf16 v[12:15], v[32:35], v[156:159], v[12:15]
  v_mfma_f32_32x32x16_bf16 v[96:111], v[152:155], v[152:155], v[96:111]
  v_mfma_f32_32x32x16_bf16 v[96:111], v[156:159], v[156:159], v[96:111]
  s_branch L_k1E_c12_r
L_k1E_c13:
  v_mfma_f32_16x16x32_bf16 v[36:39], v[32:35], v[48:51], v[36:39]
  v_mfma_f32_16x16x32_bf16 v[40:43], v[32:35], v[52:55], v[40:43]
  s_branch L_k1E_c13_r
L_k1E_c14:
  v_mfma_f32_16x16x32_bf16 v[36:39], v[32:35], v[56:59], v[36:39]
  v_mfma_f32_16x16x32_bf16 v[40:43], v[32:35], v[60:63], v[40:43]
  s_branch L_k1E_c14_r
L_k1E_c15:
  v_mfma_f32_16x16x32_bf16 v[12:15], v[32:35], v[160:163], v[12:15]
  v_mfma_f32_16x16x32_bf16 v[12:15], v[32:35], v[164:167], v[12:15]
  v_mfma_f32_32x32x16_bf16 v[96:111], v[160:163], v[160:163], v[96:111]
  v_mfma_f32_32x32x16_bf16 v[96:111], v[164:167], v[164:167], v[96:111]
  s_branch L_k1E_c15_r
L_k1E_c16:
  v_mfma_f32_16x16x32_bf16 v[36:39], v[32:35], v[48:51], v[36:39]
  v_mfma_f32_16x16x32_bf16 v[40:43], v[32:35], v[52:55], v[40:43]
  s_branch L_k1E_c16_r
L_k1E_c17:
  v_mfma_f32_16x16x32_bf16 v[36:39], v[32:35], v[56:59], v[36:39]
  v_mfma_f32_16x16x32_bf16 v[40:43], v[32:35], v[60:63], v[40:43]
  s_branch L_k1E_c17_r
L_k1E_c18:
  v_mfma_f32_16x16x32_bf16 v[12:15], v[32:35], v[168:171], v[12:15]
  v_mfma_f32_16x16x32_bf16 v[12:15], v[32:35], v[172:175], v[12:15]
  v_mfma_f32_32x32x16_bf16 v[96:111], v[168:171], v[168:171], v[96:111]
  v_mfma_f32_32x32x16_bf16 v[96:111], v[172:175], v[172:175], v[96:111]
  s_branch L_k1E_c18_r
L_k1E_c19:
  v_mfma_f32_16x16x32_bf16 v[36:39], v[32:35], v[48:51], v[36:39]
  v_mfma_f32_16x16x32_bf16 v[40:43], v[32:35], v[52:55], v[40:43]
  s_branch L_k1E_c19_r
L_k1E_c20:
  v_mfma_f32_16x16x32_bf16 v[36:39], v[32:35], v[56:59], v[36:39]
  v_mfma_f32_16x16x32_bf16 v[40:43], v[32:35], v[60:63], v[40:43]
  s_branch L_k1E_c20_r
L_k1E_c21:
  v_mfma_f32_16x16x32_bf16 v[12:15], v[32:35], v[176:179], v[12:15]
  v_mfma_f32_16x16x32_bf16 v[12:15], v[32:35], v[180:183], v[12:15]
  v_mfma_f32_32x32x16_bf16 v[96:111], v[176:179], v[176:179], v[96:111]
  v_mfma_f32_32x32x16_bf16 v[96:111], v[180:183], v[180:183], v[96:111]
  s_branch L_k1E_c21_r
L_k1E_c22:
  v_mfma_f32_16x16x32_bf16 v[36:39], v[32:35], v[48:51], v[36:39]
  v_mfma_f32_16x16x32_bf16 v[40:43], v[32:35], v[52:55], v[40:43]
  s_branch L_k1E_c22_r
L_k1E_c23:
  v_mfma_f32_16x16x32_bf16 v[36:39], v[32:35], v[56:59], v[36:39]
  v_mfma_f32_16x16x32_bf16 v[40:43], v[32:35], v[60:63], v[40:43]
  s_branch L_k1E_c23_r
L_k1E_c24:
  v_mfma_f32_16x16x32_bf16 v[12:15], v[32:35], v[184:187], v[12:15]
  v_mfma_f32_16x16x32_bf16 v[12:15], v[32:35], v[188:191], v[12:15]
  v_mfma_f32_32x32x16_bf16 v[96:111], v[184:187], v[184:187], v[96:111]
  v_mfma_f32_32x32x16_bf16 v[96:111], v[188:191], v[188:191], v[96:111]
  s_branch L_k1E_c24_r
L_k1E_c25:
  v_mfma_f32_16x16x32_bf16 v[36:39], v[32:35], v[48:51], v[36:39]
  v_mfma_f32_16x16x32_bf16 v[40:43], v[32:35], v[52:55], v[40:43]
  s_branch L_k1E_c25_r
L_k1E_c26:
  v_mfma_f32_16x16x32_bf16 v[36:39], v[32:35], v[56:59], v[36:39]
  v_mfma_f32_16x16x32_bf16 v[40:43], v[32:35], v[60:63], v[40:43]
  s_branch L_k1E_c26_r
L_k1E_c27:
  v_mfma_f32_16x16x32_bf16 v[12:15], v[32:35], v[192:195], v[12:15]
  v_mfma_f32_16x16x32_bf16 v[12:15], v[32:35], v[196:199], v[12:15]
  v_mfma_f32_32x32x16_bf16 v[96:111], v[192:195], v[192:195], v[96:111]
  v_mfma_f32_32x32x16_bf16 v[96:111], v[196:199], v[196:199], v[96:111]
  s_branch L_k1E_c27_r
L_k1E_c28:
  v_mfma_f32_16x16x32_bf16 v[36:39], v[32:35], v[48:51], v[36:39]
  v_mfma_f32_16x16x32_bf16 v[40:43], v[32:35], v[52:55], v[40:43]
  s_branch L_k1E_c28_r
L_k1E_c29:
  v_mfma_f32_16x16x32_bf16 v[36:39], v[32:35], v[56:59], v[36:39]
  v_mfma_f32_16x16x32_bf16 v[40:43], v[32:35], v[60:63], v[40:43]
  s_branch L_k1E_c29_r
L_k1E_c30:
  v_mfma_f32_16x16x32_bf16 v[12:15], v[32:35], v[200:203], v[12:15]
  v_mfma_f32_16x16x32_bf16 v[12:15], v[32:35], v[204:207], v[12:15]
  v_mfma_f32_32x32x16_bf16 v[96:111], v[200:203], v[200:203], v[96:111]
  v_mfma_f32_32x32x16_bf16 v[96:111], v[204:207], v[204:207], v[96:111]
  s_branch L_k1E_c30_r
L_k1E_c31:
  v_mfma_f32_16x16x32_bf16 v[36:39], v[32:35], v[48:51], v[36:39]
  v_mfma_f32_16x16x32_bf16 v[40:43], v[32:35], v[52:55], v[40:43]
  s_branch L_k1E_c31_r
L_k1E_c32:
  v_mfma_f32_16x16x32_bf16 v[36:39], v[32:35], v[56:59], v[36:39]
  v_mfma_f32_16x16x32_bf16 v[40:43], v[32:35], v[60:63], v[40:43]
  s_branch L_k1E_c32_r
L_k1E_c33:
  v_mfma_f32_16x16x32_bf16 v[12:15], v[32:35], v[208:211], v[12:15]
  v_mfma_f32_16x16x32_bf16 v[12:15], v[32:35], v[212:215], v[12:15]
  v_mfma_f32_32x32x16_bf16 v[96:111], v[208:211], v[208:211], v[96:111]
  v_mfma_f32_32x32x16_bf16 v[96:111], v[212:215], v[212:215], v[96:111]
  s_branch L_k1E_c33_r
L_k1E_c34:
  v_mfma_f32_16x16x32_bf16 v[36:39], v[32:35], v[48:51], v[36:39]
  v_mfma_f32_16x16x32_bf16 v[40:43], v[32:35], v[52:55], v[40:43]
  s_branch L_k1E_c34_r
L_k1E_c35:
  v_mfma_f32_16x16x32_bf16 v[36:39], v[32:35], v[56:59], v[36:39]
  v_mfma_f32_16x16x32_bf16 v[40:43], v[32:35], v[60:63], v[40:43]
  s_branch L_k1E_c35_r
L_k1E_c36:
  v_mfma_f32_16x16x32_bf16 v[12:15], v[32:35], v[216:219], v[12:15]
  v_mfma_f32_16x16x32_bf16 v[12:15], v[32:35], v[220:223], v[12:15]
  v_mfma_f32_32x32x16_bf16 v[96:111], v[216:219], v[216:219], v[96:111]
  v_mfma_f32_32x32x16_bf16 v[96:111], v[220:223], v[220:223], v[96:111]
  s_branch L_k1E_c36_r
L_k1E_c37:
  v_mfma_f32_16x16x32_bf16 v[36:39], v[32:35], v[48:51], v[36:39]
  v_mfma_f32_16x16x32_bf16 v[40:43], v[32:35], v[52:55], v[40:43]
  s_branch L_k1E_c37_r
L_k1E_c38:
  v_mfma_f32_16x16x32_bf16 v[36:39], v[32:35], v[56:59], v[36:39]
  v_mfma_f32_16x16x32_bf16 v[40:43], v[32:35], v[60:63], v[40:43]
  s_branch L_k1E_c38_r
L_k1E_c39:
  v_mfma_f32_16x16x32_bf16 v[12:15], v[32:35], v[224:227], v[12:15]
  v_mfma_f32_16x16x32_bf16 v[12:15], v[32:35], v[228:231], v[12:15]
  v_mfma_f32_32x32x16_bf16 v[96:111], v[224:227], v[224:227], v[96:111]
  v_mfma_f32_32x32x16_bf16 v[96:111], v[228:231], v[228:231], v[96:111]
  s_branch L_k1E_c39_r
L_k1E_c40:
  v_mfma_f32_16x16x32_bf16 v[36:39], v[32:35], v[48:51], v[36:39]
  v_mfma_f32_16x16x32_bf16 v[40:43], v[32:35], v[52:55], v[40:43]
  s_branch L_k1E_c40_r
L_k1E_c41:
  v_mfma_f32_16x16x32_bf16 v[36:39], v[32:35], v[56:59], v[36:39]
  v_mfma_f32_16x16x32_bf16 v[40:43], v[32:35], v[60:63], v[40:43]
  s_branch L_k1E_c41_r
L_k1E_c42:
  v_mfma_f32_16x16x32_bf16 v[12:15], v[32:35], v[232:235], v[12:15]
  v_mfma_f32_16x16x32_bf16 v[12:15], v[32:35], v[236:239], v[12:15]
  v_mfma_f32_32x32x16_bf16 v[96:111], v[232:235], v[232:235], v[96:111]
  v_mfma_f32_32x32x16_bf16 v[96:111], v[236:239], v[236:239], v[96:111]
  s_branch L_k1E_c42_r
L_k1E_c43:
  v_mfma_f32_16x16x32_bf16 v[36:39], v[32:35], v[48:51], v[36:39]
  v_mfma_f32_16x16x32_bf16 v[40:43], v[32:35], v[52:55], v[40:43]
  s_branch L_k1E_c43_r
L_k1E_c44:
  v_mfma_f32_16x16x32_bf16 v[36:39], v[32:35], v[56:59], v[36:39]
  v_mfma_f32_16x16x32_bf16 v[40:43], v[32:35], v[60:63], v[40:43]
  s_branch L_k1E_c44_r
L_k1E_c45:
  v_mfma_f32_16x16x32_bf16 v[12:15], v[32:35], v[240:243], v[12:15]
  v_mfma_f32_16x16x32_bf16 v[12:15], v[32:35], v[244:247], v[12:15]
  v_mfma_f32_32x32x16_bf16 v[96:111], v[240:243], v[240:243], v[96:111]
  v_mfma_f32_32x32x16_bf16 v[96:111], v[244:247], v[244:247], v[96:111]
  s_branch L_k1E_c45_r
L_k1E_c46:
  v_mfma_f32_16x16x32_bf16 v[36:39], v[32:35], v[48:51], v[36:39]
  v_mfma_f32_16x16x32_bf16 v[40:43], v[32:35], v[52:55], v[40:43]
  s_branch L_k1E_c46_r
L_k1E_c47:
  v_mfma_f32_16x16x32_bf16 v[36:39], v[32:35], v[56:59], v[36:39]
  v_mfma_f32_16x16x32_bf16 v[40:43], v[32:35], v[60:63], v[40:43]
  s_branch L_k1E_c47_r
L_k1E_c48:
  v_mfma_f32_16x16x32_bf16 v[12:15], v[32:35], v[248:251], v[12:15]
  v_mfma_f32_16x16x32_bf16 v[12:15], v[32:35], v[252:255], v[12:15]
  v_mfma_f32_32x32x16_bf16 v[96:111], v[248:251], v[248:251], v[96:111]
  v_mfma_f32_32x32x16_bf16 v[96:111], v[252:255], v[252:255], v[96:111]
  s_branch L_k1E_c48_r
L_k1E_c49:
  v_mfma_f32_16x16x32_bf16 v[36:39], v[32:35], v[48:51], 0
  v_mfma_f32_16x16x32_bf16 v[40:43], v[32:35], v[52:55], 0
  s_branch L_k1E_c49_r
L_k1E_c50:
  v_mfma_f32_16x16x32_bf16 v[36:39], v[32:35], v[56:59], 0
  v_mfma_f32_16x16x32_bf16 v[40:43], v[32:35], v[60:63], 0
  s_branch L_k1E_c50_r
L_k1E_c51:
  v_mfma_f32_16x16x32_bf16 v[36:39], v[32:35], v[48:51], 0
  v_mfma_f32_16x16x32_bf16 v[40:43], v[32:35], v[52:55], 0
  s_branch L_k1E_c51_r
L_k1E_c52:
  v_mfma_f32_16x16x32_bf16 v[36:39], v[32:35], v[56:59], 0
  v_mfma_f32_16x16x32_bf16 v[40:43], v[32:35], v[60:63], 0
  s_branch L_k1E_c52_r
L_k1E_c53:
  v_mfma_f32_16x16x32_bf16 v[36:39], v[32:35], v[48:51], v[36:39]
  v_mfma_f32_16x16x32_bf16 v[40:43], v[32:35], v[52:55], v[40:43]
  s_branch L_k1E_c53_r
L_k1E_c54:
  v_mfma_f32_16x16x32_bf16 v[36:39], v[32:35], v[56:59], v[36:39]
  v_mfma_f32_16x16x32_bf16 v[40:43], v[32:35], v[60:63], v[40:43]
  s_branch L_k1E_c54_r
L_k1E_c55:
  v_mfma_f32_16x16x32_bf16 v[36:39], v[32:35], v[48:51], v[36:39]
  v_mfma_f32_16x16x32_bf16 v[40:43], v[32:35], v[52:55], v[40:43]
  s_branch L_k1E_c55_r
L_k1E_c56:
  v_mfma_f32_16x16x32_bf16 v[36:39], v[32:35], v[56:59], v[36:39]
  v_mfma_f32_16x16x32_bf16 v[40:43], v[32:35], v[60:63], v[40:43]
  s_branch L_k1E_c56_r
L_k1E_c57:
  v_mfma_f32_16x16x32_bf16 v[36:39], v[32:35], v[48:51], v[36:39]
  v_mfma_f32_16x16x32_bf16 v[40:43], v[32:35], v[52:55], v[40:43]
  s_branch L_k1E_c57_r
L_k1E_c58:
  v_mfma_f32_16x16x32_bf16 v[36:39], v[32:35], v[56:59], v[36:39]
  v_mfma_f32_16x16x32_bf16 v[40:43], v[32:35], v[60:63], v[40:43]
  s_branch L_k1E_c58_r
L_k1E_c59:
  v_mfma_f32_16x16x32_bf16 v[36:39], v[32:35], v[48:51], v[36:39]
  v_mfma_f32_16x16x32_bf16 v[40:43], v[32:35], v[52:55], v[40:43]
  s_branch L_k1E_c59_r
L_k1E_c60:
  v_mfma_f32_16x16x32_bf16 v[36:39], v[32:35], v[56:59], v[36:39]
  v_mfma_f32_16x16x32_bf16 v[40:43], v[32:35], v[60:63], v[40:43]
  s_branch L_k1E_c60_r
L_k1E_c61:
  v_mfma_f32_16x16x32_bf16 v[36:39], v[32:35], v[48:51], v[36:39]
  v_mfma_f32_16x16x32_bf16 v[40:43], v[32:35], v[52:55], v[40:43]
  s_branch L_k1E_c61_r
L_k1E_c62:
  v_mfma_f32_16x16x32_bf16 v[36:39], v[32:35], v[56:59], v[36:39]
  v_mfma_f32_16x16x32_bf16 v[40:43], v[32:35], v[60:63], v[40:43]
  s_branch L_k1E_c62_r
L_k1E_c63:
  v_mfma_f32_16x16x32_bf16 v[36:39], v[32:35], v[48:51], v[36:39]
  v_mfma_f32_16x16x32_bf16 v[40:43], v[32:35], v[52:55], v[40:43]
  s_branch L_k1E_c63_r
L_k1E_c64:
  v_mfma_f32_16x16x32_bf16 v[36:39], v[32:35], v[56:59], v[36:39]
  v_mfma_f32_16x16x32_bf16 v[40:43], v[32:35], v[60:63], v[40:43]
  s_branch L_k1E_c64_r
L_k1E_c65:
  v_mfma_f32_16x16x32_bf16 v[36:39], v[32:35], v[48:51], v[36:39]
  v_mfma_f32_16x16x32_bf16 v[40:43], v[32:35], v[52:55], v[40:43]
  s_branch L_k1E_c65_r
L_k1E_c66:
  v_mfma_f32_16x16x32_bf16 v[36:39], v[32:35], v[56:59], v[36:39]
  v_mfma_f32_16x16x32_bf16 v[40:43], v[32:35], v[60:63], v[40:43]
  s_branch L_k1E_c66_r
L_k1E_c67:
  v_mfma_f32_16x16x32_bf16 v[36:39], v[32:35], v[48:51], v[36:39]
  v_mfma_f32_16x16x32_bf16 v[40:43], v[32:35], v[52:55], v[40:43]
  s_branch L_k1E_c67_r
L_k1E_c68:
  v_mfma_f32_16x16x32_bf16 v[36:39], v[32:35], v[56:59], v[36:39]
  v_mfma_f32_16x16x32_bf16 v[40:43], v[32:35], v[60:63], v[40:43]
  s_branch L_k1E_c68_r
L_k1E_c69:
  v_mfma_f32_16x16x32_bf16 v[36:39], v[32:35], v[48:51], v[36:39]
  v_mfma_f32_16x16x32_bf16 v[40:43], v[32:35], v[52:55], v[40:43]
  s_branch L_k1E_c69_r
L_k1E_c70:
  v_mfma_f32_16x16x32_bf16 v[36:39], v[32:35], v[56:59], v[36:39]
  v_mfma_f32_16x16x32_bf16 v[40:43], v[32:35], v[60:63], v[40:43]
  s_branch L_k1E_c70_r
L_k1E_c71:
  v_mfma_f32_16x16x32_bf16 v[36:39], v[32:35], v[48:51], v[36:39]
  v_mfma_f32_16x16x32_bf16 v[40:43], v[32:35], v[52:55], v[40:43]
  s_branch L_k1E_c71_r
L_k1E_c72:
  v_mfma_f32_16x16x32_bf16 v[36:39], v[32:35], v[56:59], v[36:39]
  v_mfma_f32_16x16x32_bf16 v[40:43], v[32:35], v[60:63], v[40:43]
  s_branch L_k1E_c72_r
L_k1E_c73:
  v_mfma_f32_16x16x32_bf16 v[36:39], v[32:35], v[48:51], v[36:39]
  v_mfma_f32_16x16x32_bf16 v[40:43], v[32:35], v[52:55], v[40:43]
  s_branch L_k1E_c73_r
L_k1E_c74:
  v_mfma_f32_16x16x32_bf16 v[36:39], v[32:35], v[56:59], v[36:39]
  v_mfma_f32_16x16x32_bf16 v[40:43], v[32:35], v[60:63], v[40:43]
  s_branch L_k1E_c74_r
L_k1E_c75:
  v_mfma_f32_16x16x32_bf16 v[36:39], v[32:35], v[48:51], v[36:39]
  v_mfma_f32_16x16x32_bf16 v[40:43], v[32:35], v[52:55], v[40:43]
  s_branch L_k1E_c75_r
L_k1E_c76:
  v_mfma_f32_16x16x32_bf16 v[36:39], v[32:35], v[56:59], v[36:39]
  v_mfma_f32_16x16x32_bf16 v[40:43], v[32:35], v[60:63], v[40:43]
  s_branch L_k1E_c76_r
L_k1E_c77:
  v_mfma_f32_16x16x32_bf16 v[36:39], v[32:35], v[48:51], v[36:39]
  v_mfma_f32_16x16x32_bf16 v[40:43], v[32:35], v[52:55], v[40:43]
  s_branch L_k1E_c77_r
L_k1E_c78:
  v_mfma_f32_16x16x32_bf16 v[36:39], v[32:35], v[56:59], v[36:39]
  v_mfma_f32_16x16x32_bf16 v[40:43], v[32:35], v[60:63], v[40:43]
  s_branch L_k1E_c78_r
L_k1E_c79:
  v_mfma_f32_16x16x32_bf16 v[36:39], v[32:35], v[48:51], v[36:39]
  v_mfma_f32_16x16x32_bf16 v[40:43], v[32:35], v[52:55], v[40:43]
  s_branch L_k1E_c79_r
L_k1E_c80:
  v_mfma_f32_16x16x32_bf16 v[36:39], v[32:35], v[56:59], v[36:39]
  v_mfma_f32_16x16x32_bf16 v[40:43], v[32:35], v[60:63], v[40:43]
  s_branch L_k1E_c80_r
L_k1E_c81:
  v_mfma_f32_16x16x32_bf16 v[36:39], v[32:35], v[48:51], 0
  v_mfma_f32_16x16x32_bf16 v[36:39], v[32:35], v[52:55], v[36:39]
  s_branch L_k1E_c81_r
L_k1E_c82:
  v_mfma_f32_16x16x32_bf16 v[36:39], v[32:35], v[56:59], 0
  v_mfma_f32_16x16x32_bf16 v[36:39], v[32:35], v[60:63], v[36:39]
  s_branch L_k1E_c82_r
L_k1E_c83:
  v_mfma_f32_16x16x32_bf16 v[36:39], v[32:35], v[48:51], 0
  v_mfma_f32_16x16x32_bf16 v[36:39], v[32:35], v[52:55], v[36:39]
  s_branch L_k1E_c83_r
L_k1E_c84:
  v_mfma_f32_16x16x32_bf16 v[36:39], v[32:35], v[56:59], 0
  v_mfma_f32_16x16x32_bf16 v[36:39], v[32:35], v[60:63], v[36:39]
  s_branch L_k1E_c84_r
L_k1E_c85:
  v_mfma_f32_16x16x32_bf16 v[36:39], v[32:35], v[48:51], v[36:39]
  v_mfma_f32_16x16x32_bf16 v[36:39], v[32:35], v[52:55], v[36:39]
  s_branch L_k1E_c85_r
L_k1E_c86:
  v_mfma_f32_16x16x32_bf16 v[36:39], v[32:35], v[56:59], v[36:39]
  v_mfma_f32_16x16x32_bf16 v[36:39], v[32:35], v[60:63], v[36:39]
  s_branch L_k1E_c86_r
L_k1E_c87:
  v_mfma_f32_16x16x32_bf16 v[36:39], v[32:35], v[48:51], v[36:39]
  v_mfma_f32_16x16x32_bf16 v[36:39], v[32:35], v[52:55], v[36:39]
  s_branch L_k1E_c87_r
L_k1E_c88:
  v_mfma_f32_16x16x32_bf16 v[36:39], v[32:35], v[56:59], v[36:39]
  v_mfma_f32_16x16x32_bf16 v[36:39], v[32:35], v[60:63], v[36:39]
  s_branch L_k1E_c88_r
L_k1E_c89:
  v_mfma_f32_16x16x32_bf16 v[36:39], v[32:35], v[48:51], v[36:39]
  v_mfma_f32_16x16x32_bf16 v[36:39], v[32:35], v[52:55], v[36:39]
  s_branch L_k1E_c89_r
L_k1E_c90:
  v_mfma_f32_16x16x32_bf16 v[36:39], v[32:35], v[56:59], v[36:39]
  v_mfma_f32_16x16x32_bf16 v[36:39], v[32:35], v[60:63], v[36:39]
  s_branch L_k1E_c90_r
L_k1E_c91:
  v_mfma_f32_16x16x32_bf16 v[36:39], v[32:35], v[48:51], v[36:39]
  v_mfma_f32_16x16x32_bf16 v[36:39], v[32:35], v[52:55], v[36:39]
  s_branch L_k1E_c91_r
L_k1E_c92:
  v_mfma_f32_16x16x32_bf16 v[36:39], v[32:35], v[56:59], v[36:39]
  v_mfma_f32_16x16x32_bf16 v[36:39], v[32:35], v[60:63], v[36:39]
  s_branch L_k1E_c92_r
L_k1E_c93:
  v_mfma_f32_16x16x32_bf16 v[36:39], v[32:35], v[48:51], v[36:39]
  v_mfma_f32_16x16x32_bf16 v[36:39], v[32:35], v[52:55], v[36:39]
  s_branch L_k1E_c93_r
L_k1E_c94:
  v_mfma_f32_16x16x32_bf16 v[36:39], v[32:35], v[56:59], v[36:39]
  v_mfma_f32_16x16x32_bf16 v[36:39], v[32:35], v[60:63], v[36:39]
  s_branch L_k1E_c94_r
L_k1E_c95:
  v_mfma_f32_16x16x32_bf16 v[36:39], v[32:35], v[48:51], v[36:39]
  v_mfma_f32_16x16x32_bf16 v[36:39], v[32:35], v[52:55], v[36:39]
  s_branch L_k1E_c95_r
L_k1E_c96:
  v_mfma_f32_16x16x32_bf16 v[36:39], v[32:35], v[56:59], v[36:39]
  v_mfma_f32_16x16x32_bf16 v[36:39], v[32:35], v[60:63], v[36:39]
  s_branch L_k1E_c96_r
L_k1_O:
  s_nop 0
  s_add_u32 m0, s54, 16384
  s_bfe_u32 s60, s12, 0x40000
  s_mul_i32 s60, s60, 196608
  s_add_u32 s60, s60, s58
  s_add_u32 s60, s60, 1024
  buffer_load_dwordx4 v9, s[28:31], s60 offen lds
  s_add_u32 m0, s54, 24576
  s_bfe_u32 s60, s12, 0x40000
  s_mul_i32 s60, s60, 196608
  s_add_u32 s60, s60, s58
  s_add_u32 s60, s60, 2048
  buffer_load_dwordx4 v9, s[28:31], s60 offen lds
  s_mov_b32 s40, s22
  s_mov_b32 s41, s23
  s_mov_b32 s42, 0x980000
  s_mov_b32 s43, 0x20000
  s_lshl_b32 s86, s51, 8
  s_add_u32 s86, s86, 0x970000
  s_lshl_b32 s87, s51, 8
  s_add_u32 s87, s87, 0x971000
  s_lshl_b32 s88, s52, 8
  s_add_u32 s88, s88, 0x972000
  s_lshl_b32 s84, s52, 13
  s_add_u32 s84, s84, 0x900000
  v_mov_b32 v28, 0
  v_mov_b32 v29, 0
  v_mov_b32 v30, 0
  v_mov_b32 v31, 0
  v_mov_b32 v17, 0x7ffffff0
  v_cmp_eq_u32 vcc, 0, v0
  s_nop 1
  v_cndmask_b32 v16, v17, v28
  v_mov_b32 v45, 0
  v_mov_b32 v47, 0
  s_mov_b32 s93, 0x7ffffff0
  s_cmp_eq_u32 s83, 0
  s_cselect_b32 s60, s86, s93
  s_cselect_b32 s61, s87, s93
  buffer_store_dword v28, v16, s[40:43], s61 offen sc1
  s_lshl_b32 s61, s51, 8
  s_add_u32 s61, s61, 0x972800
  s_cmp_eq_u32 s83, 0
  s_cselect_b32 s61, s61, s93
  buffer_store_dword v28, v16, s[40:43], s61 offen sc1
  buffer_store_dword v28, v16, s[40:43], s60 offen sc1
  s_cmp_eq_u32 s51, 0
  s_cselect_b32 s60, s87, s93
  s_cselect_b32 s61, s88, s93
  s_cselect_b32 s62, s84, s93
  buffer_store_dword v28, v16, s[40:43], s61 offen sc1
  s_min_u32 s63, s62, 0x7ffefff0
  s_add_u32 s63, s63, s54
  buffer_store_dwordx4 v[28:31], v1, s[40:43], s63 offen sc1
  s_mov_b32 s44, s20
  s_mov_b32 s45, s21
  s_mov_b32 s46, 0x100
  s_mov_b32 s47, 0x20000
  s_lshl_b32 s60, s51, 2
  s_add_u32 s60, s60, s49
  s_mul_i32 s59, s60, 147456
  s_mov_b32 s64, 0xffff
  s_mov_b32 s65, 0xffff
  s_lshl_b32 s60, s50, 12
  s_add_u32 s85, s84, s60
  s_lshl_b32 s91, s51, 2
  s_lshl_b32 s92, s83, 2
  s_add_u32 s92, s92, 128
  s_lshl_b32 s60, s50, 7
  s_add_u32 s95, s60, 0x20000
  s_lshl_b32 s60, s56, 5
  s_add_u32 s66, s59, s60
  s_lshl_b32 s61, s50, 11
  s_add_u32 s66, s66, s61
  s_lshl_b32 s60, s57, 5
  s_add_u32 s67, s59, s60
  s_lshl_b32 s61, s50, 10
  s_add_u32 s67, s67, s61
  v_mov_b32 v5, 0x3f803f80
  v_mov_b32 v28, 0x21200
  v_mov_b32 v30, 0
  v_mov_b32 v31, 0
  ds_write_b64 v28, v[30:31]
  ds_write_b32 v28, v30 offset:8
  v_lshrrev_b32 v28, 9, v1
  v_lshlrev_b32 v28, 3, v28
  v_bfe_u32 v29, v1, 6, 2
  v_add_u32 v28, v28, v29
  v_bfe_u32 v29, v1, 8, 1
  v_bfe_u32 v30, v1, 5, 1
  v_lshl_add_u32 v30, v29, 1, v30
  s_lshl_b32 s60, s50, 2
  v_add_u32 v30, s60, v30
  v_bfe_u32 v31, v1, 7, 1
  v_lshlrev_b32 v31, 2, v31
  v_xor_b32 v30, v30, v31
  v_lshlrev_b32 v30, 4, v30
  v_lshl_add_u32 v6, v28, 7, v30
  v_bfe_u32 v31, v1, 4, 1
  v_lshl_add_u32 v6, v31, 3, v6
  v_add_u32 v7, 0x10000, v6
  v_bfe_u32 v28, v1, 4, 5
  s_lshl_b32 s60, s49, 5
  v_add_u32 v29, s60, v28
  v_lshlrev_b32 v29, 7, v29
  v_bfe_u32 v30, v1, 5, 3
  v_lshrrev_b32 v31, 9, v1
  v_xor_b32 v30, v30, v31
  v_xor_b32 v31, 0, v30
  v_lshl_add_u32 v20, v31, 4, v29
  v_add_u32 v24, 0x10000, v20
  v_xor_b32 v31, 2, v30
  v_lshl_add_u32 v21, v31, 4, v29
  v_add_u32 v25, 0x10000, v21
  v_xor_b32 v31, 4, v30
  v_lshl_add_u32 v22, v31, 4, v29
  v_add_u32 v26, 0x10000, v22
  v_xor_b32 v31, 6, v30
  v_lshl_add_u32 v23, v31, 4, v29
  v_add_u32 v27, 0x10000, v23
  s_add_u32 m0, s55, 32768
  s_bfe_u32 s60, s12, 0x40004
  s_mul_i32 s60, s60, 128
  s_add_u32 s60, s60, s53
  buffer_load_dwordx4 v10, s[24:27], s60 offen lds
  s_add_u32 m0, s55, 33792
  s_bfe_u32 s60, s12, 0x40004
  s_mul_i32 s60, s60, 128
  s_add_u32 s60, s60, s53
  buffer_load_dwordx4 v11, s[24:27], s60 offen lds
  s_add_u32 m0, s54, 49152
  s_bfe_u32 s60, s12, 0x40004
  s_mul_i32 s60, s60, 196608
  s_add_u32 s60, s60, s58
  s_add_u32 s60, s60, 1024
  buffer_load_dwordx4 v9, s[28:31], s60 offen lds
  s_add_u32 m0, s54, 57344
  s_bfe_u32 s60, s12, 0x40004
  s_mul_i32 s60, s60, 196608
  s_add_u32 s60, s60, s58
  s_add_u32 s60, s60, 2048
  buffer_load_dwordx4 v9, s[28:31], s60 offen lds
  s_lshl_b32 s60, s50, 1
  s_add_u32 s60, s60, s49
  s_and_b32 s6, s60, 3
  s_lshl_b32 s60, s50, 10
  s_add_u32 s4, s60, 0x22000
  s_lshl_b32 s60, s49, 2
  s_add_u32 s5, s4, s60
  v_bfe_u32 v28, v1, 4, 4
  v_bfe_u32 v29, v1, 8, 1
  v_cmp_eq_u32 vcc, v28, v29
  v_mov_b32 v30, 0x3f803f80
  v_mov_b32 v31, 0
  v_cndmask_b32 v32, v31, v30
  v_cndmask_b32 v33, v31, v30
  v_cndmask_b32 v34, v31, v30
  v_cndmask_b32 v35, v31, v30
  v_mov_b32 v12, 0
  v_mov_b32 v13, 0
  v_mov_b32 v14, 0
  v_mov_b32 v15, 0
  s_waitcnt vmcnt(9)
  s_waitcnt vmcnt(4)
  s_waitcnt lgkmcnt(0)
  s_barrier
  v_add_u32 v28, s54, v1
  v_mov_b32 v29, 0x7ffffff0
  v_cmp_ne_u32 vcc, 0, v28
  s_nop 1
  v_cndmask_b32 v28, v28, v29
  v_mov_b32 v29, 1
  s_lshl_b32 s60, s52, 2
  s_add_u32 s60, s60, 192
  s_cmp_eq_u32 s51, 0
  s_cselect_b32 s60, s60, 0x7ffffff0
  buffer_store_dword v29, v28, s[44:47], s60 offen sc1
  v_add_u32 v28, s54, v1
  v_mov_b32 v29, 0x7ffffff0
  v_cmp_ne_u32 vcc, 0, v28
  s_nop 1
  v_cndmask_b32 v28, v28, v29
  v_mov_b32 v29, 1
  s_mov_b32 s61, 0x7ffffff0
  s_cmp_eq_u32 s83, 0
  s_cselect_b32 s60, s91, s61
  buffer_store_dword v29, v28, s[44:47], s60 offen sc1
  s_memtime s[22:23]
  ds_read_b128 v[128:131], v20 offset:0
  ds_read_b64_tr_b16 v[48:49], v6 offset:16384
  ds_read_b64_tr_b16 v[50:51], v6 offset:16896
  ds_read_b64_tr_b16 v[52:53], v6 offset:24576
  ds_read_b64_tr_b16 v[54:55], v6 offset:25088
  s_waitcnt lgkmcnt(2)
  v_mfma_f32_32x32x16_bf16 v[64:79], v[128:131], v[48:51], 0
  ds_read_b128 v[132:135], v21 offset:0
  ds_read_b64_tr_b16 v[56:57], v6 offset:18432
  ds_read_b64_tr_b16 v[58:59], v6 offset:18944
  s_waitcnt lgkmcnt(3)
  v_mfma_f32_32x32x16_bf16 v[80:95], v[128:131], v[52:55], 0
  s_cmp_eq_u32 s6, 0
  s_cbranch_scc1 L_k1O_c1
L_k1O_c1_r:
  ds_read_b64_tr_b16 v[60:61], v6 offset:26624
  ds_read_b64_tr_b16 v[62:63], v6 offset:27136
  s_add_u32 m0, s55, 65536
  s_bfe_u32 s60, s12, 0x40008
  s_mul_i32 s60, s60, 128
  s_add_u32 s60, s60, s53
  buffer_load_dwordx4 v10, s[24:27], s60 offen lds
  s_waitcnt lgkmcnt(2)
  v_mfma_f32_32x32x16_bf16 v[64:79], v[132:135], v[56:59], v[64:79]
  ds_read_b128 v[136:139], v22 offset:0
  ds_read_b64_tr_b16 v[48:49], v6 offset:20480
  ds_read_b64_tr_b16 v[50:51], v6 offset:20992
  s_waitcnt lgkmcnt(3)
  v_mfma_f32_32x32x16_bf16 v[80:95], v[132:135], v[60:63], v[80:95]
  s_cmp_eq_u32 s6, 1
  s_cbranch_scc1 L_k1O_c2
L_k1O_c2_r:
  ds_read_b64_tr_b16 v[52:53], v6 offset:28672
  ds_read_b64_tr_b16 v[54:55], v6 offset:29184
  s_add_u32 m0, s55, 66560
  s_bfe_u32 s60, s12, 0x40008
  s_mul_i32 s60, s60, 128
  s_add_u32 s60, s60, s53
  buffer_load_dwordx4 v11, s[24:27], s60 offen lds
  s_cmp_eq_u32 s50, 0
  s_cbranch_scc1 L_k1O_c3
L_k1O_c3_r:
  s_waitcnt lgkmcnt(2)
  v_mfma_f32_32x32x16_bf16 v[64:79], v[136:139], v[48:51], v[64:79]
  ds_read_b128 v[140:143], v23 offset:0
  ds_read_b64_tr_b16 v[56:57], v6 offset:22528
  ds_read_b64_tr_b16 v[58:59], v6 offset:23040
  s_waitcnt lgkmcnt(3)
  v_mfma_f32_32x32x16_bf16 v[80:95], v[136:139], v[52:55], v[80:95]
  s_cmp_eq_u32 s6, 2
  s_cbranch_scc1 L_k1O_c4
L_k1O_c4_r:
  ds_read_b64_tr_b16 v[60:61], v6 offset:30720
  ds_read_b64_tr_b16 v[62:63], v6 offset:31232
  s_add_u32 m0, s54, 81920
  s_bfe_u32 s60, s12, 0x40008
  s_mul_i32 s60, s60, 196608
  s_add_u32 s60, s60, s58
  s_add_u32 s60, s60, 1024
  buffer_load_dwordx4 v9, s[28:31], s60 offen lds
  s_waitcnt vmcnt(5)
  s_barrier
  s_waitcnt lgkmcnt(2)
  v_mfma_f32_32x32x16_bf16 v[64:79], v[140:143], v[56:59], v[64:79]
  ds_read_b128 v[144:147], v20 offset:32768
  ds_read_b64_tr_b16 v[48:49], v6 offset:49152
  ds_read_b64_tr_b16 v[50:51], v6 offset:49664
  s_waitcnt lgkmcnt(3)
  v_mfma_f32_32x32x16_bf16 v[80:95], v[140:143], v[60:63], v[80:95]
  s_cmp_eq_u32 s6, 3
  s_cbranch_scc1 L_k1O_c5
L_k1O_c5_r:
  ds_read_b64_tr_b16 v[52:53], v6 offset:57344
  ds_read_b64_tr_b16 v[54:55], v6 offset:57856
  s_add_u32 m0, s54, 90112
  s_bfe_u32 s60, s12, 0x40008
  s_mul_i32 s60, s60, 196608
  s_add_u32 s60, s60, s58
  s_add_u32 s60, s60, 2048
  buffer_load_dwordx4 v9, s[28:31], s60 offen lds
  s_cmp_eq_u32 s50, 1
  s_cbranch_scc1 L_k1O_c6
L_k1O_c6_r:
  s_waitcnt lgkmcnt(2)
  v_mfma_f32_32x32x16_bf16 v[64:79], v[144:147], v[48:51], v[64:79]
  ds_read_b128 v[148:151], v21 offset:32768
  ds_read_b64_tr_b16 v[56:57], v6 offset:51200
  ds_read_b64_tr_b16 v[58:59], v6 offset:51712
  s_waitcnt lgkmcnt(3)
  v_mfma_f32_32x32x16_bf16 v[80:95], v[144:147], v[52:55], v[80:95]
  s_cmp_eq_u32 s6, 0
  s_cbranch_scc1 L_k1O_c7
L_k1O_c7_r:
  ds_read_b64_tr_b16 v[60:61], v6 offset:59392
  ds_read_b64_tr_b16 v[62:63], v6 offset:59904
  s_add_u32 m0, s55, 98304
  s_bfe_u32 s60, s12, 0x4000c
  s_mul_i32 s60, s60, 128
  s_add_u32 s60, s60, s53
  buffer_load_dwordx4 v10, s[24:27], s60 offen lds
  s_waitcnt lgkmcnt(2)
  v_mfma_f32_32x32x16_bf16 v[64:79], v[148:151], v[56:59], v[64:79]
  ds_read_b128 v[152:155], v22 offset:32768
  ds_read_b64_tr_b16 v[48:49], v6 offset:53248
  ds_read_b64_tr_b16 v[50:51], v6 offset:53760
  s_waitcnt lgkmcnt(3)
  v_mfma_f32_32x32x16_bf16 v[80:95], v[148:151], v[60:63], v[80:95]
  s_cmp_eq_u32 s6, 1
  s_cbranch_scc1 L_k1O_c8
L_k1O_c8_r:
  ds_read_b64_tr_b16 v[52:53], v6 offset:61440
  ds_read_b64_tr_b16 v[54:55], v6 offset:61952
  s_add_u32 m0, s55, 99328
  s_bfe_u32 s60, s12, 0x4000c
  s_mul_i32 s60, s60, 128
  s_add_u32 s60, s60, s53
  buffer_load_dwordx4 v11, s[24:27], s60 offen lds
  s_cmp_eq_u32 s50, 0
  s_cbranch_scc1 L_k1O_c9
L_k1O_c9_r:
  s_waitcnt lgkmcnt(2)
  v_mfma_f32_32x32x16_bf16 v[64:79], v[152:155], v[48:51], v[64:79]
  ds_read_b128 v[156:159], v23 offset:32768
  ds_read_b64_tr_b16 v[56:57], v6 offset:55296
  ds_read_b64_tr_b16 v[58:59], v6 offset:55808
  s_waitcnt lgkmcnt(3)
  v_mfma_f32_32x32x16_bf16 v[80:95], v[152:155], v[52:55], v[80:95]
  s_cmp_eq_u32 s6, 2
  s_cbranch_scc1 L_k1O_c10
L_k1O_c10_r:
  ds_read_b64_tr_b16 v[60:61], v6 offset:63488
  ds_read_b64_tr_b16 v[62:63], v6 offset:64000
  s_add_u32 m0, s54, 114688
  s_bfe_u32 s60, s12, 0x4000c
  s_mul_i32 s60, s60, 196608
  s_add_u32 s60, s60, s58
  s_add_u32 s60, s60, 1024
  buffer_load_dwordx4 v9, s[28:31], s60 offen lds
  s_waitcnt vmcnt(3)
  s_barrier
  s_waitcnt lgkmcnt(2)
  v_mfma_f32_32x32x16_bf16 v[64:79], v[156:159], v[56:59], v[64:79]
  ds_read_b128 v[160:163], v24 offset:0
  ds_read_b64_tr_b16 v[48:49], v7 offset:16384
  ds_read_b64_tr_b16 v[50:51], v7 offset:16896
  s_waitcnt lgkmcnt(3)
  v_mfma_f32_32x32x16_bf16 v[80:95], v[156:159], v[60:63], v[80:95]
  s_cmp_eq_u32 s6, 3
  s_cbranch_scc1 L_k1O_c11
L_k1O_c11_r:
  ds_read_b64_tr_b16 v[52:53], v7 offset:24576
  ds_read_b64_tr_b16 v[54:55], v7 offset:25088
  s_add_u32 m0, s54, 122880
  s_bfe_u32 s60, s12, 0x4000c
  s_mul_i32 s60, s60, 196608
  s_add_u32 s60, s60, s58
  s_add_u32 s60, s60, 2048
  buffer_load_dwordx4 v9, s[28:31], s60 offen lds
  s_cmp_eq_u32 s50, 1
  s_cbranch_scc1 L_k1O_c12
L_k1O_c12_r:
  s_waitcnt lgkmcnt(2)
  v_mfma_f32_32x32x16_bf16 v[64:79], v[160:163], v[48:51], v[64:79]
  ds_read_b128 v[164:167], v25 offset:0
  ds_read_b64_tr_b16 v[56:57], v7 offset:18432
  ds_read_b64_tr_b16 v[58:59], v7 offset:18944
  s_waitcnt lgkmcnt(3)
  v_mfma_f32_32x32x16_bf16 v[80:95], v[160:163], v[52:55], v[80:95]
  s_cmp_eq_u32 s6, 0
  s_cbranch_scc1 L_k1O_c13
L_k1O_c13_r:
  ds_read_b64_tr_b16 v[60:61], v7 offset:26624
  ds_read_b64_tr_b16 v[62:63], v7 offset:27136
  s_add_u32 m0, s55, 0
  s_bfe_u32 s60, s12, 0x40010
  s_mul_i32 s60, s60, 128
  s_add_u32 s60, s60, s53
  buffer_load_dwordx4 v10, s[24:27], s60 offen lds
  s_waitcnt lgkmcnt(2)
  v_mfma_f32_32x32x16_bf16 v[64:79], v[164:167], v[56:59], v[64:79]
  ds_read_b128 v[168:171], v26 offset:0
  ds_read_b64_tr_b16 v[48:49], v7 offset:20480
  ds_read_b64_tr_b16 v[50:51], v7 offset:20992
  s_waitcnt lgkmcnt(3)
  v_mfma_f32_32x32x16_bf16 v[80:95], v[164:167], v[60:63], v[80:95]
  s_cmp_eq_u32 s6, 1
  s_cbranch_scc1 L_k1O_c14
L_k1O_c14_r:
  ds_read_b64_tr_b16 v[52:53], v7 offset:28672
  ds_read_b64_tr_b16 v[54:55], v7 offset:29184
  s_add_u32 m0, s55, 1024
  s_bfe_u32 s60, s12, 0x40010
  s_mul_i32 s60, s60, 128
  s_add_u32 s60, s60, s53
  buffer_load_dwordx4 v11, s[24:27], s60 offen lds
  s_cmp_eq_u32 s50, 0
  s_cbranch_scc1 L_k1O_c15
L_k1O_c15_r:
  s_waitcnt lgkmcnt(2)
  v_mfma_f32_32x32x16_bf16 v[64:79], v[168:171], v[48:51], v[64:79]
  ds_read_b128 v[172:175], v27 offset:0
  ds_read_b64_tr_b16 v[56:57], v7 offset:22528
  ds_read_b64_tr_b16 v[58:59], v7 offset:23040
  s_waitcnt lgkmcnt(3)
  v_mfma_f32_32x32x16_bf16 v[80:95], v[168:171], v[52:55], v[80:95]
  s_cmp_eq_u32 s6, 2
  s_cbranch_scc1 L_k1O_c16
L_k1O_c16_r:
  ds_read_b64_tr_b16 v[60:61], v7 offset:30720
  ds_read_b64_tr_b16 v[62:63], v7 offset:31232
  s_add_u32 m0, s54, 16384
  s_bfe_u32 s60, s12, 0x40010
  s_mul_i32 s60, s60, 196608
  s_add_u32 s60, s60, s58
  s_add_u32 s60, s60, 1024
  buffer_load_dwordx4 v9, s[28:31], s60 offen lds
  s_waitcnt vmcnt(3)
  s_barrier
  s_waitcnt lgkmcnt(2)
  v_mfma_f32_32x32x16_bf16 v[64:79], v[172:175], v[56:59], v[64:79]
  ds_read_b128 v[176:179], v24 offset:32768
  ds_read_b64_tr_b16 v[48:49], v7 offset:49152
  ds_read_b64_tr_b16 v[50:51], v7 offset:49664
  s_waitcnt lgkmcnt(3)
  v_mfma_f32_32x32x16_bf16 v[80:95], v[172:175], v[60:63], v[80:95]
  s_cmp_eq_u32 s6, 3
  s_cbranch_scc1 L_k1O_c17
L_k1O_c17_r:
  ds_read_b64_tr_b16 v[52:53], v7 offset:57344
  ds_read_b64_tr_b16 v[54:55], v7 offset:57856
  s_add_u32 m0, s54, 24576
  s_bfe_u32 s60, s12, 0x40010
  s_mul_i32 s60, s60, 196608
  s_add_u32 s60, s60, s58
  s_add_u32 s60, s60, 2048
  buffer_load_dwordx4 v9, s[28:31], s60 offen lds
  s_cmp_eq_u32 s50, 1
  s_cbranch_scc1 L_k1O_c18
L_k1O_c18_r:
  s_cmp_eq_u32 s48, 0
  s_mov_b32 s61, 0x7ffffff0
  s_cselect_b32 s11, s91, s61
  buffer_load_dword v31, off, s[44:47], s11 sc1
  s_waitcnt lgkmcnt(2)
  v_mfma_f32_32x32x16_bf16 v[64:79], v[176:179], v[48:51], v[64:79]
  ds_read_b128 v[180:183], v25 offset:32768
  ds_read_b64_tr_b16 v[56:57], v7 offset:51200
  ds_read_b64_tr_b16 v[58:59], v7 offset:51712
  s_waitcnt lgkmcnt(3)
  v_mfma_f32_32x32x16_bf16 v[80:95], v[176:179], v[52:55], v[80:95]
  s_cmp_eq_u32 s6, 0
  s_cbranch_scc1 L_k1O_c19
L_k1O_c19_r:
  ds_read_b64_tr_b16 v[60:61], v7 offset:59392
  ds_read_b64_tr_b16 v[62:63], v7 offset:59904
  s_add_u32 m0, s55, 32768
  s_bfe_u32 s60, s12, 0x40014
  s_mul_i32 s60, s60, 128
  s_add_u32 s60, s60, s53
  buffer_load_dwordx4 v10, s[24:27], s60 offen lds
  s_waitcnt lgkmcnt(2)
  v_mfma_f32_32x32x16_bf16 v[64:79], v[180:183], v[56:59], v[64:79]
  ds_read_b128 v[184:187], v26 offset:32768
  ds_read_b64_tr_b16 v[48:49], v7 offset:53248
  ds_read_b64_tr_b16 v[50:51], v7 offset:53760
  s_waitcnt lgkmcnt(3)
  v_mfma_f32_32x32x16_bf16 v[80:95], v[180:183], v[60:63], v[80:95]
  s_cmp_eq_u32 s6, 1
  s_cbranch_scc1 L_k1O_c20
L_k1O_c20_r:
  ds_read_b64_tr_b16 v[52:53], v7 offset:61440
  ds_read_b64_tr_b16 v[54:55], v7 offset:61952
  s_add_u32 m0, s55, 33792
  s_bfe_u32 s60, s12, 0x40014
  s_mul_i32 s60, s60, 128
  s_add_u32 s60, s60, s53
  buffer_load_dwordx4 v11, s[24:27], s60 offen lds
  s_cmp_eq_u32 s50, 0
  s_cbranch_scc1 L_k1O_c21
L_k1O_c21_r:
  s_waitcnt lgkmcnt(2)
  v_mfma_f32_32x32x16_bf16 v[64:79], v[184:187], v[48:51], v[64:79]
  ds_read_b128 v[188:191], v27 offset:32768
  ds_read_b64_tr_b16 v[56:57], v7 offset:55296
  ds_read_b64_tr_b16 v[58:59], v7 offset:55808
  s_waitcnt lgkmcnt(3)
  v_mfma_f32_32x32x16_bf16 v[80:95], v[184:187], v[52:55], v[80:95]
  s_cmp_eq_u32 s6, 2
  s_cbranch_scc1 L_k1O_c22
L_k1O_c22_r:
  ds_read_b64_tr_b16 v[60:61], v7 offset:63488
  ds_read_b64_tr_b16 v[62:63], v7 offset:64000
  s_add_u32 m0, s54, 49152
  s_bfe_u32 s60, s12, 0x40014
  s_mul_i32 s60, s60, 196608
  s_add_u32 s60, s60, s58
  s_add_u32 s60, s60, 1024
  buffer_load_dwordx4 v9, s[28:31], s60 offen lds
  s_waitcnt vmcnt(4)
  s_barrier
  s_waitcnt lgkmcnt(2)
  v_mfma_f32_32x32x16_bf16 v[64:79], v[188:191], v[56:59], v[64:79]
  ds_read_b128 v[192:195], v20 offset:0
  ds_read_b64_tr_b16 v[48:49], v6 offset:16384
  ds_read_b64_tr_b16 v[50:51], v6 offset:16896
  s_waitcnt lgkmcnt(3)
  v_mfma_f32_32x32x16_bf16 v[80:95], v[188:191], v[60:63], v[80:95]
  s_cmp_eq_u32 s6, 3
  s_cbranch_scc1 L_k1O_c23
L_k1O_c23_r:
  ds_read_b64_tr_b16 v[52:53], v6 offset:24576
  ds_read_b64_tr_b16 v[54:55], v6 offset:25088
  s_add_u32 m0, s54, 57344
  s_bfe_u32 s60, s12, 0x40014
  s_mul_i32 s60, s60, 196608
  s_add_u32 s60, s60, s58
  s_add_u32 s60, s60, 2048
  buffer_load_dwordx4 v9, s[28:31], s60 offen lds
  s_cmp_eq_u32 s50, 1
  s_cbranch_scc1 L_k1O_c24
L_k1O_c24_r:
  s_waitcnt lgkmcnt(2)
  v_mfma_f32_32x32x16_bf16 v[64:79], v[192:195], v[48:51], v[64:79]
  ds_read_b128 v[196:199], v21 offset:0
  ds_read_b64_tr_b16 v[56:57], v6 offset:18432
  ds_read_b64_tr_b16 v[58:59], v6 offset:18944
  s_waitcnt lgkmcnt(3)
  v_mfma_f32_32x32x16_bf16 v[80:95], v[192:195], v[52:55], v[80:95]
  s_cmp_eq_u32 s6, 0
  s_cbranch_scc1 L_k1O_c25
L_k1O_c25_r:
  ds_read_b64_tr_b16 v[60:61], v6 offset:26624
  ds_read_b64_tr_b16 v[62:63], v6 offset:27136
  s_add_u32 m0, s55, 65536
  s_bfe_u32 s60, s12, 0x40018
  s_mul_i32 s60, s60, 128
  s_add_u32 s60, s60, s53
  buffer_load_dwordx4 v10, s[24:27], s60 offen lds
  s_waitcnt lgkmcnt(2)
  v_mfma_f32_32x32x16_bf16 v[64:79], v[196:199], v[56:59], v[64:79]
  ds_read_b128 v[200:203], v22 offset:0
  ds_read_b64_tr_b16 v[48:49], v6 offset:20480
  ds_read_b64_tr_b16 v[50:51], v6 offset:20992
  s_waitcnt lgkmcnt(3)
  v_mfma_f32_32x32x16_bf16 v[80:95], v[196:199], v[60:63], v[80:95]
  s_cmp_eq_u32 s6, 1
  s_cbranch_scc1 L_k1O_c26
L_k1O_c26_r:
  ds_read_b64_tr_b16 v[52:53], v6 offset:28672
  ds_read_b64_tr_b16 v[54:55], v6 offset:29184
  s_add_u32 m0, s55, 66560
  s_bfe_u32 s60, s12, 0x40018
  s_mul_i32 s60, s60, 128
  s_add_u32 s60, s60, s53
  buffer_load_dwordx4 v11, s[24:27], s60 offen lds
  s_cmp_eq_u32 s50, 0
  s_cbranch_scc1 L_k1O_c27
L_k1O_c27_r:
  s_lshl_b32 s18, s52, 2
  s_add_u32 s18, s18, 192
  buffer_load_dword v0, off, s[44:47], s18 sc1
  s_waitcnt lgkmcnt(2)
  v_mfma_f32_32x32x16_bf16 v[64:79], v[200:203], v[48:51], v[64:79]
  ds_read_b128 v[204:207], v23 offset:0
  ds_read_b64_tr_b16 v[56:57], v6 offset:22528
  ds_read_b64_tr_b16 v[58:59], v6 offset:23040
  s_waitcnt lgkmcnt(3)
  v_mfma_f32_32x32x16_bf16 v[80:95], v[200:203], v[52:55], v[80:95]
  s_cmp_eq_u32 s6, 2
  s_cbranch_scc1 L_k1O_c28
L_k1O_c28_r:
  ds_read_b64_tr_b16 v[60:61], v6 offset:30720
  ds_read_b64_tr_b16 v[62:63], v6 offset:31232
  s_add_u32 m0, s54, 81920
  s_bfe_u32 s60, s12, 0x40018
  s_mul_i32 s60, s60, 196608
  s_add_u32 s60, s60, s58
  s_add_u32 s60, s60, 1024
  buffer_load_dwordx4 v9, s[28:31], s60 offen lds
  s_waitcnt vmcnt(4)
  s_barrier
  s_waitcnt lgkmcnt(2)
  v_mfma_f32_32x32x16_bf16 v[64:79], v[204:207], v[56:59], v[64:79]
  ds_read_b128 v[208:211], v20 offset:32768
  ds_read_b64_tr_b16 v[48:49], v6 offset:49152
  ds_read_b64_tr_b16 v[50:51], v6 offset:49664
  s_waitcnt lgkmcnt(3)
  v_mfma_f32_32x32x16_bf16 v[80:95], v[204:207], v[60:63], v[80:95]
  s_cmp_eq_u32 s6, 3
  s_cbranch_scc1 L_k1O_c29
L_k1O_c29_r:
  ds_read_b64_tr_b16 v[52:53], v6 offset:57344
  ds_read_b64_tr_b16 v[54:55], v6 offset:57856
  s_add_u32 m0, s54, 90112
  s_bfe_u32 s60, s12, 0x40018
  s_mul_i32 s60, s60, 196608
  s_add_u32 s60, s60, s58
  s_add_u32 s60, s60, 2048
  buffer_load_dwordx4 v9, s[28:31], s60 offen lds
  s_cmp_eq_u32 s50, 1
  s_cbranch_scc1 L_k1O_c30
L_k1O_c30_r:
  s_waitcnt lgkmcnt(2)
  v_mfma_f32_32x32x16_bf16 v[64:79], v[208:211], v[48:51], v[64:79]
  ds_read_b128 v[212:215], v21 offset:32768
  ds_read_b64_tr_b16 v[56:57], v6 offset:51200
  ds_read_b64_tr_b16 v[58:59], v6 offset:51712
  s_waitcnt lgkmcnt(3)
  v_mfma_f32_32x32x16_bf16 v[80:95], v[208:211], v[52:55], v[80:95]
  s_cmp_eq_u32 s6, 0
  s_cbranch_scc1 L_k1O_c31
L_k1O_c31_r:
  ds_read_b64_tr_b16 v[60:61], v6 offset:59392
  ds_read_b64_tr_b16 v[62:63], v6 offset:59904
  s_add_u32 m0, s55, 98304
  s_bfe_u32 s60, s12, 0x4001c
  s_mul_i32 s60, s60, 128
  s_add_u32 s60, s60, s53
  buffer_load_dwordx4 v10, s[24:27], s60 offen lds
  s_waitcnt lgkmcnt(2)
  v_mfma_f32_32x32x16_bf16 v[64:79], v[212:215], v[56:59], v[64:79]
  ds_read_b128 v[216:219], v22 offset:32768
  ds_read_b64_tr_b16 v[48:49], v6 offset:53248
  ds_read_b64_tr_b16 v[50:51], v6 offset:53760
  s_waitcnt lgkmcnt(3)
  v_mfma_f32_32x32x16_bf16 v[80:95], v[212:215], v[60:63], v[80:95]
  s_cmp_eq_u32 s6, 1
  s_cbranch_scc1 L_k1O_c32
L_k1O_c32_r:
  ds_read_b64_tr_b16 v[52:53], v6 offset:61440
  ds_read_b64_tr_b16 v[54:55], v6 offset:61952
  s_add_u32 m0, s55, 99328
  s_bfe_u32 s60, s12, 0x4001c
  s_mul_i32 s60, s60, 128
  s_add_u32 s60, s60, s53
  buffer_load_dwordx4 v11, s[24:27], s60 offen lds
  s_cmp_eq_u32 s50, 0
  s_cbranch_scc1 L_k1O_c33
L_k1O_c33_r:
  s_waitcnt lgkmcnt(2)
  v_mfma_f32_32x32x16_bf16 v[64:79], v[216:219], v[48:51], v[64:79]
  ds_read_b128 v[220:223], v23 offset:32768
  ds_read_b64_tr_b16 v[56:57], v6 offset:55296
  ds_read_b64_tr_b16 v[58:59], v6 offset:55808
  s_waitcnt lgkmcnt(3)
  v_mfma_f32_32x32x16_bf16 v[80:95], v[216:219], v[52:55], v[80:95]
  s_cmp_eq_u32 s6, 2
  s_cbranch_scc1 L_k1O_c34
L_k1O_c34_r:
  ds_read_b64_tr_b16 v[60:61], v6 offset:63488
  ds_read_b64_tr_b16 v[62:63], v6 offset:64000
  s_add_u32 m0, s54, 114688
  s_bfe_u32 s60, s12, 0x4001c
  s_mul_i32 s60, s60, 196608
  s_add_u32 s60, s60, s58
  s_add_u32 s60, s60, 1024
  buffer_load_dwordx4 v9, s[28:31], s60 offen lds
  s_waitcnt vmcnt(3)
  s_barrier
  s_waitcnt lgkmcnt(2)
  v_mfma_f32_32x32x16_bf16 v[64:79], v[220:223], v[56:59], v[64:79]
  ds_read_b128 v[224:227], v24 offset:0
  ds_read_b64_tr_b16 v[48:49], v7 offset:16384
  ds_read_b64_tr_b16 v[50:51], v7 offset:16896
  s_waitcnt lgkmcnt(3)
  v_mfma_f32_32x32x16_bf16 v[80:95], v[220:223], v[60:63], v[80:95]
  s_cmp_eq_u32 s6, 3
  s_cbranch_scc1 L_k1O_c35
L_k1O_c35_r:
  ds_read_b64_tr_b16 v[52:53], v7 offset:24576
  ds_read_b64_tr_b16 v[54:55], v7 offset:25088
  s_add_u32 m0, s54, 122880
  s_bfe_u32 s60, s12, 0x4001c
  s_mul_i32 s60, s60, 196608
  s_add_u32 s60, s60, s58
  s_add_u32 s60, s60, 2048
  buffer_load_dwordx4 v9, s[28:31], s60 offen lds
  s_cmp_eq_u32 s50, 1
  s_cbranch_scc1 L_k1O_c36
L_k1O_c36_r:
  s_waitcnt lgkmcnt(2)
  v_mfma_f32_32x32x16_bf16 v[64:79], v[224:227], v[48:51], v[64:79]
  ds_read_b128 v[228:231], v25 offset:0
  ds_read_b64_tr_b16 v[56:57], v7 offset:18432
  ds_read_b64_tr_b16 v[58:59], v7 offset:18944
  s_waitcnt lgkmcnt(3)
  v_mfma_f32_32x32x16_bf16 v[80:95], v[224:227], v[52:55], v[80:95]
  s_cmp_eq_u32 s6, 0
  s_cbranch_scc1 L_k1O_c37
L_k1O_c37_r:
  ds_read_b64_tr_b16 v[60:61], v7 offset:26624
  ds_read_b64_tr_b16 v[62:63], v7 offset:27136
  v_lshrrev_b32 v10, 6, v1
  s_lshl_b32 s60, s49, 4
  v_add_u32 v10, s60, v10
  v_mul_u32_u24 v10, 3584, v10
  v_and_b32 v11, 48, v1
  v_add_u32 v10, v10, v11
  v_xor_b32 v11, 32, v10
  s_add_u32 m0, s54, 0
  s_bfe_u32 s60, s13, 0x40000
  s_mul_i32 s60, s60, 229376
  s_add_u32 s60, s60, s57
  buffer_load_dwordx4 v10, s[32:35], s60 offen lds
  s_waitcnt lgkmcnt(2)
  v_mfma_f32_32x32x16_bf16 v[64:79], v[228:231], v[56:59], v[64:79]
  ds_read_b128 v[232:235], v26 offset:0
  ds_read_b64_tr_b16 v[48:49], v7 offset:20480
  ds_read_b64_tr_b16 v[50:51], v7 offset:20992
  s_waitcnt lgkmcnt(3)
  v_mfma_f32_32x32x16_bf16 v[80:95], v[228:231], v[60:63], v[80:95]
  s_cmp_eq_u32 s6, 1
  s_cbranch_scc1 L_k1O_c38
L_k1O_c38_r:
  ds_read_b64_tr_b16 v[52:53], v7 offset:28672
  ds_read_b64_tr_b16 v[54:55], v7 offset:29184
  s_add_u32 m0, s54, 8192
  s_bfe_u32 s60, s13, 0x40000
  s_mul_i32 s60, s60, 229376
  s_add_u32 s60, s60, s57
  buffer_load_dwordx4 v11, s[36:39], s60 offen lds
  s_cmp_eq_u32 s50, 0
  s_cbranch_scc1 L_k1O_c39
L_k1O_c39_r:
  v_readfirstlane_b32 s62, v31
  s_cmp_eq_u32 s48, 0
  s_cbranch_scc0 L_rO_ok
  s_mov_b32 s82, 0
L_rO_chk:
  s_cmp_ge_u32 s62, 1
  s_cbranch_scc0 L_rO_spin
  s_branch L_rO_ok
L_rO_spin:
  s_sleep 8
  buffer_load_dword v31, off, s[44:47], s91 sc1
  s_waitcnt vmcnt(0)
  v_readfirstlane_b32 s62, v31
  s_add_u32 s82, s82, 1
  s_cmp_lt_u32 s82, 0x100000
  s_cbranch_scc1 L_rO_chk
L_rO_ok:
  s_nop 1
  s_waitcnt lgkmcnt(2)
  v_mfma_f32_32x32x16_bf16 v[64:79], v[232:235], v[48:51], v[64:79]
  ds_read_b128 v[236:239], v27 offset:0
  ds_read_b64_tr_b16 v[56:57], v7 offset:22528
  ds_read_b64_tr_b16 v[58:59], v7 offset:23040
  s_waitcnt lgkmcnt(3)
  v_mfma_f32_32x32x16_bf16 v[80:95], v[232:235], v[52:55], v[80:95]
  s_cmp_eq_u32 s6, 2
  s_cbranch_scc1 L_k1O_c40
L_k1O_c40_r:
  ds_read_b64_tr_b16 v[60:61], v7 offset:30720
  ds_read_b64_tr_b16 v[62:63], v7 offset:31232
  s_add_u32 m0, s54, 16384
  s_bfe_u32 s60, s13, 0x40008
  s_mul_i32 s60, s60, 229376
  s_add_u32 s60, s60, s57
  buffer_load_dwordx4 v10, s[32:35], s60 offen lds
  s_waitcnt vmcnt(3)
  s_barrier
  s_waitcnt lgkmcnt(2)
  v_mfma_f32_32x32x16_bf16 v[64:79], v[236:239], v[56:59], v[64:79]
  ds_read_b128 v[240:243], v24 offset:32768
  ds_read_b64_tr_b16 v[48:49], v7 offset:49152
  ds_read_b64_tr_b16 v[50:51], v7 offset:49664
  s_waitcnt lgkmcnt(3)
  v_mfma_f32_32x32x16_bf16 v[80:95], v[236:239], v[60:63], v[80:95]
  s_cmp_eq_u32 s6, 3
  s_cbranch_scc1 L_k1O_c41
L_k1O_c41_r:
  ds_read_b64_tr_b16 v[52:53], v7 offset:57344
  ds_read_b64_tr_b16 v[54:55], v7 offset:57856
  s_add_u32 m0, s54, 24576
  s_bfe_u32 s60, s13, 0x40008
  s_mul_i32 s60, s60, 229376
  s_add_u32 s60, s60, s57
  buffer_load_dwordx4 v11, s[36:39], s60 offen lds
  s_cmp_eq_u32 s50, 1
  s_cbranch_scc1 L_k1O_c42
L_k1O_c42_r:
  s_waitcnt lgkmcnt(2)
  v_mfma_f32_32x32x16_bf16 v[64:79], v[240:243], v[48:51], v[64:79]
  ds_read_b128 v[244:247], v25 offset:32768
  ds_read_b64_tr_b16 v[56:57], v7 offset:51200
  ds_read_b64_tr_b16 v[58:59], v7 offset:51712
  s_waitcnt lgkmcnt(3)
  v_mfma_f32_32x32x16_bf16 v[80:95], v[240:243], v[52:55], v[80:95]
  s_cmp_eq_u32 s6, 0
  s_cbranch_scc1 L_k1O_c43
L_k1O_c43_r:
  ds_read_b64_tr_b16 v[60:61], v7 offset:59392
  ds_read_b64_tr_b16 v[62:63], v7 offset:59904
  s_add_u32 m0, s54, 32768
  s_bfe_u32 s60, s13, 0x40010
  s_mul_i32 s60, s60, 229376
  s_add_u32 s60, s60, s57
  buffer_load_dwordx4 v10, s[32:35], s60 offen lds
  s_waitcnt lgkmcnt(2)
  v_mfma_f32_32x32x16_bf16 v[64:79], v[244:247], v[56:59], v[64:79]
  ds_read_b128 v[248:251], v26 offset:32768
  ds_read_b64_tr_b16 v[48:49], v7 offset:53248
  ds_read_b64_tr_b16 v[50:51], v7 offset:53760
  s_waitcnt lgkmcnt(3)
  v_mfma_f32_32x32x16_bf16 v[80:95], v[244:247], v[60:63], v[80:95]
  s_cmp_eq_u32 s6, 1
  s_cbranch_scc1 L_k1O_c44
L_k1O_c44_r:
  ds_read_b64_tr_b16 v[52:53], v7 offset:61440
  ds_read_b64_tr_b16 v[54:55], v7 offset:61952
  s_add_u32 m0, s54, 40960
  s_bfe_u32 s60, s13, 0x40010
  s_mul_i32 s60, s60, 229376
  s_add_u32 s60, s60, s57
  buffer_load_dwordx4 v11, s[36:39], s60 offen lds
  s_cmp_eq_u32 s50, 0
  s_cbranch_scc1 L_k1O_c45
L_k1O_c45_r:
  s_waitcnt lgkmcnt(2)
  v_mfma_f32_32x32x16_bf16 v[64:79], v[248:251], v[48:51], v[64:79]
  ds_read_b128 v[252:255], v27 offset:32768
  ds_read_b64_tr_b16 v[56:57], v7 offset:55296
  ds_read_b64_tr_b16 v[58:59], v7 offset:55808
  s_waitcnt lgkmcnt(3)
  v_mfma_f32_32x32x16_bf16 v[80:95], v[248:251], v[52:55], v[80:95]
  s_cmp_eq_u32 s6, 2
  s_cbranch_scc1 L_k1O_c46
L_k1O_c46_r:
  ds_read_b64_tr_b16 v[60:61], v7 offset:63488
  ds_read_b64_tr_b16 v[62:63], v7 offset:64000
  s_add_u32 m0, s54, 49152
  s_bfe_u32 s60, s13, 0x40018
  s_mul_i32 s60, s60, 229376
  s_add_u32 s60, s60, s57
  buffer_load_dwordx4 v10, s[32:35], s60 offen lds
  s_waitcnt vmcnt(5)
  s_barrier
  s_waitcnt lgkmcnt(2)
  v_mfma_f32_32x32x16_bf16 v[64:79], v[252:255], v[56:59], v[64:79]
  v_lshrrev_b32 v20, 9, v1
  v_lshlrev_b32 v20, 3, v20
  v_bfe_u32 v21, v1, 6, 2
  v_add_u32 v20, v20, v21
  v_bfe_u32 v21, v1, 8, 1
  v_bfe_u32 v22, v1, 5, 1
  s_lshl_b32 s60, s50, 1
  v_add_u32 v22, s60, v22
  v_lshlrev_b32 v23, 1, v21
  v_xor_b32 v22, v22, v23
  v_lshlrev_b32 v22, 4, v22
  v_lshl_add_u32 v6, v20, 6, v22
  v_lshlrev_b32 v23, 13, v21
  v_add_u32 v6, v6, v23
  v_bfe_u32 v23, v1, 4, 1
  v_lshl_add_u32 v6, v23, 3, v6
  v_add_u32 v7, 0x10000, v6
  s_waitcnt lgkmcnt(0)
  v_mfma_f32_32x32x16_bf16 v[80:95], v[252:255], v[60:63], v[80:95]
  s_cmp_eq_u32 s6, 3
  s_cbranch_scc1 L_k1O_c47
L_k1O_c47_r:
  ds_read_b64_tr_b16 v[48:49], v6 offset:0
  ds_read_b64_tr_b16 v[50:51], v6 offset:256
  ds_read_b64_tr_b16 v[52:53], v6 offset:1024
  ds_read_b64_tr_b16 v[54:55], v6 offset:1280
  s_add_u32 m0, s54, 57344
  s_bfe_u32 s60, s13, 0x40018
  s_mul_i32 s60, s60, 229376
  s_add_u32 s60, s60, s57
  buffer_load_dwordx4 v11, s[36:39], s60 offen lds
  s_cmp_eq_u32 s50, 1
  s_cbranch_scc1 L_k1O_c48
L_k1O_c48_r:
  s_memtime s[14:15]
  v_mov_b32 v29, 0x23c00
  v_add_u32 v28, s5, v1
  v_cmp_gt_u32 vcc, 256, v1
  s_nop 1
  v_cndmask_b32 v28, v29, v28
  ds_write_b32 v28, v36 offset:0
  ds_write_b32 v28, v37 offset:256
  ds_write_b32 v28, v40 offset:512
  ds_write_b32 v28, v41 offset:768
  v_mov_b32 v16, 0
  v_mov_b32 v17, 0
  s_mov_b32 s62, 0x1
  s_mov_b32 s63, 0x10
  v_cndmask_b32 v16, v16, v96, s[62:63]
  s_mov_b32 s98, 0x2
  s_mov_b32 s99, 0x20
  v_cndmask_b32 v17, v17, v97, s[98:99]
  s_mov_b32 s62, 0x4
  s_mov_b32 s63, 0x40
  v_cndmask_b32 v16, v16, v98, s[62:63]
  s_mov_b32 s98, 0x8
  s_mov_b32 s99, 0x80
  v_cndmask_b32 v17, v17, v99, s[98:99]
  s_mov_b32 s62, 0x100
  s_mov_b32 s63, 0x1000
  v_cndmask_b32 v16, v16, v100, s[62:63]
  s_mov_b32 s98, 0x200
  s_mov_b32 s99, 0x2000
  v_cndmask_b32 v17, v17, v101, s[98:99]
  s_mov_b32 s62, 0x400
  s_mov_b32 s63, 0x4000
  v_cndmask_b32 v16, v16, v102, s[62:63]
  s_mov_b32 s98, 0x800
  s_mov_b32 s99, 0x8000
  v_cndmask_b32 v17, v17, v103, s[98:99]
  s_mov_b32 s62, 0x10000
  s_mov_b32 s63, 0x100000
  v_cndmask_b32 v16, v16, v104, s[62:63]
  s_mov_b32 s98, 0x20000
  s_mov_b32 s99, 0x200000
  v_cndmask_b32 v17, v17, v105, s[98:99]
  s_mov_b32 s62, 0x40000
  s_mov_b32 s63, 0x400000
  v_cndmask_b32 v16, v16, v106, s[62:63]
  s_mov_b32 s98, 0x80000
  s_mov_b32 s99, 0x800000
  v_cndmask_b32 v17, v17, v107, s[98:99]
  s_mov_b32 s62, 0x1000000
  s_mov_b32 s63, 0x10000000
  v_cndmask_b32 v16, v16, v108, s[62:63]
  s_mov_b32 s98, 0x2000000
  s_mov_b32 s99, 0x20000000
  v_cndmask_b32 v17, v17, v109, s[98:99]
  s_mov_b32 s62, 0x4000000
  s_mov_b32 s63, 0x40000000
  v_cndmask_b32 v16, v16, v110, s[62:63]
  s_mov_b32 s98, 0x8000000
  s_mov_b32 s99, 0x80000000
  v_cndmask_b32 v17, v17, v111, s[98:99]
  v_add_f32 v16, v16, v17
  s_waitcnt lgkmcnt(6)
  v_mfma_f32_32x32x16_bf16 v[96:111], v[48:51], v[128:131], 0
  ds_read_b64_tr_b16 v[56:57], v6 offset:2048
  ds_read_b64_tr_b16 v[58:59], v6 offset:2304
  s_add_u32 m0, s54, 65536
  s_bfe_u32 s60, s12, 0x40000
  s_mul_i32 s60, s60, 229376
  s_add_u32 s60, s60, s56
  buffer_load_dwordx4 v8, s[32:35], s60 offen lds
  v_and_b32 v28, 0x1f0, v1
  v_lshrrev_b32 v29, 9, v1
  v_lshl_add_u32 v28, v29, 2, v28
  s_lshl_b32 s61, s49, 9
  s_lshl_b32 s62, s50, 3
  s_add_u32 s61, s61, s62
  s_waitcnt lgkmcnt(6)
  v_mfma_f32_32x32x16_bf16 v[96:111], v[52:55], v[132:135], v[96:111]
  s_cmp_eq_u32 s6, 0
  s_cbranch_scc1 L_k1O_c49
L_k1O_c49_r:
  ds_read_b64_tr_b16 v[60:61], v6 offset:3072
  ds_read_b64_tr_b16 v[62:63], v6 offset:3328
  s_add_u32 s61, s61, 0x23400
  v_add_u32 v28, s61, v28
  ds_write_b32 v28, v16
  v_lshrrev_b32 v28, 1, v1
  s_lshl_b32 s61, s49, 8
  s_lshl_b32 s62, s50, 2
  s_waitcnt lgkmcnt(3)
  v_mfma_f32_32x32x16_bf16 v[96:111], v[56:59], v[136:139], v[96:111]
  ds_read_b64_tr_b16 v[48:49], v6 offset:4096
  ds_read_b64_tr_b16 v[50:51], v6 offset:4352
  s_add_u32 m0, s54, 73728
  s_bfe_u32 s60, s12, 0x40000
  s_mul_i32 s60, s60, 229376
  s_add_u32 s60, s60, s56
  buffer_load_dwordx4 v8, s[36:39], s60 offen lds
  s_add_u32 s61, s61, s62
  s_add_u32 s61, s61, 0x23000
  v_add_u32 v28, s61, v28
  v_mov_b32 v29, 0x23c00
  v_cmp_gt_u32 vcc, 256, v1
  s_nop 1
  v_cndmask_b32 v28, v29, v28
  s_waitcnt lgkmcnt(3)
  v_mfma_f32_32x32x16_bf16 v[96:111], v[60:63], v[140:143], v[96:111]
  s_cmp_eq_u32 s6, 1
  s_cbranch_scc1 L_k1O_c50
L_k1O_c50_r:
  ds_read_b64_tr_b16 v[52:53], v6 offset:5120
  ds_read_b64_tr_b16 v[54:55], v6 offset:5376
  ds_write_b32 v28, v12
  ds_write_b32 v28, v13 offset:128
  s_waitcnt lgkmcnt(4)
  v_mfma_f32_32x32x16_bf16 v[96:111], v[48:51], v[144:147], v[96:111]
  ds_read_b64_tr_b16 v[56:57], v6 offset:6144
  ds_read_b64_tr_b16 v[58:59], v6 offset:6400
  s_waitcnt lgkmcnt(4)
  v_mfma_f32_32x32x16_bf16 v[96:111], v[52:55], v[148:151], v[96:111]
  s_cmp_eq_u32 s6, 2
  s_cbranch_scc1 L_k1O_c51
L_k1O_c51_r:
  ds_read_b64_tr_b16 v[60:61], v6 offset:7168
  ds_read_b64_tr_b16 v[62:63], v6 offset:7424
  s_waitcnt vmcnt(6)
  s_waitcnt lgkmcnt(4)
  s_barrier
  s_waitcnt lgkmcnt(2)
  v_mfma_f32_32x32x16_bf16 v[96:111], v[56:59], v[152:155], v[96:111]
  ds_read_b64_tr_b16 v[48:49], v6 offset:16384
  ds_read_b64_tr_b16 v[50:51], v6 offset:16640
  s_add_u32 m0, s54, 81920
  s_bfe_u32 s60, s12, 0x40004
  s_mul_i32 s60, s60, 229376
  s_add_u32 s60, s60, s56
  buffer_load_dwordx4 v8, s[32:35], s60 offen lds
  v_and_b32 v28, 0x1f0, v1
  s_lshl_b32 s61, s49, 9
  s_add_u32 s61, s61, 0x23400
  v_add_u32 v29, s61, v28
  ds_read_b128 v[16:19], v29
  v_lshrrev_b32 v28, 1, v28
  s_waitcnt lgkmcnt(3)
  v_mfma_f32_32x32x16_bf16 v[96:111], v[60:63], v[156:159], v[96:111]
  s_cmp_eq_u32 s6, 3
  s_cbranch_scc1 L_k1O_c52
L_k1O_c52_r:
  ds_read_b64_tr_b16 v[52:53], v6 offset:17408
  ds_read_b64_tr_b16 v[54:55], v6 offset:17664
  s_lshl_b32 s61, s49, 8
  s_add_u32 s61, s61, 0x23000
  v_add_u32 v29, s61, v28
  ds_read_b64 v[12:13], v29
  s_waitcnt lgkmcnt(4)
  v_mfma_f32_32x32x16_bf16 v[96:111], v[48:51], v[160:163], v[96:111]
  ds_read_b64_tr_b16 v[56:57], v6 offset:18432
  ds_read_b64_tr_b16 v[58:59], v6 offset:18688
  s_add_u32 m0, s54, 90112
  s_bfe_u32 s60, s12, 0x40004
  s_mul_i32 s60, s60, 229376
  s_add_u32 s60, s60, s56
  buffer_load_dwordx4 v8, s[36:39], s60 offen lds
  s_waitcnt lgkmcnt(5)
  v_add_f32 v16, v16, v17
  v_add_f32 v18, v18, v19
  s_waitcnt lgkmcnt(2)
  v_add_f32 v12, v12, v13
  v_add_f32 v16, v16, v18
  v_mfma_f32_32x32x16_bf16 v[96:111], v[52:55], v[164:167], v[96:111]
  s_cmp_eq_u32 s6, 0
  s_cbranch_scc1 L_k1O_c53
L_k1O_c53_r:
  ds_read_b64_tr_b16 v[60:61], v6 offset:19456
  ds_read_b64_tr_b16 v[62:63], v6 offset:19712
  v_mul_f32 v12, 0x3b000000, v12
  v_mul_f32 v16, 0x3b000000, v16
  v_fma_f32 v16, -v12, v12, v16
  v_max_f32 v16, 0, v16
  v_sub_f32 v13, 0, v12
  v_cvt_pk_bf16_f32 v13, v13, v13
  s_waitcnt lgkmcnt(2)
  v_mfma_f32_32x32x16_bf16 v[96:111], v[56:59], v[168:171], v[96:111]
  ds_read_b64_tr_b16 v[48:49], v6 offset:20480
  ds_read_b64_tr_b16 v[50:51], v6 offset:20736
  v_cmp_gt_u32 vcc, 512, v1
  v_mov_b32 v14, 0
  s_nop 0
  v_cndmask_b32 v44, v14, v13
  v_cvt_pk_bf16_f32 v16, v16, v16
  v_lshlrev_b32 v16, 16, v16
  v_add_f32 v16, 0x3727c5ac, v16
  s_waitcnt lgkmcnt(2)
  v_mfma_f32_32x32x16_bf16 v[96:111], v[60:63], v[172:175], v[96:111]
  s_cmp_eq_u32 s6, 1
  s_cbranch_scc1 L_k1O_c54
L_k1O_c54_r:
  ds_read_b64_tr_b16 v[52:53], v6 offset:21504
  ds_read_b64_tr_b16 v[54:55], v6 offset:21760
  v_cvt_pk_bf16_f32 v16, v16, v16
  v_lshlrev_b32 v16, 16, v16
  v_sqrt_f32 v16, v16
  s_nop 0
  v_cvt_pk_bf16_f32 v16, v16, v16
  v_lshlrev_b32 v16, 16, v16
  s_waitcnt lgkmcnt(2)
  v_mfma_f32_32x32x16_bf16 v[96:111], v[48:51], v[176:179], v[96:111]
  ds_read_b64_tr_b16 v[56:57], v6 offset:22528
  ds_read_b64_tr_b16 v[58:59], v6 offset:22784
  v_rcp_f32 v17, v16
  v_mul_f32 v4, v16, v16
  v_mul_f32 v3, 0xc0135761, v17
  v_mul_f32 v18, v17, v17
  v_mul_f32 v18, v18, v17
  v_mul_f32 v2, 0xbdd2d3e8, v18
  s_waitcnt lgkmcnt(2)
  v_mfma_f32_32x32x16_bf16 v[96:111], v[52:55], v[180:183], v[96:111]
  s_cmp_eq_u32 s6, 2
  s_cbranch_scc1 L_k1O_c55
L_k1O_c55_r:
  ds_read_b64_tr_b16 v[60:61], v6 offset:23552
  ds_read_b64_tr_b16 v[62:63], v6 offset:23808
  v_lshrrev_b32 v28, 1, v28
  s_lshl_b32 s61, s49, 7
  s_add_u32 s61, s61, 0x21000
  v_add_u32 v28, s61, v28
  ds_write_b32 v28, v17
  s_waitcnt vmcnt(6)
  s_waitcnt lgkmcnt(0)
  s_barrier
  v_mfma_f32_32x32x16_bf16 v[96:111], v[56:59], v[184:187], v[96:111]
  ds_read_b64_tr_b16 v[48:49], v6 offset:32768
  ds_read_b64_tr_b16 v[50:51], v6 offset:33024
  s_add_u32 m0, s54, 0
  s_bfe_u32 s60, s12, 0x40008
  s_mul_i32 s60, s60, 229376
  s_add_u32 s60, s60, s56
  buffer_load_dwordx4 v8, s[32:35], s60 offen lds
  v_and_b32 v28, 0x1f0, v1
  v_add_u32 v28, s4, v28
  ds_read_b128 v[20:23], v28 offset:0
  ds_read_b128 v[24:27], v28 offset:512
  s_waitcnt lgkmcnt(1)
  v_add_f32 v20, v20, v21
  v_add_f32 v22, v22, v23
  v_mfma_f32_32x32x16_bf16 v[96:111], v[60:63], v[188:191], v[96:111]
  s_cmp_eq_u32 s6, 3
  s_cbranch_scc1 L_k1O_c56
L_k1O_c56_r:
  ds_read_b64_tr_b16 v[52:53], v6 offset:33792
  ds_read_b64_tr_b16 v[54:55], v6 offset:34048
  v_add_f32 v20, v20, v22
  v_cvt_pk_bf16_f32 v21, v20, v20
  v_lshlrev_b32 v21, 16, v21
  v_sub_f32 v21, v20, v21
  v_cvt_pk_bf16_f32 v46, v20, v21
  v_mfma_f32_32x32x16_bf16 v[96:111], v[48:51], v[192:195], v[96:111]
  ds_read_b64_tr_b16 v[56:57], v6 offset:34816
  ds_read_b64_tr_b16 v[58:59], v6 offset:35072
  s_add_u32 m0, s54, 8192
  s_bfe_u32 s60, s12, 0x40008
  s_mul_i32 s60, s60, 229376
  s_add_u32 s60, s60, s56
  buffer_load_dwordx4 v8, s[36:39], s60 offen lds
  v_mfma_f32_32x32x8_bf16 v[64:79], v[44:45], v[46:47], v[64:79]
  s_waitcnt lgkmcnt(4)
  v_add_f32 v24, v24, v25
  v_add_f32 v26, v26, v27
  v_add_f32 v24, v24, v26
  v_cvt_pk_bf16_f32 v25, v24, v24
  v_lshlrev_b32 v25, 16, v25
  s_waitcnt lgkmcnt(2)
  v_mfma_f32_32x32x16_bf16 v[96:111], v[52:55], v[196:199], v[96:111]
  s_cmp_eq_u32 s6, 0
  s_cbranch_scc1 L_k1O_c57
L_k1O_c57_r:
  ds_read_b64_tr_b16 v[60:61], v6 offset:35840
  ds_read_b64_tr_b16 v[62:63], v6 offset:36096
  v_sub_f32 v25, v24, v25
  v_cvt_pk_bf16_f32 v46, v24, v25
  s_nop 1
  v_mfma_f32_32x32x8_bf16 v[80:95], v[44:45], v[46:47], v[80:95]
  s_waitcnt lgkmcnt(2)
  v_mfma_f32_32x32x16_bf16 v[96:111], v[56:59], v[200:203], v[96:111]
  ds_read_b64_tr_b16 v[48:49], v6 offset:36864
  ds_read_b64_tr_b16 v[50:51], v6 offset:37120
  v_lshrrev_b32 v28, 9, v1
  v_lshlrev_b32 v28, 4, v28
  s_lshl_b32 s61, s49, 7
  v_add_u32 v28, s61, v28
  v_add_u32 v28, 0x21000, v28
  s_waitcnt lgkmcnt(2)
  v_mfma_f32_32x32x16_bf16 v[96:111], v[60:63], v[204:207], v[96:111]
  s_cmp_eq_u32 s6, 1
  s_cbranch_scc1 L_k1O_c58
L_k1O_c58_r:
  ds_read_b64_tr_b16 v[52:53], v6 offset:37888
  ds_read_b64_tr_b16 v[54:55], v6 offset:38144
  ds_read_b128 v[12:15], v28 offset:0
  ds_read_b128 v[16:19], v28 offset:32
  ds_read_b128 v[20:23], v28 offset:64
  ds_read_b128 v[24:27], v28 offset:96
  s_waitcnt lgkmcnt(3)
  v_mul_f32 v80, v80, v12
  v_mul_f32 v81, v81, v13
  v_mfma_f32_32x32x16_bf16 v[96:111], v[48:51], v[208:211], v[96:111]
  ds_read_b64_tr_b16 v[56:57], v6 offset:38912
  ds_read_b64_tr_b16 v[58:59], v6 offset:39168
  v_mul_f32 v82, v82, v14
  v_mul_f32 v83, v83, v15
  s_waitcnt lgkmcnt(4)
  v_mul_f32 v84, v84, v16
  v_mul_f32 v85, v85, v17
  v_mul_f32 v86, v86, v18
  v_mul_f32 v87, v87, v19
  v_mfma_f32_32x32x16_bf16 v[96:111], v[52:55], v[212:215], v[96:111]
  s_cmp_eq_u32 s6, 2
  s_cbranch_scc1 L_k1O_c59
L_k1O_c59_r:
  ds_read_b64_tr_b16 v[60:61], v6 offset:39936
  ds_read_b64_tr_b16 v[62:63], v6 offset:40192
  s_waitcnt lgkmcnt(5)
  v_mul_f32 v88, v88, v20
  v_mul_f32 v89, v89, v21
  v_mul_f32 v90, v90, v22
  v_mul_f32 v91, v91, v23
  s_waitcnt lgkmcnt(4)
  v_mul_f32 v92, v92, v24
  v_mul_f32 v93, v93, v25
  s_waitcnt vmcnt(6)
  s_barrier
  s_waitcnt lgkmcnt(2)
  v_mfma_f32_32x32x16_bf16 v[96:111], v[56:59], v[216:219], v[96:111]
  ds_read_b64_tr_b16 v[48:49], v6 offset:49152
  ds_read_b64_tr_b16 v[50:51], v6 offset:49408
  s_add_u32 m0, s54, 16384
  s_bfe_u32 s60, s12, 0x4000c
  s_mul_i32 s60, s60, 229376
  s_add_u32 s60, s60, s56
  buffer_load_dwordx4 v8, s[32:35], s60 offen lds
  v_mul_f32 v94, v94, v26
  v_mul_f32 v95, v95, v27
  v_mul_f32 v64, v64, v12
  v_mul_f32 v65, v65, v13
  v_mul_f32 v66, v66, v14
  v_mul_f32 v67, v67, v15
  s_waitcnt lgkmcnt(2)
  v_mfma_f32_32x32x16_bf16 v[96:111], v[60:63], v[220:223], v[96:111]
  s_cmp_eq_u32 s6, 3
  s_cbranch_scc1 L_k1O_c60
L_k1O_c60_r:
  ds_read_b64_tr_b16 v[52:53], v6 offset:50176
  ds_read_b64_tr_b16 v[54:55], v6 offset:50432
  v_min_f32 v28, 0, v64
  v_min_f32 v29, 0, v65
  v_min_f32 v30, 0, v66
  v_min_f32 v31, 0, v67
  v_mul_f32 v28, 0x3fb8aa3b, v28
  v_mul_f32 v29, 0x3fb8aa3b, v29
  s_waitcnt lgkmcnt(2)
  v_mfma_f32_32x32x16_bf16 v[96:111], v[48:51], v[224:227], v[96:111]
  ds_read_b64_tr_b16 v[56:57], v6 offset:51200
  ds_read_b64_tr_b16 v[58:59], v6 offset:51456
  s_add_u32 m0, s54, 24576
  s_bfe_u32 s60, s12, 0x4000c
  s_mul_i32 s60, s60, 229376
  s_add_u32 s60, s60, s56
  buffer_load_dwordx4 v8, s[36:39], s60 offen lds
  v_mul_f32 v30, 0x3fb8aa3b, v30
  v_mul_f32 v31, 0x3fb8aa3b, v31
  v_exp_f32 v28, v28
  v_exp_f32 v29, v29
  v_exp_f32 v30, v30
  v_exp_f32 v31, v31
  s_waitcnt lgkmcnt(2)
  v_mfma_f32_32x32x16_bf16 v[96:111], v[52:55], v[228:231], v[96:111]
  s_cmp_eq_u32 s6, 0
  s_cbranch_scc1 L_k1O_c61
L_k1O_c61_r:
  ds_read_b64_tr_b16 v[60:61], v6 offset:52224
  ds_read_b64_tr_b16 v[62:63], v6 offset:52480
  v_max_f32 v64, 0, v64
  v_max_f32 v65, 0, v65
  v_max_f32 v66, 0, v66
  v_max_f32 v67, 0, v67
  v_add_f32 v28, 0x358637bd, v28
  v_add_f32 v29, 0x358637bd, v29
  s_waitcnt lgkmcnt(2)
  v_mfma_f32_32x32x16_bf16 v[96:111], v[56:59], v[232:235], v[96:111]
  ds_read_b64_tr_b16 v[48:49], v6 offset:53248
  ds_read_b64_tr_b16 v[50:51], v6 offset:53504
  v_add_f32 v30, 0x358637bd, v30
  v_add_f32 v31, 0x358637bd, v31
  v_add_f32 v64, v64, v28
  v_add_f32 v65, v65, v29
  v_add_f32 v66, v66, v30
  v_add_f32 v67, v67, v31
  s_waitcnt lgkmcnt(2)
  v_mfma_f32_32x32x16_bf16 v[96:111], v[60:63], v[236:239], v[96:111]
  s_cmp_eq_u32 s6, 1
  s_cbranch_scc1 L_k1O_c62
L_k1O_c62_r:
  ds_read_b64_tr_b16 v[52:53], v6 offset:54272
  ds_read_b64_tr_b16 v[54:55], v6 offset:54528
  v_cvt_pk_bf16_f32 v64, v64, v65
  v_cvt_pk_bf16_f32 v65, v66, v67
  v_mul_f32 v68, v68, v16
  v_mul_f32 v69, v69, v17
  v_mul_f32 v70, v70, v18
  v_mul_f32 v71, v71, v19
  s_waitcnt lgkmcnt(2)
  v_mfma_f32_32x32x16_bf16 v[96:111], v[48:51], v[240:243], v[96:111]
  ds_read_b64_tr_b16 v[56:57], v6 offset:55296
  ds_read_b64_tr_b16 v[58:59], v6 offset:55552
  v_min_f32 v28, 0, v68
  v_min_f32 v29, 0, v69
  v_min_f32 v30, 0, v70
  v_min_f32 v31, 0, v71
  v_mul_f32 v28, 0x3fb8aa3b, v28
  v_mul_f32 v29, 0x3fb8aa3b, v29
  s_waitcnt lgkmcnt(2)
  v_mfma_f32_32x32x16_bf16 v[96:111], v[52:55], v[244:247], v[96:111]
  s_cmp_eq_u32 s6, 2
  s_cbranch_scc1 L_k1O_c63
L_k1O_c63_r:
  ds_read_b64_tr_b16 v[60:61], v6 offset:56320
  ds_read_b64_tr_b16 v[62:63], v6 offset:56576
  v_mul_f32 v30, 0x3fb8aa3b, v30
  v_mul_f32 v31, 0x3fb8aa3b, v31
  v_exp_f32 v28, v28
  v_exp_f32 v29, v29
  v_exp_f32 v30, v30
  v_exp_f32 v31, v31
  s_waitcnt lgkmcnt(2)
  v_mfma_f32_32x32x16_bf16 v[96:111], v[56:59], v[248:251], v[96:111]
  v_max_f32 v68, 0, v68
  v_max_f32 v69, 0, v69
  v_max_f32 v70, 0, v70
  v_max_f32 v71, 0, v71
  v_add_f32 v28, 0x358637bd, v28
  v_add_f32 v29, 0x358637bd, v29
  s_waitcnt vmcnt(6)
  s_barrier
  s_waitcnt lgkmcnt(0)
  v_mfma_f32_32x32x16_bf16 v[96:111], v[60:63], v[252:255], v[96:111]
  s_cmp_eq_u32 s6, 3
  s_cbranch_scc1 L_k1O_c64
L_k1O_c64_r:
  s_nop 7
  v_lshrrev_b32 v38, 9, v1
  v_lshlrev_b32 v38, 3, v38
  v_bfe_u32 v39, v1, 6, 2
  v_add_u32 v38, v38, v39
  v_bfe_u32 v39, v1, 8, 1
  v_bfe_u32 v42, v1, 5, 1
  v_lshl_add_u32 v42, v39, 1, v42
  s_lshl_b32 s60, s50, 2
  v_add_u32 v42, s60, v42
  v_bfe_u32 v43, v1, 7, 1
  v_lshlrev_b32 v43, 2, v43
  v_xor_b32 v42, v42, v43
  v_lshlrev_b32 v42, 4, v42
  v_lshl_add_u32 v6, v38, 7, v42
  v_bfe_u32 v43, v1, 4, 1
  v_lshl_add_u32 v6, v43, 3, v6
  v_add_u32 v7, 0x10000, v6
  ds_read_b64_tr_b16 v[48:49], v7 offset:0
  ds_read_b64_tr_b16 v[50:51], v7 offset:512
  ds_read_b64_tr_b16 v[52:53], v7 offset:8192
  ds_read_b64_tr_b16 v[54:55], v7 offset:8704
  v_add_f32 v30, 0x358637bd, v30
  v_add_f32 v31, 0x358637bd, v31
  v_add_f32 v68, v68, v28
  v_add_f32 v69, v69, v29
  v_add_f32 v70, v70, v30
  v_add_f32 v71, v71, v31
  v_cvt_pk_bf16_f32 v66, v68, v69
  v_cvt_pk_bf16_f32 v67, v70, v71
  v_mul_f32 v72, v72, v20
  v_mul_f32 v73, v73, v21
  v_mul_f32 v74, v74, v22
  v_mul_f32 v75, v75, v23
  v_min_f32 v28, 0, v72
  v_min_f32 v29, 0, v73
  v_min_f32 v30, 0, v74
  v_min_f32 v31, 0, v75
  v_mul_f32 v28, 0x3fb8aa3b, v28
  v_mul_f32 v29, 0x3fb8aa3b, v29
  v_mul_f32 v30, 0x3fb8aa3b, v30
  v_mul_f32 v31, 0x3fb8aa3b, v31
  v_exp_f32 v28, v28
  v_exp_f32 v29, v29
  v_exp_f32 v30, v30
  v_exp_f32 v31, v31
  v_max_f32 v72, 0, v72
  v_max_f32 v73, 0, v73
  v_max_f32 v74, 0, v74
  v_max_f32 v75, 0, v75
  v_add_f32 v28, 0x358637bd, v28
  v_add_f32 v29, 0x358637bd, v29
  v_add_f32 v30, 0x358637bd, v30
  v_add_f32 v31, 0x358637bd, v31
  v_add_f32 v72, v72, v28
  v_add_f32 v73, v73, v29
  v_add_f32 v74, v74, v30
  v_add_f32 v75, v75, v31
  v_cvt_pk_bf16_f32 v68, v72, v73
  v_cvt_pk_bf16_f32 v69, v74, v75
  v_mul_f32 v76, v76, v24
  v_mul_f32 v77, v77, v25
  v_mul_f32 v78, v78, v26
  v_mul_f32 v79, v79, v27
  v_min_f32 v28, 0, v76
  v_min_f32 v29, 0, v77
  v_min_f32 v30, 0, v78
  v_min_f32 v31, 0, v79
  v_mul_f32 v28, 0x3fb8aa3b, v28
  v_mul_f32 v29, 0x3fb8aa3b, v29
  v_mul_f32 v30, 0x3fb8aa3b, v30
  v_mul_f32 v31, 0x3fb8aa3b, v31
  v_exp_f32 v28, v28
  v_exp_f32 v29, v29
  v_exp_f32 v30, v30
  v_exp_f32 v31, v31
  v_max_f32 v76, 0, v76
  v_max_f32 v77, 0, v77
  v_max_f32 v78, 0, v78
  v_max_f32 v79, 0, v79
  v_add_f32 v28, 0x358637bd, v28
  v_add_f32 v29, 0x358637bd, v29
  v_add_f32 v30, 0x358637bd, v30
  v_add_f32 v31, 0x358637bd, v31
  v_add_f32 v76, v76, v28
  v_add_f32 v77, v77, v29
  v_add_f32 v78, v78, v30
  v_add_f32 v79, v79, v31
  v_cvt_pk_bf16_f32 v70, v76, v77
  v_cvt_pk_bf16_f32 v71, v78, v79
  v_cvt_pk_bf16_f32 v12, v80, v81
  v_cvt_pk_bf16_f32 v13, v82, v83
  v_cvt_pk_bf16_f32 v14, v84, v85
  v_cvt_pk_bf16_f32 v15, v86, v87
  v_cvt_pk_bf16_f32 v16, v88, v89
  v_cvt_pk_bf16_f32 v17, v90, v91
  v_cvt_pk_bf16_f32 v18, v92, v93
  v_cvt_pk_bf16_f32 v19, v94, v95
  v_cndmask_b32 v80, v5, v12, s[64:65]
  v_cndmask_b32 v81, v5, v13, s[64:65]
  v_cndmask_b32 v82, v5, v14, s[64:65]
  v_cndmask_b32 v83, v5, v15, s[64:65]
  v_cndmask_b32 v84, v5, v16, s[64:65]
  v_cndmask_b32 v85, v5, v17, s[64:65]
  v_cndmask_b32 v86, v5, v18, s[64:65]
  v_cndmask_b32 v87, v5, v19, s[64:65]
  v_cndmask_b32 v88, v12, v5, s[64:65]
  v_cndmask_b32 v89, v13, v5, s[64:65]
  v_cndmask_b32 v90, v14, v5, s[64:65]
  v_cndmask_b32 v91, v15, v5, s[64:65]
  v_cndmask_b32 v92, v16, v5, s[64:65]
  v_cndmask_b32 v93, v17, v5, s[64:65]
  v_cndmask_b32 v94, v18, v5, s[64:65]
  v_cndmask_b32 v95, v19, v5, s[64:65]
  s_lshl_b32 s61, s49, 13
  s_lshl_b32 s62, s50, 12
  s_add_u32 s61, s61, s62
  s_add_u32 s61, s61, 0x18000
  v_add_u32 v28, s61, v1
  v_mfma_f32_32x32x16_bf16 v[12:27], v[64:67], v[80:83], 0
  v_mfma_f32_32x32x16_bf16 v[12:27], v[68:71], v[84:87], v[12:27]
  s_nop 11
  ds_write_b128 v28, v[12:15] offset:0
  ds_write_b128 v28, v[16:19] offset:1024
  s_nop 0
  v_mfma_f32_32x32x16_bf16 v[12:27], v[64:67], v[88:91], 0
  v_mfma_f32_32x32x16_bf16 v[12:27], v[68:71], v[92:95], v[12:27]
  s_nop 11
  ds_write_b128 v28, v[20:23] offset:2048
  ds_write_b128 v28, v[24:27] offset:3072
  s_memtime s[20:21]
  v_mov_b32 v29, 0x23c00
  s_nop 0
  v_add_u32 v28, s5, v1
  v_cmp_gt_u32 vcc, 256, v1
  s_nop 1
  v_cndmask_b32 v28, v29, v28
  ds_write_b32 v28, v36 offset:2048
  ds_write_b32 v28, v37 offset:2304
  s_waitcnt lgkmcnt(8)
  v_mfma_f32_32x32x16_bf16 v[64:79], v[48:51], v[128:131], 0
  ds_read_b64_tr_b16 v[56:57], v7 offset:2048
  ds_read_b64_tr_b16 v[58:59], v7 offset:2560
  s_waitcnt lgkmcnt(8)
  v_mfma_f32_32x32x16_bf16 v[80:95], v[52:55], v[128:131], 0
  s_cmp_eq_u32 s6, 0
  s_cbranch_scc1 L_k1O_c65
L_k1O_c65_r:
  ds_read_b64_tr_b16 v[60:61], v7 offset:10240
  ds_read_b64_tr_b16 v[62:63], v7 offset:10752
  s_add_u32 m0, s54, 32768
  s_bfe_u32 s60, s12, 0x40010
  s_mul_i32 s60, s60, 229376
  s_add_u32 s60, s60, s56
  buffer_load_dwordx4 v8, s[32:35], s60 offen lds
  s_waitcnt lgkmcnt(2)
  v_mfma_f32_32x32x16_bf16 v[64:79], v[56:59], v[132:135], v[64:79]
  ds_read_b64_tr_b16 v[48:49], v7 offset:4096
  ds_read_b64_tr_b16 v[50:51], v7 offset:4608
  s_waitcnt lgkmcnt(2)
  v_mfma_f32_32x32x16_bf16 v[80:95], v[60:63], v[132:135], v[80:95]
  s_cmp_eq_u32 s6, 1
  s_cbranch_scc1 L_k1O_c66
L_k1O_c66_r:
  ds_read_b64_tr_b16 v[52:53], v7 offset:12288
  ds_read_b64_tr_b16 v[54:55], v7 offset:12800
  s_waitcnt lgkmcnt(2)
  v_mfma_f32_32x32x16_bf16 v[64:79], v[48:51], v[136:139], v[64:79]
  ds_read_b64_tr_b16 v[56:57], v7 offset:6144
  ds_read_b64_tr_b16 v[58:59], v7 offset:6656
  s_waitcnt lgkmcnt(2)
  v_mfma_f32_32x32x16_bf16 v[80:95], v[52:55], v[136:139], v[80:95]
  s_cmp_eq_u32 s6, 2
  s_cbranch_scc1 L_k1O_c67
L_k1O_c67_r:
  ds_read_b64_tr_b16 v[60:61], v7 offset:14336
  ds_read_b64_tr_b16 v[62:63], v7 offset:14848
  s_add_u32 m0, s54, 40960
  s_bfe_u32 s60, s12, 0x40010
  s_mul_i32 s60, s60, 229376
  s_add_u32 s60, s60, s56
  buffer_load_dwordx4 v8, s[36:39], s60 offen lds
  s_waitcnt vmcnt(6)
  s_barrier
  v_readfirstlane_b32 s62, v0
  s_nop 1
  s_cmp_ge_u32 s62, 1
  s_cbranch_scc1 L_zO_ok
  s_mov_b32 s82, 0
L_zO_spin:
  s_sleep 16
  buffer_load_dword v0, off, s[44:47], s18 sc1
  s_waitcnt vmcnt(0)
  v_readfirstlane_b32 s62, v0
  s_add_u32 s82, s82, 1
  s_cmp_ge_u32 s82, 0x100000
  s_cbranch_scc1 L_zO_ok
  s_cmp_ge_u32 s62, 1
  s_cbranch_scc0 L_zO_spin
L_zO_ok:
  s_nop 1
  v_add_u32 v12, s54, v1
  v_add_u32 v12, 0x18000, v12
  ds_read_b128 v[112:115], v12 offset:0
  ds_read_b128 v[116:119], v12 offset:8192
  ds_read_b128 v[120:123], v12 offset:16384
  ds_read_b128 v[124:127], v12 offset:24576
  s_waitcnt lgkmcnt(2)
  v_add_f32 v112, v112, v116
  v_add_f32 v113, v113, v117
  v_add_f32 v114, v114, v118
  v_add_f32 v115, v115, v119
  s_waitcnt lgkmcnt(0)
  v_add_f32 v120, v120, v124
  v_add_f32 v121, v121, v125
  v_add_f32 v122, v122, v126
  v_add_f32 v123, v123, v127
  v_add_f32 v112, v112, v120
  v_add_f32 v113, v113, v121
  v_add_f32 v114, v114, v122
  v_add_f32 v115, v115, v123
  v_lshrrev_b32 v13, 2, v1
  s_add_u32 s61, s84, s54
  buffer_atomic_add_f32 v112, v13, s[40:43], s61 offen offset:0
  buffer_atomic_add_f32 v113, v13, s[40:43], s61 offen offset:256
  buffer_atomic_add_f32 v114, v13, s[40:43], s61 offen offset:512
  buffer_atomic_add_f32 v115, v13, s[40:43], s61 offen offset:768
  v_mfma_f32_32x32x16_bf16 v[64:79], v[56:59], v[140:143], v[64:79]
  ds_read_b64_tr_b16 v[48:49], v7 offset:16384
  ds_read_b64_tr_b16 v[50:51], v7 offset:16896
  v_and_b32 v28, 0x1f0, v1
  v_add_u32 v28, s4, v28
  ds_read_b128 v[20:23], v28 offset:2048
  s_waitcnt lgkmcnt(0)
  v_add_f32 v20, v20, v21
  v_mfma_f32_32x32x16_bf16 v[80:95], v[60:63], v[140:143], v[80:95]
  s_cmp_eq_u32 s6, 3
  s_cbranch_scc1 L_k1O_c68
L_k1O_c68_r:
  ds_read_b64_tr_b16 v[52:53], v7 offset:24576
  ds_read_b64_tr_b16 v[54:55], v7 offset:25088
  v_add_f32 v22, v22, v23
  v_add_f32 v20, v20, v22
  v_cvt_pk_bf16_f32 v21, v20, v20
  v_lshlrev_b32 v21, 16, v21
  v_mfma_f32_32x32x16_bf16 v[64:79], v[48:51], v[144:147], v[64:79]
  ds_read_b64_tr_b16 v[56:57], v7 offset:18432
  ds_read_b64_tr_b16 v[58:59], v7 offset:18944
  v_sub_f32 v21, v20, v21
  v_cvt_pk_bf16_f32 v46, v20, v21
  s_nop 1
  v_mfma_f32_32x32x8_bf16 v[96:111], v[46:47], v[44:45], v[96:111]
  s_waitcnt lgkmcnt(2)
  v_mfma_f32_32x32x16_bf16 v[80:95], v[52:55], v[144:147], v[80:95]
  s_cmp_eq_u32 s6, 0
  s_cbranch_scc1 L_k1O_c69
L_k1O_c69_r:
  ds_read_b64_tr_b16 v[60:61], v7 offset:26624
  ds_read_b64_tr_b16 v[62:63], v7 offset:27136
  s_add_u32 m0, s54, 49152
  s_bfe_u32 s60, s12, 0x40014
  s_mul_i32 s60, s60, 229376
  s_add_u32 s60, s60, s56
  buffer_load_dwordx4 v8, s[32:35], s60 offen lds
  s_nop 0
  v_mul_f32 v28, v96, v96
  s_waitcnt lgkmcnt(2)
  v_mfma_f32_32x32x16_bf16 v[64:79], v[56:59], v[148:151], v[64:79]
  ds_read_b64_tr_b16 v[48:49], v7 offset:20480
  ds_read_b64_tr_b16 v[50:51], v7 offset:20992
  v_mul_f32 v29, v97, v97
  v_mul_f32 v30, v98, v98
  v_mul_f32 v31, v99, v99
  v_fma_f32 v28, v28, v2, v3
  s_waitcnt lgkmcnt(2)
  v_mfma_f32_32x32x16_bf16 v[80:95], v[60:63], v[148:151], v[80:95]
  s_cmp_eq_u32 s6, 1
  s_cbranch_scc1 L_k1O_c70
L_k1O_c70_r:
  ds_read_b64_tr_b16 v[52:53], v7 offset:28672
  ds_read_b64_tr_b16 v[54:55], v7 offset:29184
  v_fma_f32 v29, v29, v2, v3
  v_fma_f32 v30, v30, v2, v3
  v_fma_f32 v31, v31, v2, v3
  v_mul_f32 v28, v96, v28
  s_waitcnt lgkmcnt(2)
  v_mfma_f32_32x32x16_bf16 v[64:79], v[48:51], v[152:155], v[64:79]
  ds_read_b64_tr_b16 v[56:57], v7 offset:22528
  ds_read_b64_tr_b16 v[58:59], v7 offset:23040
  v_mul_f32 v29, v97, v29
  v_mul_f32 v30, v98, v30
  v_mul_f32 v31, v99, v31
  v_exp_f32 v28, v28
  s_waitcnt lgkmcnt(2)
  v_mfma_f32_32x32x16_bf16 v[80:95], v[52:55], v[152:155], v[80:95]
  s_cmp_eq_u32 s6, 2
  s_cbranch_scc1 L_k1O_c71
L_k1O_c71_r:
  ds_read_b64_tr_b16 v[60:61], v7 offset:30720
  ds_read_b64_tr_b16 v[62:63], v7 offset:31232
  s_add_u32 m0, s54, 57344
  s_bfe_u32 s60, s12, 0x40014
  s_mul_i32 s60, s60, 229376
  s_add_u32 s60, s60, s56
  buffer_load_dwordx4 v8, s[36:39], s60 offen lds
  v_exp_f32 v29, v29
  v_exp_f32 v30, v30
  v_exp_f32 v31, v31
  v_mul_f32 v104, v96, v104
  s_waitcnt vmcnt(10)
  s_barrier
  s_waitcnt lgkmcnt(2)
  v_mfma_f32_32x32x16_bf16 v[64:79], v[56:59], v[156:159], v[64:79]
  ds_read_b64_tr_b16 v[48:49], v6 offset:0
  ds_read_b64_tr_b16 v[50:51], v6 offset:512
  v_mul_f32 v105, v97, v105
  v_mul_f32 v106, v98, v106
  v_mul_f32 v107, v99, v107
  v_fma_f32 v28, v28, v4, v4
  s_waitcnt lgkmcnt(2)
  v_mfma_f32_32x32x16_bf16 v[80:95], v[60:63], v[156:159], v[80:95]
  s_cmp_eq_u32 s6, 3
  s_cbranch_scc1 L_k1O_c72
L_k1O_c72_r:
  ds_read_b64_tr_b16 v[52:53], v6 offset:8192
  ds_read_b64_tr_b16 v[54:55], v6 offset:8704
  v_fma_f32 v29, v29, v4, v4
  v_fma_f32 v30, v30, v4, v4
  v_fma_f32 v31, v31, v4, v4
  v_rcp_f32 v28, v28
  s_waitcnt lgkmcnt(2)
  v_mfma_f32_32x32x16_bf16 v[64:79], v[48:51], v[160:163], v[64:79]
  ds_read_b64_tr_b16 v[56:57], v6 offset:2048
  ds_read_b64_tr_b16 v[58:59], v6 offset:2560
  v_rcp_f32 v29, v29
  v_rcp_f32 v30, v30
  v_rcp_f32 v31, v31
  v_mul_f32 v104, v104, v28
  s_waitcnt lgkmcnt(2)
  v_mfma_f32_32x32x16_bf16 v[80:95], v[52:55], v[160:163], v[80:95]
  s_cmp_eq_u32 s6, 0
  s_cbranch_scc1 L_k1O_c73
L_k1O_c73_r:
  ds_read_b64_tr_b16 v[60:61], v6 offset:10240
  ds_read_b64_tr_b16 v[62:63], v6 offset:10752
  s_add_u32 m0, s54, 65536
  s_bfe_u32 s60, s12, 0x40018
  s_mul_i32 s60, s60, 229376
  s_add_u32 s60, s60, s56
  buffer_load_dwordx4 v8, s[32:35], s60 offen lds
  v_mul_f32 v105, v105, v29
  v_mul_f32 v106, v106, v30
  v_mul_f32 v107, v107, v31
  v_cvt_pk_bf16_f32 v20, v104, v105
  s_waitcnt lgkmcnt(2)
  v_mfma_f32_32x32x16_bf16 v[64:79], v[56:59], v[164:167], v[64:79]
  ds_read_b64_tr_b16 v[48:49], v6 offset:4096
  ds_read_b64_tr_b16 v[50:51], v6 offset:4608
  v_cvt_pk_bf16_f32 v21, v106, v107
  v_mul_f32 v28, v100, v100
  v_mul_f32 v29, v101, v101
  v_mul_f32 v30, v102, v102
  s_waitcnt lgkmcnt(2)
  v_mfma_f32_32x32x16_bf16 v[80:95], v[60:63], v[164:167], v[80:95]
  s_cmp_eq_u32 s6, 1
  s_cbranch_scc1 L_k1O_c74
L_k1O_c74_r:
  ds_read_b64_tr_b16 v[52:53], v6 offset:12288
  ds_read_b64_tr_b16 v[54:55], v6 offset:12800
  v_mul_f32 v31, v103, v103
  v_fma_f32 v28, v28, v2, v3
  v_fma_f32 v29, v29, v2, v3
  v_fma_f32 v30, v30, v2, v3
  s_waitcnt lgkmcnt(2)
  v_mfma_f32_32x32x16_bf16 v[64:79], v[48:51], v[168:171], v[64:79]
  ds_read_b64_tr_b16 v[56:57], v6 offset:6144
  ds_read_b64_tr_b16 v[58:59], v6 offset:6656
  v_fma_f32 v31, v31, v2, v3
  v_mul_f32 v28, v100, v28
  v_mul_f32 v29, v101, v29
  v_mul_f32 v30, v102, v30
  s_waitcnt lgkmcnt(2)
  v_mfma_f32_32x32x16_bf16 v[80:95], v[52:55], v[168:171], v[80:95]
  s_cmp_eq_u32 s6, 2
  s_cbranch_scc1 L_k1O_c75
L_k1O_c75_r:
  ds_read_b64_tr_b16 v[60:61], v6 offset:14336
  ds_read_b64_tr_b16 v[62:63], v6 offset:14848
  s_add_u32 m0, s54, 73728
  s_bfe_u32 s60, s12, 0x40018
  s_mul_i32 s60, s60, 229376
  s_add_u32 s60, s60, s56
  buffer_load_dwordx4 v8, s[36:39], s60 offen lds
  v_mul_f32 v31, v103, v31
  v_exp_f32 v28, v28
  v_exp_f32 v29, v29
  v_exp_f32 v30, v30
  s_waitcnt vmcnt(10)
  s_waitcnt vmcnt(4)
  s_barrier
  v_add_u32 v15, s54, v1
  v_mov_b32 v16, 0x7ffffff0
  v_cmp_ne_u32 vcc, 0, v15
  s_nop 1
  v_cndmask_b32 v15, v15, v16
  v_mov_b32 v16, 1
  buffer_atomic_add v16, v15, s[40:43], s88 offen
  s_waitcnt lgkmcnt(2)
  v_mfma_f32_32x32x16_bf16 v[64:79], v[56:59], v[172:175], v[64:79]
  ds_read_b64_tr_b16 v[48:49], v6 offset:16384
  ds_read_b64_tr_b16 v[50:51], v6 offset:16896
  v_exp_f32 v31, v31
  v_mul_f32 v108, v100, v108
  v_mul_f32 v109, v101, v109
  v_mul_f32 v110, v102, v110
  s_waitcnt lgkmcnt(2)
  v_mfma_f32_32x32x16_bf16 v[80:95], v[60:63], v[172:175], v[80:95]
  s_cmp_eq_u32 s6, 3
  s_cbranch_scc1 L_k1O_c76
L_k1O_c76_r:
  ds_read_b64_tr_b16 v[52:53], v6 offset:24576
  ds_read_b64_tr_b16 v[54:55], v6 offset:25088
  v_mul_f32 v111, v103, v111
  v_fma_f32 v28, v28, v4, v4
  v_fma_f32 v29, v29, v4, v4
  v_fma_f32 v30, v30, v4, v4
  s_waitcnt lgkmcnt(2)
  v_mfma_f32_32x32x16_bf16 v[64:79], v[48:51], v[176:179], v[64:79]
  ds_read_b64_tr_b16 v[56:57], v6 offset:18432
  ds_read_b64_tr_b16 v[58:59], v6 offset:18944
  v_fma_f32 v31, v31, v4, v4
  v_rcp_f32 v28, v28
  v_rcp_f32 v29, v29
  v_rcp_f32 v30, v30
  s_waitcnt lgkmcnt(2)
  v_mfma_f32_32x32x16_bf16 v[80:95], v[52:55], v[176:179], v[80:95]
  s_cmp_eq_u32 s6, 0
  s_cbranch_scc1 L_k1O_c77
L_k1O_c77_r:
  ds_read_b64_tr_b16 v[60:61], v6 offset:26624
  ds_read_b64_tr_b16 v[62:63], v6 offset:27136
  s_add_u32 m0, s54, 81920
  s_bfe_u32 s60, s12, 0x4001c
  s_mul_i32 s60, s60, 229376
  s_add_u32 s60, s60, s56
  buffer_load_dwordx4 v8, s[32:35], s60 offen lds
  v_rcp_f32 v31, v31
  v_mul_f32 v108, v108, v28
  v_mul_f32 v109, v109, v29
  v_mul_f32 v110, v110, v30
  s_waitcnt lgkmcnt(2)
  v_mfma_f32_32x32x16_bf16 v[64:79], v[56:59], v[180:183], v[64:79]
  ds_read_b64_tr_b16 v[48:49], v6 offset:20480
  ds_read_b64_tr_b16 v[50:51], v6 offset:20992
  v_mul_f32 v111, v111, v31
  v_cvt_pk_bf16_f32 v22, v108, v109
  v_cvt_pk_bf16_f32 v23, v110, v111
  s_add_u32 s61, s67, 0
  s_waitcnt lgkmcnt(2)
  v_mfma_f32_32x32x16_bf16 v[80:95], v[60:63], v[180:183], v[80:95]
  s_cmp_eq_u32 s6, 1
  s_cbranch_scc1 L_k1O_c78
L_k1O_c78_r:
  ds_read_b64_tr_b16 v[52:53], v6 offset:28672
  ds_read_b64_tr_b16 v[54:55], v6 offset:29184
  buffer_store_dwordx4 v[20:23], v1, s[40:43], s61 offen sc1
  s_waitcnt lgkmcnt(2)
  v_mfma_f32_32x32x16_bf16 v[64:79], v[48:51], v[184:187], v[64:79]
  ds_read_b64_tr_b16 v[56:57], v6 offset:22528
  ds_read_b64_tr_b16 v[58:59], v6 offset:23040
  s_waitcnt lgkmcnt(2)
  v_mfma_f32_32x32x16_bf16 v[80:95], v[52:55], v[184:187], v[80:95]
  s_cmp_eq_u32 s6, 2
  s_cbranch_scc1 L_k1O_c79
L_k1O_c79_r:
  ds_read_b64_tr_b16 v[60:61], v6 offset:30720
  ds_read_b64_tr_b16 v[62:63], v6 offset:31232
  s_add_u32 m0, s54, 90112
  s_bfe_u32 s60, s12, 0x4001c
  s_mul_i32 s60, s60, 229376
  s_add_u32 s60, s60, s56
  buffer_load_dwordx4 v8, s[36:39], s60 offen lds
  s_barrier
  s_waitcnt lgkmcnt(2)
  v_mfma_f32_32x32x16_bf16 v[64:79], v[56:59], v[188:191], v[64:79]
  ds_read_b64_tr_b16 v[48:49], v6 offset:32768
  ds_read_b64_tr_b16 v[50:51], v6 offset:33280
  s_waitcnt lgkmcnt(2)
  v_mfma_f32_32x32x16_bf16 v[80:95], v[60:63], v[188:191], v[80:95]
  s_cmp_eq_u32 s6, 3
  s_cbranch_scc1 L_k1O_c80
L_k1O_c80_r:
  ds_read_b64_tr_b16 v[52:53], v6 offset:40960
  ds_read_b64_tr_b16 v[54:55], v6 offset:41472
  s_waitcnt lgkmcnt(2)
  v_mfma_f32_32x32x16_bf16 v[64:79], v[48:51], v[192:195], v[64:79]
  ds_read_b64_tr_b16 v[56:57], v6 offset:34816
  ds_read_b64_tr_b16 v[58:59], v6 offset:35328
  s_waitcnt lgkmcnt(2)
  v_mfma_f32_32x32x16_bf16 v[80:95], v[52:55], v[192:195], v[80:95]
  s_cmp_eq_u32 s6, 0
  s_cbranch_scc1 L_k1O_c81
L_k1O_c81_r:
  ds_read_b64_tr_b16 v[60:61], v6 offset:43008
  ds_read_b64_tr_b16 v[62:63], v6 offset:43520
  s_waitcnt lgkmcnt(2)
  v_mfma_f32_32x32x16_bf16 v[64:79], v[56:59], v[196:199], v[64:79]
  ds_read_b64_tr_b16 v[48:49], v6 offset:36864
  ds_read_b64_tr_b16 v[50:51], v6 offset:37376
  s_waitcnt lgkmcnt(2)
  v_mfma_f32_32x32x16_bf16 v[80:95], v[60:63], v[196:199], v[80:95]
  s_cmp_eq_u32 s6, 1
  s_cbranch_scc1 L_k1O_c82
L_k1O_c82_r:
  ds_read_b64_tr_b16 v[52:53], v6 offset:45056
  ds_read_b64_tr_b16 v[54:55], v6 offset:45568
  s_waitcnt lgkmcnt(2)
  v_mfma_f32_32x32x16_bf16 v[64:79], v[48:51], v[200:203], v[64:79]
  ds_read_b64_tr_b16 v[56:57], v6 offset:38912
  ds_read_b64_tr_b16 v[58:59], v6 offset:39424
  s_waitcnt lgkmcnt(2)
  v_mfma_f32_32x32x16_bf16 v[80:95], v[52:55], v[200:203], v[80:95]
  s_cmp_eq_u32 s6, 2
  s_cbranch_scc1 L_k1O_c83
L_k1O_c83_r:
  ds_read_b64_tr_b16 v[60:61], v6 offset:47104
  ds_read_b64_tr_b16 v[62:63], v6 offset:47616
  s_waitcnt vmcnt(6)
  s_waitcnt vmcnt(1)
  s_barrier
  v_add_u32 v15, s54, v1
  v_mov_b32 v16, 0x7ffffff0
  v_cmp_ne_u32 vcc, 0, v15
  s_nop 1
  v_cndmask_b32 v15, v15, v16
  v_mov_b32 v16, 1
  buffer_atomic_add v16, v15, s[40:43], s87 offen
  s_waitcnt lgkmcnt(2)
  v_mfma_f32_32x32x16_bf16 v[64:79], v[56:59], v[204:207], v[64:79]
  ds_read_b64_tr_b16 v[48:49], v6 offset:49152
  ds_read_b64_tr_b16 v[50:51], v6 offset:49664
  s_waitcnt lgkmcnt(2)
  v_mfma_f32_32x32x16_bf16 v[80:95], v[60:63], v[204:207], v[80:95]
  s_cmp_eq_u32 s6, 3
  s_cbranch_scc1 L_k1O_c84
L_k1O_c84_r:
  ds_read_b64_tr_b16 v[52:53], v6 offset:57344
  ds_read_b64_tr_b16 v[54:55], v6 offset:57856
  s_mov_b32 s68, s16
  s_mov_b32 s69, s17
  s_mov_b32 s70, 0x1c0000
  s_mov_b32 s71, 0x20000
  s_mov_b32 s72, s8
  s_mov_b32 s73, s9
  s_mov_b32 s74, 0x80000
  s_mov_b32 s75, 0x20000
  s_mul_i32 s62, s77, 72
  s_mul_i32 s63, s48, 9
  s_add_u32 s62, s62, s63
  v_lshrrev_b32 v12, 6, v1
  v_add_u32 v12, s62, v12
  v_lshlrev_b32 v12, 10, v12
  v_and_b32 v13, 48, v1
  v_lshlrev_b32 v13, 3, v13
  v_add_u32 v12, v12, v13
  s_lshl_b32 s62, s78, 9
  v_add_u32 v12, s62, v12
  v_mov_b32 v13, 0x7ffffff0
  v_cmp_gt_u32 vcc, 576, v1
  s_nop 1
  v_cndmask_b32 v12, v13, v12
  buffer_load_dword v14, v12, s[68:71], 0 offen
  v_subrev_u32 v13, 1835008, v12
  buffer_load_dword v15, v13, s[72:75], 0 offen
  s_getpc_b64 s[80:81]
L_k1_pc2O:
  s_add_u32 s80, s80, L_p2_startO-L_k1_pc2O
  s_addc_u32 s81, s81, 0
  v_add_u32 v16, s54, v1
  global_load_dword v17, v16, s[80:81]
  v_add_u32 v16, 0x2000, v16
  global_load_dword v18, v16, s[80:81]
  s_waitcnt lgkmcnt(2)
  v_mfma_f32_32x32x16_bf16 v[64:79], v[48:51], v[208:211], v[64:79]
  ds_read_b64_tr_b16 v[56:57], v6 offset:51200
  ds_read_b64_tr_b16 v[58:59], v6 offset:51712
  s_waitcnt lgkmcnt(2)
  v_mfma_f32_32x32x16_bf16 v[80:95], v[52:55], v[208:211], v[80:95]
  s_cmp_eq_u32 s6, 0
  s_cbranch_scc1 L_k1O_c85
L_k1O_c85_r:
  ds_read_b64_tr_b16 v[60:61], v6 offset:59392
  ds_read_b64_tr_b16 v[62:63], v6 offset:59904
  s_waitcnt lgkmcnt(2)
  v_mfma_f32_32x32x16_bf16 v[64:79], v[56:59], v[212:215], v[64:79]
  ds_read_b64_tr_b16 v[48:49], v6 offset:53248
  ds_read_b64_tr_b16 v[50:51], v6 offset:53760
  s_waitcnt lgkmcnt(2)
  v_mfma_f32_32x32x16_bf16 v[80:95], v[60:63], v[212:215], v[80:95]
  s_cmp_eq_u32 s6, 1
  s_cbranch_scc1 L_k1O_c86
L_k1O_c86_r:
  ds_read_b64_tr_b16 v[52:53], v6 offset:61440
  ds_read_b64_tr_b16 v[54:55], v6 offset:61952
  s_waitcnt lgkmcnt(2)
  v_mfma_f32_32x32x16_bf16 v[64:79], v[48:51], v[216:219], v[64:79]
  ds_read_b64_tr_b16 v[56:57], v6 offset:55296
  ds_read_b64_tr_b16 v[58:59], v6 offset:55808
  s_waitcnt lgkmcnt(2)
  v_mfma_f32_32x32x16_bf16 v[80:95], v[52:55], v[216:219], v[80:95]
  s_cmp_eq_u32 s6, 2
  s_cbranch_scc1 L_k1O_c87
L_k1O_c87_r:
  ds_read_b64_tr_b16 v[60:61], v6 offset:63488
  ds_read_b64_tr_b16 v[62:63], v6 offset:64000
  s_barrier
  s_waitcnt lgkmcnt(2)
  v_mfma_f32_32x32x16_bf16 v[64:79], v[56:59], v[220:223], v[64:79]
  ds_read_b64_tr_b16 v[48:49], v7 offset:0
  ds_read_b64_tr_b16 v[50:51], v7 offset:512
  s_waitcnt lgkmcnt(2)
  v_mfma_f32_32x32x16_bf16 v[80:95], v[60:63], v[220:223], v[80:95]
  s_cmp_eq_u32 s6, 3
  s_cbranch_scc1 L_k1O_c88
L_k1O_c88_r:
  ds_read_b64_tr_b16 v[52:53], v7 offset:8192
  ds_read_b64_tr_b16 v[54:55], v7 offset:8704
  s_waitcnt lgkmcnt(2)
  v_mfma_f32_32x32x16_bf16 v[64:79], v[48:51], v[224:227], v[64:79]
  ds_read_b64_tr_b16 v[56:57], v7 offset:2048
  ds_read_b64_tr_b16 v[58:59], v7 offset:2560
  s_waitcnt lgkmcnt(2)
  v_mfma_f32_32x32x16_bf16 v[80:95], v[52:55], v[224:227], v[80:95]
  s_cmp_eq_u32 s6, 0
  s_cbranch_scc1 L_k1O_c89
L_k1O_c89_r:
  ds_read_b64_tr_b16 v[60:61], v7 offset:10240
  ds_read_b64_tr_b16 v[62:63], v7 offset:10752
  s_waitcnt lgkmcnt(2)
  v_mfma_f32_32x32x16_bf16 v[64:79], v[56:59], v[228:231], v[64:79]
  ds_read_b64_tr_b16 v[48:49], v7 offset:4096
  ds_read_b64_tr_b16 v[50:51], v7 offset:4608
  s_waitcnt lgkmcnt(2)
  v_mfma_f32_32x32x16_bf16 v[80:95], v[60:63], v[228:231], v[80:95]
  s_cmp_eq_u32 s6, 1
  s_cbranch_scc1 L_k1O_c90
L_k1O_c90_r:
  ds_read_b64_tr_b16 v[52:53], v7 offset:12288
  ds_read_b64_tr_b16 v[54:55], v7 offset:12800
  s_waitcnt lgkmcnt(2)
  v_mfma_f32_32x32x16_bf16 v[64:79], v[48:51], v[232:235], v[64:79]
  ds_read_b64_tr_b16 v[56:57], v7 offset:6144
  ds_read_b64_tr_b16 v[58:59], v7 offset:6656
  s_waitcnt lgkmcnt(2)
  v_mfma_f32_32x32x16_bf16 v[80:95], v[52:55], v[232:235], v[80:95]
  s_cmp_eq_u32 s6, 2
  s_cbranch_scc1 L_k1O_c91
L_k1O_c91_r:
  ds_read_b64_tr_b16 v[60:61], v7 offset:14336
  ds_read_b64_tr_b16 v[62:63], v7 offset:14848
  s_waitcnt vmcnt(5)
  s_barrier
  buffer_load_dword v0, off, s[40:43], s87 sc1
  s_waitcnt lgkmcnt(2)
  v_mfma_f32_32x32x16_bf16 v[64:79], v[56:59], v[236:239], v[64:79]
  ds_read_b64_tr_b16 v[48:49], v7 offset:16384
  ds_read_b64_tr_b16 v[50:51], v7 offset:16896
  s_waitcnt lgkmcnt(2)
  v_mfma_f32_32x32x16_bf16 v[80:95], v[60:63], v[236:239], v[80:95]
  s_cmp_eq_u32 s6, 3
  s_cbranch_scc1 L_k1O_c92
L_k1O_c92_r:
  ds_read_b64_tr_b16 v[52:53], v7 offset:24576
  ds_read_b64_tr_b16 v[54:55], v7 offset:25088
  s_waitcnt lgkmcnt(2)
  v_mfma_f32_32x32x16_bf16 v[64:79], v[48:51], v[240:243], v[64:79]
  ds_read_b64_tr_b16 v[56:57], v7 offset:18432
  ds_read_b64_tr_b16 v[58:59], v7 offset:18944
  s_waitcnt lgkmcnt(2)
  v_mfma_f32_32x32x16_bf16 v[80:95], v[52:55], v[240:243], v[80:95]
  s_cmp_eq_u32 s6, 0
  s_cbranch_scc1 L_k1O_c93
L_k1O_c93_r:
  ds_read_b64_tr_b16 v[60:61], v7 offset:26624
  ds_read_b64_tr_b16 v[62:63], v7 offset:27136
  s_waitcnt lgkmcnt(2)
  v_mfma_f32_32x32x16_bf16 v[64:79], v[56:59], v[244:247], v[64:79]
  ds_read_b64_tr_b16 v[48:49], v7 offset:20480
  ds_read_b64_tr_b16 v[50:51], v7 offset:20992
  s_waitcnt lgkmcnt(2)
  v_mfma_f32_32x32x16_bf16 v[80:95], v[60:63], v[244:247], v[80:95]
  s_cmp_eq_u32 s6, 1
  s_cbranch_scc1 L_k1O_c94
L_k1O_c94_r:
  ds_read_b64_tr_b16 v[52:53], v7 offset:28672
  ds_read_b64_tr_b16 v[54:55], v7 offset:29184
  s_waitcnt lgkmcnt(2)
  v_mfma_f32_32x32x16_bf16 v[64:79], v[48:51], v[248:251], v[64:79]
  ds_read_b64_tr_b16 v[56:57], v7 offset:22528
  ds_read_b64_tr_b16 v[58:59], v7 offset:23040
  s_waitcnt lgkmcnt(2)
  v_mfma_f32_32x32x16_bf16 v[80:95], v[52:55], v[248:251], v[80:95]
  s_cmp_eq_u32 s6, 2
  s_cbranch_scc1 L_k1O_c95
L_k1O_c95_r:
  ds_read_b64_tr_b16 v[60:61], v7 offset:30720
  ds_read_b64_tr_b16 v[62:63], v7 offset:31232
  s_waitcnt lgkmcnt(2)
  v_mfma_f32_32x32x16_bf16 v[64:79], v[56:59], v[252:255], v[64:79]
  s_waitcnt lgkmcnt(0)
  v_mfma_f32_32x32x16_bf16 v[80:95], v[60:63], v[252:255], v[80:95]
  s_cmp_eq_u32 s6, 3
  s_cbranch_scc1 L_k1O_c96
L_k1O_c96_r:
  v_mov_b32 v29, 0x23c00
  v_add_u32 v28, s5, v1
  v_cmp_gt_u32 vcc, 256, v1
  s_nop 1
  v_cndmask_b32 v28, v29, v28
  s_nop 1
  ds_write_b32 v28, v36 offset:0
  ds_write_b32 v28, v37 offset:256
  ds_write_b32 v28, v40 offset:512
  ds_write_b32 v28, v41 offset:768
  s_waitcnt lgkmcnt(0)
  s_barrier
L_p2_startO:
  s_memtime s[44:45]
  s_load_dwordx2 s[28:29], s[0:1], 56
  v_lshrrev_b32 v176, 4, v1
  s_lshr_b32 s60, s83, 3
  s_lshl_b32 s60, s60, 2
  s_and_b32 s61, s83, 3
  s_add_u32 s33, s60, s61
  s_lshr_b32 s60, s83, 2
  s_and_b32 s60, s60, 1
  s_lshl_b32 s61, s51, 1
  s_add_u32 s32, s61, s60
  s_lshl_b32 s39, s51, 8
  s_add_u32 s39, s39, 0x972800
  s_cmp_ge_u32 s48, 4
  s_cbranch_scc1 L_p2_loaderO
  s_and_b32 s60, s48, 1
  s_lshr_b32 s61, s48, 1
  v_lshlrev_b32 v177, 4, v176
  s_lshl_b32 s62, s60, 12
  v_add_u32 v177, s62, v177
  v_add_u32 v178, 0x10000, v177
  v_add_u32 v179, 0x20000, v177
  v_lshrrev_b32 v192, 5, v176
  v_lshlrev_b32 v192, 2, v192
  v_bfe_u32 v193, v176, 2, 2
  v_add_u32 v192, v192, v193
  v_bfe_u32 v194, v176, 4, 1
  v_bfe_u32 v195, v176, 1, 1
  v_and_b32 v196, 1, v176
  v_lshlrev_b32 v196, 3, v196
  v_lshl_add_u32 v197, v194, 1, v195
  s_lshl_b32 s62, s61, 2
  v_add_u32 v197, s62, v197
  v_bfe_u32 v198, v176, 3, 1
  v_lshlrev_b32 v198, 2, v198
  v_xor_b32 v197, v197, v198
  v_lshlrev_b32 v197, 4, v197
  v_lshl_add_u32 v180, v192, 7, v197
  v_add_u32 v180, v180, v196
  v_add_u32 v180, 0x2000, v180
  v_add_u32 v181, 0x10000, v180
  v_add_u32 v182, 0x20000, v180
  s_lshl_b32 s62, s32, 6
  s_lshl_b32 s63, s60, 5
  s_add_u32 s62, s62, s63
  v_and_b32 v192, 31, v176
  v_add_u32 v192, s62, v192
  v_lshlrev_b32 v183, 10, v192
  s_lshl_b32 s62, s33, 7
  s_lshl_b32 s63, s61, 6
  s_add_u32 s62, s62, s63
  v_lshrrev_b32 v192, 5, v176
  v_lshlrev_b32 v192, 3, v192
  v_add_u32 v192, s62, v192
  v_add_u32 v183, v183, v192
  buffer_load_dwordx2 v[184:185], v183, s[24:27], 0 offen offset:0
  buffer_load_dwordx2 v[186:187], v183, s[24:27], 0 offen offset:16
  buffer_load_dwordx2 v[188:189], v183, s[24:27], 0 offen offset:32
  buffer_load_dwordx2 v[190:191], v183, s[24:27], 0 offen offset:48
  s_waitcnt lgkmcnt(0)
  s_mov_b32 s30, 0x200000
  s_mov_b32 s31, 0x20000
  v_and_b32 v28, 0x1f0, v1
  v_add_u32 v28, s4, v28
  ds_read_b128 v[20:23], v28 offset:0
  ds_read_b128 v[24:27], v28 offset:512
  s_waitcnt lgkmcnt(1)
  v_add_f32 v20, v20, v21
  v_add_f32 v22, v22, v23
  v_add_f32 v20, v20, v22
  v_cvt_pk_bf16_f32 v21, v20, v20
  v_lshlrev_b32 v21, 16, v21
  v_sub_f32 v21, v20, v21
  v_cvt_pk_bf16_f32 v46, v20, v21
  s_nop 1
  v_mfma_f32_32x32x8_bf16 v[64:79], v[46:47], v[44:45], v[64:79]
  s_waitcnt lgkmcnt(0)
  v_add_f32 v24, v24, v25
  v_add_f32 v26, v26, v27
  v_add_f32 v24, v24, v26
  v_cvt_pk_bf16_f32 v25, v24, v24
  v_lshlrev_b32 v25, 16, v25
  v_sub_f32 v25, v24, v25
  v_cvt_pk_bf16_f32 v46, v24, v25
  s_nop 1
  v_mfma_f32_32x32x8_bf16 v[80:95], v[46:47], v[44:45], v[80:95]
  s_nop 0
  v_mul_f32 v28, v64, v64
  v_mul_f32 v29, v65, v65
  v_mul_f32 v30, v66, v66
  v_mul_f32 v31, v67, v67
  v_fma_f32 v28, v28, v2, v3
  s_barrier
  ds_read_b128 v[192:195], v177 offset:0
  ds_read_b64_tr_b16 v[196:197], v180 offset:0
  ds_read_b64_tr_b16 v[198:199], v180 offset:1024
  ds_read_b128 v[200:203], v177 offset:1024
  ds_read_b64_tr_b16 v[204:205], v180 offset:2048
  ds_read_b64_tr_b16 v[206:207], v180 offset:3072
  ds_read_b128 v[208:211], v177 offset:2048
  ds_read_b64_tr_b16 v[212:213], v180 offset:4096
  ds_read_b64_tr_b16 v[214:215], v180 offset:5120
  s_waitcnt lgkmcnt(6)
  v_mfma_f32_32x32x16_bf16 v[224:239], v[196:199], v[192:195], 0
  v_fma_f32 v29, v29, v2, v3
  v_fma_f32 v30, v30, v2, v3
  v_fma_f32 v31, v31, v2, v3
  ds_read_b128 v[216:219], v177 offset:3072
  ds_read_b64_tr_b16 v[220:221], v180 offset:6144
  ds_read_b64_tr_b16 v[222:223], v180 offset:7168
  s_waitcnt lgkmcnt(6)
  v_mfma_f32_32x32x16_bf16 v[224:239], v[204:207], v[200:203], v[224:239]
  v_mul_f32 v28, v64, v28
  v_mul_f32 v29, v65, v29
  v_mul_f32 v30, v66, v30
  s_barrier
  ds_read_b128 v[192:195], v177 offset:16384
  ds_read_b64_tr_b16 v[196:197], v180 offset:16384
  ds_read_b64_tr_b16 v[198:199], v180 offset:17408
  s_waitcnt lgkmcnt(6)
  v_mfma_f32_32x32x16_bf16 v[224:239], v[212:215], v[208:211], v[224:239]
  v_mul_f32 v31, v67, v31
  v_exp_f32 v28, v28
  v_exp_f32 v29, v29
  ds_read_b128 v[200:203], v177 offset:17408
  ds_read_b64_tr_b16 v[204:205], v180 offset:18432
  ds_read_b64_tr_b16 v[206:207], v180 offset:19456
  s_waitcnt lgkmcnt(6)
  v_mfma_f32_32x32x16_bf16 v[224:239], v[220:223], v[216:219], v[224:239]
  v_exp_f32 v30, v30
  v_exp_f32 v31, v31
  v_mul_f32 v80, v64, v80
  ds_read_b128 v[208:211], v177 offset:18432
  ds_read_b64_tr_b16 v[212:213], v180 offset:20480
  ds_read_b64_tr_b16 v[214:215], v180 offset:21504
  s_waitcnt lgkmcnt(6)
  v_mfma_f32_32x32x16_bf16 v[224:239], v[196:199], v[192:195], v[224:239]
  v_mul_f32 v81, v65, v81
  v_mul_f32 v82, v66, v82
  v_mul_f32 v83, v67, v83
  ds_read_b128 v[216:219], v177 offset:19456
  ds_read_b64_tr_b16 v[220:221], v180 offset:22528
  ds_read_b64_tr_b16 v[222:223], v180 offset:23552
  s_waitcnt lgkmcnt(6)
  v_mfma_f32_32x32x16_bf16 v[224:239], v[204:207], v[200:203], v[224:239]
  v_fma_f32 v28, v28, v4, v4
  v_fma_f32 v29, v29, v4, v4
  v_fma_f32 v30, v30, v4, v4
  s_barrier
  ds_read_b128 v[192:195], v177 offset:32768
  ds_read_b64_tr_b16 v[196:197], v180 offset:32768
  ds_read_b64_tr_b16 v[198:199], v180 offset:33792
  s_waitcnt lgkmcnt(6)
  v_mfma_f32_32x32x16_bf16 v[224:239], v[212:215], v[208:211], v[224:239]
  v_fma_f32 v31, v31, v4, v4
  v_rcp_f32 v28, v28
  v_rcp_f32 v29, v29
  ds_read_b128 v[200:203], v177 offset:33792
  ds_read_b64_tr_b16 v[204:205], v180 offset:34816
  ds_read_b64_tr_b16 v[206:207], v180 offset:35840
  s_waitcnt lgkmcnt(6)
  v_mfma_f32_32x32x16_bf16 v[224:239], v[220:223], v[216:219], v[224:239]
  v_rcp_f32 v30, v30
  v_rcp_f32 v31, v31
  v_mul_f32 v80, v80, v28
  ds_read_b128 v[208:211], v177 offset:34816
  ds_read_b64_tr_b16 v[212:213], v180 offset:36864
  ds_read_b64_tr_b16 v[214:215], v180 offset:37888
  s_waitcnt lgkmcnt(6)
  v_mfma_f32_32x32x16_bf16 v[224:239], v[196:199], v[192:195], v[224:239]
  v_mul_f32 v81, v81, v29
  v_mul_f32 v82, v82, v30
  v_mul_f32 v83, v83, v31
  ds_read_b128 v[216:219], v177 offset:35840
  ds_read_b64_tr_b16 v[220:221], v180 offset:38912
  ds_read_b64_tr_b16 v[222:223], v180 offset:39936
  s_waitcnt lgkmcnt(6)
  v_mfma_f32_32x32x16_bf16 v[224:239], v[204:207], v[200:203], v[224:239]
  v_cvt_pk_bf16_f32 v20, v80, v81
  v_cvt_pk_bf16_f32 v21, v82, v83
  v_mul_f32 v28, v68, v68
  s_barrier
  ds_read_b128 v[192:195], v177 offset:49152
  ds_read_b64_tr_b16 v[196:197], v180 offset:49152
  ds_read_b64_tr_b16 v[198:199], v180 offset:50176
  s_waitcnt lgkmcnt(6)
  v_mfma_f32_32x32x16_bf16 v[224:239], v[212:215], v[208:211], v[224:239]
  v_mul_f32 v29, v69, v69
  v_mul_f32 v30, v70, v70
  v_mul_f32 v31, v71, v71
  ds_read_b128 v[200:203], v177 offset:50176
  ds_read_b64_tr_b16 v[204:205], v180 offset:51200
  ds_read_b64_tr_b16 v[206:207], v180 offset:52224
  s_waitcnt lgkmcnt(6)
  v_mfma_f32_32x32x16_bf16 v[224:239], v[220:223], v[216:219], v[224:239]
  v_fma_f32 v28, v28, v2, v3
  v_fma_f32 v29, v29, v2, v3
  v_fma_f32 v30, v30, v2, v3
  ds_read_b128 v[208:211], v177 offset:51200
  ds_read_b64_tr_b16 v[212:213], v180 offset:53248
  ds_read_b64_tr_b16 v[214:215], v180 offset:54272
  s_waitcnt lgkmcnt(6)
  v_mfma_f32_32x32x16_bf16 v[224:239], v[196:199], v[192:195], v[224:239]
  v_fma_f32 v31, v31, v2, v3
  v_mul_f32 v28, v68, v28
  v_mul_f32 v29, v69, v29
  ds_read_b128 v[216:219], v177 offset:52224
  ds_read_b64_tr_b16 v[220:221], v180 offset:55296
  ds_read_b64_tr_b16 v[222:223], v180 offset:56320
  s_waitcnt lgkmcnt(6)
  v_mfma_f32_32x32x16_bf16 v[224:239], v[204:207], v[200:203], v[224:239]
  v_mul_f32 v30, v70, v30
  v_mul_f32 v31, v71, v31
  v_exp_f32 v28, v28
  s_barrier
  ds_read_b128 v[192:195], v178 offset:0
  ds_read_b64_tr_b16 v[196:197], v181 offset:0
  ds_read_b64_tr_b16 v[198:199], v181 offset:1024
  s_waitcnt lgkmcnt(6)
  v_mfma_f32_32x32x16_bf16 v[224:239], v[212:215], v[208:211], v[224:239]
  v_exp_f32 v29, v29
  v_exp_f32 v30, v30
  v_exp_f32 v31, v31
  ds_read_b128 v[200:203], v178 offset:1024
  ds_read_b64_tr_b16 v[204:205], v181 offset:2048
  ds_read_b64_tr_b16 v[206:207], v181 offset:3072
  s_waitcnt lgkmcnt(6)
  v_mfma_f32_32x32x16_bf16 v[224:239], v[220:223], v[216:219], v[224:239]
  v_mul_f32 v84, v68, v84
  v_mul_f32 v85, v69, v85
  v_mul_f32 v86, v70, v86
  ds_read_b128 v[208:211], v178 offset:2048
  ds_read_b64_tr_b16 v[212:213], v181 offset:4096
  ds_read_b64_tr_b16 v[214:215], v181 offset:5120
  s_waitcnt lgkmcnt(6)
  v_mfma_f32_32x32x16_bf16 v[224:239], v[196:199], v[192:195], v[224:239]
  v_mul_f32 v87, v71, v87
  v_fma_f32 v28, v28, v4, v4
  v_fma_f32 v29, v29, v4, v4
  ds_read_b128 v[216:219], v178 offset:3072
  ds_read_b64_tr_b16 v[220:221], v181 offset:6144
  ds_read_b64_tr_b16 v[222:223], v181 offset:7168
  s_waitcnt lgkmcnt(6)
  v_mfma_f32_32x32x16_bf16 v[224:239], v[204:207], v[200:203], v[224:239]
  v_fma_f32 v30, v30, v4, v4
  v_fma_f32 v31, v31, v4, v4
  v_rcp_f32 v28, v28
  s_barrier
  ds_read_b128 v[192:195], v178 offset:16384
  ds_read_b64_tr_b16 v[196:197], v181 offset:16384
  ds_read_b64_tr_b16 v[198:199], v181 offset:17408
  s_waitcnt lgkmcnt(6)
  v_mfma_f32_32x32x16_bf16 v[224:239], v[212:215], v[208:211], v[224:239]
  v_rcp_f32 v29, v29
  v_rcp_f32 v30, v30
  v_rcp_f32 v31, v31
  ds_read_b128 v[200:203], v178 offset:17408
  ds_read_b64_tr_b16 v[204:205], v181 offset:18432
  ds_read_b64_tr_b16 v[206:207], v181 offset:19456
  s_waitcnt lgkmcnt(6)
  v_mfma_f32_32x32x16_bf16 v[224:239], v[220:223], v[216:219], v[224:239]
  v_mul_f32 v84, v84, v28
  v_mul_f32 v85, v85, v29
  v_mul_f32 v86, v86, v30
  ds_read_b128 v[208:211], v178 offset:18432
  ds_read_b64_tr_b16 v[212:213], v181 offset:20480
  ds_read_b64_tr_b16 v[214:215], v181 offset:21504
  s_waitcnt lgkmcnt(6)
  v_mfma_f32_32x32x16_bf16 v[224:239], v[196:199], v[192:195], v[224:239]
  v_mul_f32 v87, v87, v31
  v_cvt_pk_bf16_f32 v22, v84, v85
  v_cvt_pk_bf16_f32 v23, v86, v87
  ds_read_b128 v[216:219], v178 offset:19456
  ds_read_b64_tr_b16 v[220:221], v181 offset:22528
  ds_read_b64_tr_b16 v[222:223], v181 offset:23552
  s_waitcnt lgkmcnt(6)
  v_mfma_f32_32x32x16_bf16 v[224:239], v[204:207], v[200:203], v[224:239]
  s_add_u32 s61, s66, 0
  buffer_store_dwordx4 v[20:23], v1, s[40:43], s61 offen sc1
  v_mul_f32 v28, v72, v72
  v_mul_f32 v29, v73, v73
  v_mul_f32 v30, v74, v74
  v_mul_f32 v31, v75, v75
  v_fma_f32 v28, v28, v2, v3
  v_fma_f32 v29, v29, v2, v3
  v_fma_f32 v30, v30, v2, v3
  v_fma_f32 v31, v31, v2, v3
  v_mul_f32 v28, v72, v28
  v_mul_f32 v29, v73, v29
  v_mul_f32 v30, v74, v30
  v_mul_f32 v31, v75, v31
  v_exp_f32 v28, v28
  v_exp_f32 v29, v29
  v_exp_f32 v30, v30
  v_exp_f32 v31, v31
  v_mul_f32 v88, v72, v88
  v_mul_f32 v89, v73, v89
  v_mul_f32 v90, v74, v90
  v_mul_f32 v91, v75, v91
  v_fma_f32 v28, v28, v4, v4
  v_fma_f32 v29, v29, v4, v4
  v_fma_f32 v30, v30, v4, v4
  v_fma_f32 v31, v31, v4, v4
  v_rcp_f32 v28, v28
  v_rcp_f32 v29, v29
  v_rcp_f32 v30, v30
  v_rcp_f32 v31, v31
  v_mul_f32 v88, v88, v28
  v_mul_f32 v89, v89, v29
  v_mul_f32 v90, v90, v30
  v_mul_f32 v91, v91, v31
  v_cvt_pk_bf16_f32 v24, v88, v89
  v_cvt_pk_bf16_f32 v25, v90, v91
  v_mul_f32 v28, v76, v76
  v_mul_f32 v29, v77, v77
  v_mul_f32 v30, v78, v78
  v_mul_f32 v31, v79, v79
  v_fma_f32 v28, v28, v2, v3
  v_fma_f32 v29, v29, v2, v3
  v_fma_f32 v30, v30, v2, v3
  v_fma_f32 v31, v31, v2, v3
  v_mul_f32 v28, v76, v28
  v_mul_f32 v29, v77, v29
  v_mul_f32 v30, v78, v30
  v_mul_f32 v31, v79, v31
  v_exp_f32 v28, v28
  v_exp_f32 v29, v29
  v_exp_f32 v30, v30
  v_exp_f32 v31, v31
  v_mul_f32 v92, v76, v92
  v_mul_f32 v93, v77, v93
  v_mul_f32 v94, v78, v94
  v_mul_f32 v95, v79, v95
  v_fma_f32 v28, v28, v4, v4
  v_fma_f32 v29, v29, v4, v4
  v_fma_f32 v30, v30, v4, v4
  v_fma_f32 v31, v31, v4, v4
  v_rcp_f32 v28, v28
  v_rcp_f32 v29, v29
  v_rcp_f32 v30, v30
  v_rcp_f32 v31, v31
  v_mul_f32 v92, v92, v28
  v_mul_f32 v93, v93, v29
  v_mul_f32 v94, v94, v30
  v_mul_f32 v95, v95, v31
  v_cvt_pk_bf16_f32 v26, v92, v93
  v_cvt_pk_bf16_f32 v27, v94, v95
  s_add_u32 s61, s66, 1024
  buffer_store_dwordx4 v[24:27], v1, s[40:43], s61 offen sc1
  s_barrier
  ds_read_b128 v[192:195], v178 offset:32768
  ds_read_b64_tr_b16 v[196:197], v181 offset:32768
  ds_read_b64_tr_b16 v[198:199], v181 offset:33792
  s_waitcnt lgkmcnt(6)
  v_mfma_f32_32x32x16_bf16 v[224:239], v[212:215], v[208:211], v[224:239]
  ds_read_b128 v[200:203], v178 offset:33792
  ds_read_b64_tr_b16 v[204:205], v181 offset:34816
  ds_read_b64_tr_b16 v[206:207], v181 offset:35840
  s_waitcnt lgkmcnt(6)
  v_mfma_f32_32x32x16_bf16 v[224:239], v[220:223], v[216:219], v[224:239]
  ds_read_b128 v[208:211], v178 offset:34816
  ds_read_b64_tr_b16 v[212:213], v181 offset:36864
  ds_read_b64_tr_b16 v[214:215], v181 offset:37888
  s_waitcnt lgkmcnt(6)
  v_mfma_f32_32x32x16_bf16 v[224:239], v[196:199], v[192:195], v[224:239]
  ds_read_b128 v[216:219], v178 offset:35840
  ds_read_b64_tr_b16 v[220:221], v181 offset:38912
  ds_read_b64_tr_b16 v[222:223], v181 offset:39936
  s_waitcnt lgkmcnt(6)
  v_mfma_f32_32x32x16_bf16 v[224:239], v[204:207], v[200:203], v[224:239]
  s_barrier
  ds_read_b128 v[192:195], v178 offset:49152
  ds_read_b64_tr_b16 v[196:197], v181 offset:49152
  ds_read_b64_tr_b16 v[198:199], v181 offset:50176
  s_waitcnt lgkmcnt(6)
  v_mfma_f32_32x32x16_bf16 v[224:239], v[212:215], v[208:211], v[224:239]
  ds_read_b128 v[200:203], v178 offset:50176
  ds_read_b64_tr_b16 v[204:205], v181 offset:51200
  ds_read_b64_tr_b16 v[206:207], v181 offset:52224
  s_waitcnt lgkmcnt(6)
  v_mfma_f32_32x32x16_bf16 v[224:239], v[220:223], v[216:219], v[224:239]
  ds_read_b128 v[208:211], v178 offset:51200
  ds_read_b64_tr_b16 v[212:213], v181 offset:53248
  ds_read_b64_tr_b16 v[214:215], v181 offset:54272
  s_waitcnt lgkmcnt(6)
  v_mfma_f32_32x32x16_bf16 v[224:239], v[196:199], v[192:195], v[224:239]
  ds_read_b128 v[216:219], v178 offset:52224
  ds_read_b64_tr_b16 v[220:221], v181 offset:55296
  ds_read_b64_tr_b16 v[222:223], v181 offset:56320
  s_waitcnt lgkmcnt(6)
  v_mfma_f32_32x32x16_bf16 v[224:239], v[204:207], v[200:203], v[224:239]
  s_waitcnt vmcnt(0)
  s_barrier
  s_memtime s[46:47]
  v_add_u32 v15, s54, v1
  v_mov_b32 v16, 0x7ffffff0
  v_cmp_ne_u32 vcc, 0, v15
  s_nop 1
  v_cndmask_b32 v15, v15, v16
  v_mov_b32 v16, 1
  buffer_atomic_add v16, v15, s[40:43], s86 offen
  ds_read_b128 v[192:195], v179 offset:0
  ds_read_b64_tr_b16 v[196:197], v182 offset:0
  ds_read_b64_tr_b16 v[198:199], v182 offset:1024
  s_waitcnt lgkmcnt(6)
  v_mfma_f32_32x32x16_bf16 v[224:239], v[212:215], v[208:211], v[224:239]
  ds_read_b128 v[200:203], v179 offset:1024
  ds_read_b64_tr_b16 v[204:205], v182 offset:2048
  ds_read_b64_tr_b16 v[206:207], v182 offset:3072
  s_waitcnt lgkmcnt(6)
  v_mfma_f32_32x32x16_bf16 v[224:239], v[220:223], v[216:219], v[224:239]
  ds_read_b128 v[208:211], v179 offset:2048
  ds_read_b64_tr_b16 v[212:213], v182 offset:4096
  ds_read_b64_tr_b16 v[214:215], v182 offset:5120
  s_waitcnt lgkmcnt(6)
  v_mfma_f32_32x32x16_bf16 v[224:239], v[196:199], v[192:195], v[224:239]
  ds_read_b128 v[216:219], v179 offset:3072
  ds_read_b64_tr_b16 v[220:221], v182 offset:6144
  ds_read_b64_tr_b16 v[222:223], v182 offset:7168
  s_waitcnt lgkmcnt(6)
  v_mfma_f32_32x32x16_bf16 v[224:239], v[204:207], v[200:203], v[224:239]
  s_barrier
  ds_read_b128 v[192:195], v179 offset:16384
  ds_read_b64_tr_b16 v[196:197], v182 offset:16384
  ds_read_b64_tr_b16 v[198:199], v182 offset:17408
  s_waitcnt lgkmcnt(6)
  v_mfma_f32_32x32x16_bf16 v[224:239], v[212:215], v[208:211], v[224:239]
  ds_read_b128 v[200:203], v179 offset:17408
  ds_read_b64_tr_b16 v[204:205], v182 offset:18432
  ds_read_b64_tr_b16 v[206:207], v182 offset:19456
  s_waitcnt lgkmcnt(6)
  v_mfma_f32_32x32x16_bf16 v[224:239], v[220:223], v[216:219], v[224:239]
  ds_read_b128 v[208:211], v179 offset:18432
  ds_read_b64_tr_b16 v[212:213], v182 offset:20480
  ds_read_b64_tr_b16 v[214:215], v182 offset:21504
  s_waitcnt lgkmcnt(6)
  v_mfma_f32_32x32x16_bf16 v[224:239], v[196:199], v[192:195], v[224:239]
  ds_read_b128 v[216:219], v179 offset:19456
  ds_read_b64_tr_b16 v[220:221], v182 offset:22528
  ds_read_b64_tr_b16 v[222:223], v182 offset:23552
  s_waitcnt lgkmcnt(6)
  v_mfma_f32_32x32x16_bf16 v[224:239], v[204:207], v[200:203], v[224:239]
  s_barrier
  ds_read_b128 v[192:195], v177 offset:0
  ds_read_b64_tr_b16 v[196:197], v180 offset:0
  ds_read_b64_tr_b16 v[198:199], v180 offset:1024
  s_waitcnt lgkmcnt(6)
  v_mfma_f32_32x32x16_bf16 v[224:239], v[212:215], v[208:211], v[224:239]
  ds_read_b128 v[200:203], v177 offset:1024
  ds_read_b64_tr_b16 v[204:205], v180 offset:2048
  ds_read_b64_tr_b16 v[206:207], v180 offset:3072
  s_waitcnt lgkmcnt(6)
  v_mfma_f32_32x32x16_bf16 v[224:239], v[220:223], v[216:219], v[224:239]
  ds_read_b128 v[208:211], v177 offset:2048
  ds_read_b64_tr_b16 v[212:213], v180 offset:4096
  ds_read_b64_tr_b16 v[214:215], v180 offset:5120
  s_waitcnt lgkmcnt(6)
  v_mfma_f32_32x32x16_bf16 v[224:239], v[196:199], v[192:195], v[224:239]
  ds_read_b128 v[216:219], v177 offset:3072
  ds_read_b64_tr_b16 v[220:221], v180 offset:6144
  ds_read_b64_tr_b16 v[222:223], v180 offset:7168
  s_waitcnt lgkmcnt(6)
  v_mfma_f32_32x32x16_bf16 v[224:239], v[204:207], v[200:203], v[224:239]
  s_barrier
  ds_read_b128 v[192:195], v177 offset:16384
  ds_read_b64_tr_b16 v[196:197], v180 offset:16384
  ds_read_b64_tr_b16 v[198:199], v180 offset:17408
  s_waitcnt lgkmcnt(6)
  v_mfma_f32_32x32x16_bf16 v[224:239], v[212:215], v[208:211], v[224:239]
  ds_read_b128 v[200:203], v177 offset:17408
  ds_read_b64_tr_b16 v[204:205], v180 offset:18432
  ds_read_b64_tr_b16 v[206:207], v180 offset:19456
  s_waitcnt lgkmcnt(6)
  v_mfma_f32_32x32x16_bf16 v[224:239], v[220:223], v[216:219], v[224:239]
  ds_read_b128 v[208:211], v177 offset:18432
  ds_read_b64_tr_b16 v[212:213], v180 offset:20480
  ds_read_b64_tr_b16 v[214:215], v180 offset:21504
  s_waitcnt lgkmcnt(6)
  v_mfma_f32_32x32x16_bf16 v[224:239], v[196:199], v[192:195], v[224:239]
  ds_read_b128 v[216:219], v177 offset:19456
  ds_read_b64_tr_b16 v[220:221], v180 offset:22528
  ds_read_b64_tr_b16 v[222:223], v180 offset:23552
  s_waitcnt lgkmcnt(6)
  v_mfma_f32_32x32x16_bf16 v[224:239], v[204:207], v[200:203], v[224:239]
  s_barrier
  ds_read_b128 v[192:195], v177 offset:32768
  ds_read_b64_tr_b16 v[196:197], v180 offset:32768
  ds_read_b64_tr_b16 v[198:199], v180 offset:33792
  s_waitcnt lgkmcnt(6)
  v_mfma_f32_32x32x16_bf16 v[224:239], v[212:215], v[208:211], v[224:239]
  ds_read_b128 v[200:203], v177 offset:33792
  ds_read_b64_tr_b16 v[204:205], v180 offset:34816
  ds_read_b64_tr_b16 v[206:207], v180 offset:35840
  s_waitcnt lgkmcnt(6)
  v_mfma_f32_32x32x16_bf16 v[224:239], v[220:223], v[216:219], v[224:239]
  ds_read_b128 v[208:211], v177 offset:34816
  ds_read_b64_tr_b16 v[212:213], v180 offset:36864
  ds_read_b64_tr_b16 v[214:215], v180 offset:37888
  s_waitcnt lgkmcnt(6)
  v_mfma_f32_32x32x16_bf16 v[224:239], v[196:199], v[192:195], v[224:239]
  ds_read_b128 v[216:219], v177 offset:35840
  ds_read_b64_tr_b16 v[220:221], v180 offset:38912
  ds_read_b64_tr_b16 v[222:223], v180 offset:39936
  s_waitcnt lgkmcnt(6)
  v_mfma_f32_32x32x16_bf16 v[224:239], v[204:207], v[200:203], v[224:239]
  s_barrier
  ds_read_b128 v[192:195], v177 offset:49152
  ds_read_b64_tr_b16 v[196:197], v180 offset:49152
  ds_read_b64_tr_b16 v[198:199], v180 offset:50176
  s_waitcnt lgkmcnt(6)
  v_mfma_f32_32x32x16_bf16 v[224:239], v[212:215], v[208:211], v[224:239]
  ds_read_b128 v[200:203], v177 offset:50176
  ds_read_b64_tr_b16 v[204:205], v180 offset:51200
  ds_read_b64_tr_b16 v[206:207], v180 offset:52224
  s_waitcnt lgkmcnt(6)
  v_mfma_f32_32x32x16_bf16 v[224:239], v[220:223], v[216:219], v[224:239]
  ds_read_b128 v[208:211], v177 offset:51200
  ds_read_b64_tr_b16 v[212:213], v180 offset:53248
  ds_read_b64_tr_b16 v[214:215], v180 offset:54272
  s_waitcnt lgkmcnt(6)
  v_mfma_f32_32x32x16_bf16 v[224:239], v[196:199], v[192:195], v[224:239]
  ds_read_b128 v[216:219], v177 offset:52224
  ds_read_b64_tr_b16 v[220:221], v180 offset:55296
  ds_read_b64_tr_b16 v[222:223], v180 offset:56320
  s_waitcnt lgkmcnt(6)
  v_mfma_f32_32x32x16_bf16 v[224:239], v[204:207], v[200:203], v[224:239]
  s_barrier
  ds_read_b128 v[192:195], v178 offset:0
  ds_read_b64_tr_b16 v[196:197], v181 offset:0
  ds_read_b64_tr_b16 v[198:199], v181 offset:1024
  s_waitcnt lgkmcnt(6)
  v_mfma_f32_32x32x16_bf16 v[224:239], v[212:215], v[208:211], v[224:239]
  ds_read_b128 v[200:203], v178 offset:1024
  ds_read_b64_tr_b16 v[204:205], v181 offset:2048
  ds_read_b64_tr_b16 v[206:207], v181 offset:3072
  s_waitcnt lgkmcnt(6)
  v_mfma_f32_32x32x16_bf16 v[224:239], v[220:223], v[216:219], v[224:239]
  ds_read_b128 v[208:211], v178 offset:2048
  ds_read_b64_tr_b16 v[212:213], v181 offset:4096
  ds_read_b64_tr_b16 v[214:215], v181 offset:5120
  s_waitcnt lgkmcnt(6)
  v_mfma_f32_32x32x16_bf16 v[224:239], v[196:199], v[192:195], v[224:239]
  ds_read_b128 v[216:219], v178 offset:3072
  ds_read_b64_tr_b16 v[220:221], v181 offset:6144
  ds_read_b64_tr_b16 v[222:223], v181 offset:7168
  s_waitcnt lgkmcnt(6)
  v_mfma_f32_32x32x16_bf16 v[224:239], v[204:207], v[200:203], v[224:239]
  s_barrier
  ds_read_b128 v[192:195], v178 offset:16384
  ds_read_b64_tr_b16 v[196:197], v181 offset:16384
  ds_read_b64_tr_b16 v[198:199], v181 offset:17408
  s_waitcnt lgkmcnt(6)
  v_mfma_f32_32x32x16_bf16 v[224:239], v[212:215], v[208:211], v[224:239]
  ds_read_b128 v[200:203], v178 offset:17408
  ds_read_b64_tr_b16 v[204:205], v181 offset:18432
  ds_read_b64_tr_b16 v[206:207], v181 offset:19456
  s_waitcnt lgkmcnt(6)
  v_mfma_f32_32x32x16_bf16 v[224:239], v[220:223], v[216:219], v[224:239]
  ds_read_b128 v[208:211], v178 offset:18432
  ds_read_b64_tr_b16 v[212:213], v181 offset:20480
  ds_read_b64_tr_b16 v[214:215], v181 offset:21504
  s_waitcnt lgkmcnt(6)
  v_mfma_f32_32x32x16_bf16 v[224:239], v[196:199], v[192:195], v[224:239]
  ds_read_b128 v[216:219], v178 offset:19456
  ds_read_b64_tr_b16 v[220:221], v181 offset:22528
  ds_read_b64_tr_b16 v[222:223], v181 offset:23552
  s_waitcnt lgkmcnt(6)
  v_mfma_f32_32x32x16_bf16 v[224:239], v[204:207], v[200:203], v[224:239]
  s_barrier
  s_memtime s[78:79]
  ds_read_b128 v[192:195], v178 offset:32768
  ds_read_b64_tr_b16 v[196:197], v181 offset:32768
  ds_read_b64_tr_b16 v[198:199], v181 offset:33792
  s_waitcnt lgkmcnt(6)
  v_mfma_f32_32x32x16_bf16 v[224:239], v[212:215], v[208:211], v[224:239]
  ds_read_b128 v[200:203], v178 offset:33792
  ds_read_b64_tr_b16 v[204:205], v181 offset:34816
  ds_read_b64_tr_b16 v[206:207], v181 offset:35840
  s_waitcnt lgkmcnt(6)
  v_mfma_f32_32x32x16_bf16 v[224:239], v[220:223], v[216:219], v[224:239]
  ds_read_b128 v[208:211], v178 offset:34816
  ds_read_b64_tr_b16 v[212:213], v181 offset:36864
  ds_read_b64_tr_b16 v[214:215], v181 offset:37888
  s_waitcnt lgkmcnt(6)
  v_mfma_f32_32x32x16_bf16 v[224:239], v[196:199], v[192:195], v[224:239]
  ds_read_b128 v[216:219], v178 offset:35840
  ds_read_b64_tr_b16 v[220:221], v181 offset:38912
  ds_read_b64_tr_b16 v[222:223], v181 offset:39936
  s_waitcnt lgkmcnt(6)
  v_mfma_f32_32x32x16_bf16 v[224:239], v[204:207], v[200:203], v[224:239]
  s_barrier
  ds_read_b128 v[192:195], v178 offset:49152
  ds_read_b64_tr_b16 v[196:197], v181 offset:49152
  ds_read_b64_tr_b16 v[198:199], v181 offset:50176
  s_waitcnt lgkmcnt(6)
  v_mfma_f32_32x32x16_bf16 v[224:239], v[212:215], v[208:211], v[224:239]
  ds_read_b128 v[200:203], v178 offset:50176
  ds_read_b64_tr_b16 v[204:205], v181 offset:51200
  ds_read_b64_tr_b16 v[206:207], v181 offset:52224
  s_waitcnt lgkmcnt(6)
  v_mfma_f32_32x32x16_bf16 v[224:239], v[220:223], v[216:219], v[224:239]
  ds_read_b128 v[208:211], v178 offset:51200
  ds_read_b64_tr_b16 v[212:213], v181 offset:53248
  ds_read_b64_tr_b16 v[214:215], v181 offset:54272
  s_waitcnt lgkmcnt(6)
  v_mfma_f32_32x32x16_bf16 v[224:239], v[196:199], v[192:195], v[224:239]
  ds_read_b128 v[216:219], v178 offset:52224
  ds_read_b64_tr_b16 v[220:221], v181 offset:55296
  ds_read_b64_tr_b16 v[222:223], v181 offset:56320
  s_waitcnt lgkmcnt(6)
  v_mfma_f32_32x32x16_bf16 v[224:239], v[204:207], v[200:203], v[224:239]
  s_barrier
  ds_read_b128 v[192:195], v179 offset:0
  ds_read_b64_tr_b16 v[196:197], v182 offset:0
  ds_read_b64_tr_b16 v[198:199], v182 offset:1024
  s_waitcnt lgkmcnt(6)
  v_mfma_f32_32x32x16_bf16 v[224:239], v[212:215], v[208:211], v[224:239]
  ds_read_b128 v[200:203], v179 offset:1024
  ds_read_b64_tr_b16 v[204:205], v182 offset:2048
  ds_read_b64_tr_b16 v[206:207], v182 offset:3072
  s_waitcnt lgkmcnt(6)
  v_mfma_f32_32x32x16_bf16 v[224:239], v[220:223], v[216:219], v[224:239]
  ds_read_b128 v[208:211], v179 offset:2048
  ds_read_b64_tr_b16 v[212:213], v182 offset:4096
  ds_read_b64_tr_b16 v[214:215], v182 offset:5120
  s_waitcnt lgkmcnt(6)
  v_mfma_f32_32x32x16_bf16 v[224:239], v[196:199], v[192:195], v[224:239]
  ds_read_b128 v[216:219], v179 offset:3072
  ds_read_b64_tr_b16 v[220:221], v182 offset:6144
  ds_read_b64_tr_b16 v[222:223], v182 offset:7168
  s_waitcnt lgkmcnt(6)
  v_mfma_f32_32x32x16_bf16 v[224:239], v[204:207], v[200:203], v[224:239]
  s_barrier
  ds_read_b128 v[192:195], v179 offset:16384
  ds_read_b64_tr_b16 v[196:197], v182 offset:16384
  ds_read_b64_tr_b16 v[198:199], v182 offset:17408
  s_waitcnt lgkmcnt(6)
  v_mfma_f32_32x32x16_bf16 v[224:239], v[212:215], v[208:211], v[224:239]
  ds_read_b128 v[200:203], v179 offset:17408
  ds_read_b64_tr_b16 v[204:205], v182 offset:18432
  ds_read_b64_tr_b16 v[206:207], v182 offset:19456
  s_waitcnt lgkmcnt(6)
  v_mfma_f32_32x32x16_bf16 v[224:239], v[220:223], v[216:219], v[224:239]
  ds_read_b128 v[208:211], v179 offset:18432
  ds_read_b64_tr_b16 v[212:213], v182 offset:20480
  ds_read_b64_tr_b16 v[214:215], v182 offset:21504
  s_waitcnt lgkmcnt(6)
  v_mfma_f32_32x32x16_bf16 v[224:239], v[196:199], v[192:195], v[224:239]
  ds_read_b128 v[216:219], v179 offset:19456
  ds_read_b64_tr_b16 v[220:221], v182 offset:22528
  ds_read_b64_tr_b16 v[222:223], v182 offset:23552
  s_waitcnt lgkmcnt(6)
  v_mfma_f32_32x32x16_bf16 v[224:239], v[204:207], v[200:203], v[224:239]
  s_barrier
  ds_read_b128 v[192:195], v177 offset:0
  ds_read_b64_tr_b16 v[196:197], v180 offset:0
  ds_read_b64_tr_b16 v[198:199], v180 offset:1024
  s_waitcnt lgkmcnt(6)
  v_mfma_f32_32x32x16_bf16 v[224:239], v[212:215], v[208:211], v[224:239]
  ds_read_b128 v[200:203], v177 offset:1024
  ds_read_b64_tr_b16 v[204:205], v180 offset:2048
  ds_read_b64_tr_b16 v[206:207], v180 offset:3072
  s_waitcnt lgkmcnt(6)
  v_mfma_f32_32x32x16_bf16 v[224:239], v[220:223], v[216:219], v[224:239]
  ds_read_b128 v[208:211], v177 offset:2048
  ds_read_b64_tr_b16 v[212:213], v180 offset:4096
  ds_read_b64_tr_b16 v[214:215], v180 offset:5120
  s_waitcnt lgkmcnt(6)
  v_mfma_f32_32x32x16_bf16 v[224:239], v[196:199], v[192:195], v[224:239]
  ds_read_b128 v[216:219], v177 offset:3072
  ds_read_b64_tr_b16 v[220:221], v180 offset:6144
  ds_read_b64_tr_b16 v[222:223], v180 offset:7168
  s_waitcnt lgkmcnt(6)
  v_mfma_f32_32x32x16_bf16 v[224:239], v[204:207], v[200:203], v[224:239]
  s_barrier
  ds_read_b128 v[192:195], v177 offset:16384
  ds_read_b64_tr_b16 v[196:197], v180 offset:16384
  ds_read_b64_tr_b16 v[198:199], v180 offset:17408
  s_waitcnt lgkmcnt(6)
  v_mfma_f32_32x32x16_bf16 v[224:239], v[212:215], v[208:211], v[224:239]
  ds_read_b128 v[200:203], v177 offset:17408
  ds_read_b64_tr_b16 v[204:205], v180 offset:18432
  ds_read_b64_tr_b16 v[206:207], v180 offset:19456
  s_waitcnt lgkmcnt(6)
  v_mfma_f32_32x32x16_bf16 v[224:239], v[220:223], v[216:219], v[224:239]
  ds_read_b128 v[208:211], v177 offset:18432
  ds_read_b64_tr_b16 v[212:213], v180 offset:20480
  ds_read_b64_tr_b16 v[214:215], v180 offset:21504
  s_waitcnt lgkmcnt(6)
  v_mfma_f32_32x32x16_bf16 v[224:239], v[196:199], v[192:195], v[224:239]
  ds_read_b128 v[216:219], v177 offset:19456
  ds_read_b64_tr_b16 v[220:221], v180 offset:22528
  ds_read_b64_tr_b16 v[222:223], v180 offset:23552
  s_waitcnt lgkmcnt(6)
  v_mfma_f32_32x32x16_bf16 v[224:239], v[204:207], v[200:203], v[224:239]
  s_barrier
  ds_read_b128 v[192:195], v177 offset:32768
  ds_read_b64_tr_b16 v[196:197], v180 offset:32768
  ds_read_b64_tr_b16 v[198:199], v180 offset:33792
  s_waitcnt lgkmcnt(6)
  v_mfma_f32_32x32x16_bf16 v[224:239], v[212:215], v[208:211], v[224:239]
  ds_read_b128 v[200:203], v177 offset:33792
  ds_read_b64_tr_b16 v[204:205], v180 offset:34816
  ds_read_b64_tr_b16 v[206:207], v180 offset:35840
  s_waitcnt lgkmcnt(6)
  v_mfma_f32_32x32x16_bf16 v[224:239], v[220:223], v[216:219], v[224:239]
  ds_read_b128 v[208:211], v177 offset:34816
  ds_read_b64_tr_b16 v[212:213], v180 offset:36864
  ds_read_b64_tr_b16 v[214:215], v180 offset:37888
  s_waitcnt lgkmcnt(6)
  v_mfma_f32_32x32x16_bf16 v[224:239], v[196:199], v[192:195], v[224:239]
  ds_read_b128 v[216:219], v177 offset:35840
  ds_read_b64_tr_b16 v[220:221], v180 offset:38912
  ds_read_b64_tr_b16 v[222:223], v180 offset:39936
  s_waitcnt lgkmcnt(6)
  v_mfma_f32_32x32x16_bf16 v[224:239], v[204:207], v[200:203], v[224:239]
  s_barrier
  ds_read_b128 v[192:195], v177 offset:49152
  ds_read_b64_tr_b16 v[196:197], v180 offset:49152
  ds_read_b64_tr_b16 v[198:199], v180 offset:50176
  s_waitcnt lgkmcnt(6)
  v_mfma_f32_32x32x16_bf16 v[224:239], v[212:215], v[208:211], v[224:239]
  ds_read_b128 v[200:203], v177 offset:50176
  ds_read_b64_tr_b16 v[204:205], v180 offset:51200
  ds_read_b64_tr_b16 v[206:207], v180 offset:52224
  s_waitcnt lgkmcnt(6)
  v_mfma_f32_32x32x16_bf16 v[224:239], v[220:223], v[216:219], v[224:239]
  ds_read_b128 v[208:211], v177 offset:51200
  ds_read_b64_tr_b16 v[212:213], v180 offset:53248
  ds_read_b64_tr_b16 v[214:215], v180 offset:54272
  s_waitcnt lgkmcnt(6)
  v_mfma_f32_32x32x16_bf16 v[224:239], v[196:199], v[192:195], v[224:239]
  ds_read_b128 v[216:219], v177 offset:52224
  ds_read_b64_tr_b16 v[220:221], v180 offset:55296
  ds_read_b64_tr_b16 v[222:223], v180 offset:56320
  s_waitcnt lgkmcnt(6)
  v_mfma_f32_32x32x16_bf16 v[224:239], v[204:207], v[200:203], v[224:239]
  s_barrier
  ds_read_b128 v[192:195], v178 offset:0
  ds_read_b64_tr_b16 v[196:197], v181 offset:0
  ds_read_b64_tr_b16 v[198:199], v181 offset:1024
  s_waitcnt lgkmcnt(6)
  v_mfma_f32_32x32x16_bf16 v[224:239], v[212:215], v[208:211], v[224:239]
  ds_read_b128 v[200:203], v178 offset:1024
  ds_read_b64_tr_b16 v[204:205], v181 offset:2048
  ds_read_b64_tr_b16 v[206:207], v181 offset:3072
  s_waitcnt lgkmcnt(6)
  v_mfma_f32_32x32x16_bf16 v[224:239], v[220:223], v[216:219], v[224:239]
  ds_read_b128 v[208:211], v178 offset:2048
  ds_read_b64_tr_b16 v[212:213], v181 offset:4096
  ds_read_b64_tr_b16 v[214:215], v181 offset:5120
  s_waitcnt lgkmcnt(6)
  v_mfma_f32_32x32x16_bf16 v[224:239], v[196:199], v[192:195], v[224:239]
  ds_read_b128 v[216:219], v178 offset:3072
  ds_read_b64_tr_b16 v[220:221], v181 offset:6144
  ds_read_b64_tr_b16 v[222:223], v181 offset:7168
  s_waitcnt lgkmcnt(6)
  v_mfma_f32_32x32x16_bf16 v[224:239], v[204:207], v[200:203], v[224:239]
  s_barrier
  ds_read_b128 v[192:195], v178 offset:16384
  ds_read_b64_tr_b16 v[196:197], v181 offset:16384
  ds_read_b64_tr_b16 v[198:199], v181 offset:17408
  s_waitcnt lgkmcnt(6)
  v_mfma_f32_32x32x16_bf16 v[224:239], v[212:215], v[208:211], v[224:239]
  ds_read_b128 v[200:203], v178 offset:17408
  ds_read_b64_tr_b16 v[204:205], v181 offset:18432
  ds_read_b64_tr_b16 v[206:207], v181 offset:19456
  s_waitcnt lgkmcnt(6)
  v_mfma_f32_32x32x16_bf16 v[224:239], v[220:223], v[216:219], v[224:239]
  ds_read_b128 v[208:211], v178 offset:18432
  ds_read_b64_tr_b16 v[212:213], v181 offset:20480
  ds_read_b64_tr_b16 v[214:215], v181 offset:21504
  s_waitcnt lgkmcnt(6)
  v_mfma_f32_32x32x16_bf16 v[224:239], v[196:199], v[192:195], v[224:239]
  ds_read_b128 v[216:219], v178 offset:19456
  ds_read_b64_tr_b16 v[220:221], v181 offset:22528
  ds_read_b64_tr_b16 v[222:223], v181 offset:23552
  s_waitcnt lgkmcnt(6)
  v_mfma_f32_32x32x16_bf16 v[224:239], v[204:207], v[200:203], v[224:239]
  s_barrier
  ds_read_b128 v[192:195], v178 offset:32768
  ds_read_b64_tr_b16 v[196:197], v181 offset:32768
  ds_read_b64_tr_b16 v[198:199], v181 offset:33792
  s_waitcnt lgkmcnt(6)
  v_mfma_f32_32x32x16_bf16 v[224:239], v[212:215], v[208:211], v[224:239]
  ds_read_b128 v[200:203], v178 offset:33792
  ds_read_b64_tr_b16 v[204:205], v181 offset:34816
  ds_read_b64_tr_b16 v[206:207], v181 offset:35840
  s_waitcnt lgkmcnt(6)
  v_mfma_f32_32x32x16_bf16 v[224:239], v[220:223], v[216:219], v[224:239]
  ds_read_b128 v[208:211], v178 offset:34816
  ds_read_b64_tr_b16 v[212:213], v181 offset:36864
  ds_read_b64_tr_b16 v[214:215], v181 offset:37888
  s_waitcnt lgkmcnt(6)
  v_mfma_f32_32x32x16_bf16 v[224:239], v[196:199], v[192:195], v[224:239]
  ds_read_b128 v[216:219], v178 offset:35840
  ds_read_b64_tr_b16 v[220:221], v181 offset:38912
  ds_read_b64_tr_b16 v[222:223], v181 offset:39936
  s_waitcnt lgkmcnt(6)
  v_mfma_f32_32x32x16_bf16 v[224:239], v[204:207], v[200:203], v[224:239]
  s_barrier
  ds_read_b128 v[192:195], v178 offset:49152
  ds_read_b64_tr_b16 v[196:197], v181 offset:49152
  ds_read_b64_tr_b16 v[198:199], v181 offset:50176
  s_waitcnt lgkmcnt(6)
  v_mfma_f32_32x32x16_bf16 v[224:239], v[212:215], v[208:211], v[224:239]
  ds_read_b128 v[200:203], v178 offset:50176
  ds_read_b64_tr_b16 v[204:205], v181 offset:51200
  ds_read_b64_tr_b16 v[206:207], v181 offset:52224
  s_waitcnt lgkmcnt(6)
  v_mfma_f32_32x32x16_bf16 v[224:239], v[220:223], v[216:219], v[224:239]
  ds_read_b128 v[208:211], v178 offset:51200
  ds_read_b64_tr_b16 v[212:213], v181 offset:53248
  ds_read_b64_tr_b16 v[214:215], v181 offset:54272
  s_waitcnt lgkmcnt(6)
  v_mfma_f32_32x32x16_bf16 v[224:239], v[196:199], v[192:195], v[224:239]
  ds_read_b128 v[216:219], v178 offset:52224
  ds_read_b64_tr_b16 v[220:221], v181 offset:55296
  ds_read_b64_tr_b16 v[222:223], v181 offset:56320
  s_waitcnt lgkmcnt(6)
  v_mfma_f32_32x32x16_bf16 v[224:239], v[204:207], v[200:203], v[224:239]
  s_barrier
  ds_read_b128 v[192:195], v179 offset:0
  ds_read_b64_tr_b16 v[196:197], v182 offset:0
  ds_read_b64_tr_b16 v[198:199], v182 offset:1024
  s_waitcnt lgkmcnt(6)
  v_mfma_f32_32x32x16_bf16 v[224:239], v[212:215], v[208:211], v[224:239]
  ds_read_b128 v[200:203], v179 offset:1024
  ds_read_b64_tr_b16 v[204:205], v182 offset:2048
  ds_read_b64_tr_b16 v[206:207], v182 offset:3072
  s_waitcnt lgkmcnt(6)
  v_mfma_f32_32x32x16_bf16 v[224:239], v[220:223], v[216:219], v[224:239]
  ds_read_b128 v[208:211], v179 offset:2048
  ds_read_b64_tr_b16 v[212:213], v182 offset:4096
  ds_read_b64_tr_b16 v[214:215], v182 offset:5120
  s_waitcnt lgkmcnt(6)
  v_mfma_f32_32x32x16_bf16 v[240:255], v[196:199], v[192:195], 0
  ds_read_b128 v[216:219], v179 offset:3072
  ds_read_b64_tr_b16 v[220:221], v182 offset:6144
  ds_read_b64_tr_b16 v[222:223], v182 offset:7168
  s_waitcnt lgkmcnt(6)
  v_mfma_f32_32x32x16_bf16 v[240:255], v[204:207], v[200:203], v[240:255]
  s_barrier
  ds_read_b128 v[192:195], v179 offset:16384
  ds_read_b64_tr_b16 v[196:197], v182 offset:16384
  ds_read_b64_tr_b16 v[198:199], v182 offset:17408
  s_waitcnt lgkmcnt(6)
  v_mfma_f32_32x32x16_bf16 v[240:255], v[212:215], v[208:211], v[240:255]
  ds_read_b128 v[200:203], v179 offset:17408
  ds_read_b64_tr_b16 v[204:205], v182 offset:18432
  ds_read_b64_tr_b16 v[206:207], v182 offset:19456
  s_waitcnt lgkmcnt(6)
  v_mfma_f32_32x32x16_bf16 v[240:255], v[220:223], v[216:219], v[240:255]
  ds_read_b128 v[208:211], v179 offset:18432
  ds_read_b64_tr_b16 v[212:213], v182 offset:20480
  ds_read_b64_tr_b16 v[214:215], v182 offset:21504
  s_waitcnt lgkmcnt(6)
  v_mfma_f32_32x32x16_bf16 v[240:255], v[196:199], v[192:195], v[240:255]
  ds_read_b128 v[216:219], v179 offset:19456
  ds_read_b64_tr_b16 v[220:221], v182 offset:22528
  ds_read_b64_tr_b16 v[222:223], v182 offset:23552
  s_waitcnt lgkmcnt(6)
  v_mfma_f32_32x32x16_bf16 v[240:255], v[204:207], v[200:203], v[240:255]
  s_barrier
  ds_read_b128 v[192:195], v177 offset:0
  ds_read_b64_tr_b16 v[196:197], v180 offset:0
  ds_read_b64_tr_b16 v[198:199], v180 offset:1024
  s_waitcnt lgkmcnt(6)
  v_mfma_f32_32x32x16_bf16 v[240:255], v[212:215], v[208:211], v[240:255]
  ds_read_b128 v[200:203], v177 offset:1024
  ds_read_b64_tr_b16 v[204:205], v180 offset:2048
  ds_read_b64_tr_b16 v[206:207], v180 offset:3072
  s_waitcnt lgkmcnt(6)
  v_mfma_f32_32x32x16_bf16 v[240:255], v[220:223], v[216:219], v[240:255]
  ds_read_b128 v[208:211], v177 offset:2048
  ds_read_b64_tr_b16 v[212:213], v180 offset:4096
  ds_read_b64_tr_b16 v[214:215], v180 offset:5120
  s_waitcnt lgkmcnt(6)
  v_mfma_f32_32x32x16_bf16 v[240:255], v[196:199], v[192:195], v[240:255]
  ds_read_b128 v[216:219], v177 offset:3072
  ds_read_b64_tr_b16 v[220:221], v180 offset:6144
  ds_read_b64_tr_b16 v[222:223], v180 offset:7168
  s_waitcnt lgkmcnt(6)
  v_mfma_f32_32x32x16_bf16 v[240:255], v[204:207], v[200:203], v[240:255]
  s_barrier
  ds_read_b128 v[192:195], v177 offset:16384
  ds_read_b64_tr_b16 v[196:197], v180 offset:16384
  ds_read_b64_tr_b16 v[198:199], v180 offset:17408
  s_waitcnt lgkmcnt(6)
  v_mfma_f32_32x32x16_bf16 v[240:255], v[212:215], v[208:211], v[240:255]
  ds_read_b128 v[200:203], v177 offset:17408
  ds_read_b64_tr_b16 v[204:205], v180 offset:18432
  ds_read_b64_tr_b16 v[206:207], v180 offset:19456
  s_waitcnt lgkmcnt(6)
  v_mfma_f32_32x32x16_bf16 v[240:255], v[220:223], v[216:219], v[240:255]
  ds_read_b128 v[208:211], v177 offset:18432
  ds_read_b64_tr_b16 v[212:213], v180 offset:20480
  ds_read_b64_tr_b16 v[214:215], v180 offset:21504
  s_waitcnt lgkmcnt(6)
  v_mfma_f32_32x32x16_bf16 v[240:255], v[196:199], v[192:195], v[240:255]
  ds_read_b128 v[216:219], v177 offset:19456
  ds_read_b64_tr_b16 v[220:221], v180 offset:22528
  ds_read_b64_tr_b16 v[222:223], v180 offset:23552
  s_waitcnt lgkmcnt(6)
  v_mfma_f32_32x32x16_bf16 v[240:255], v[204:207], v[200:203], v[240:255]
  s_barrier
  ds_read_b128 v[192:195], v177 offset:32768
  ds_read_b64_tr_b16 v[196:197], v180 offset:32768
  ds_read_b64_tr_b16 v[198:199], v180 offset:33792
  s_waitcnt lgkmcnt(6)
  v_mfma_f32_32x32x16_bf16 v[240:255], v[212:215], v[208:211], v[240:255]
  ds_read_b128 v[200:203], v177 offset:33792
  ds_read_b64_tr_b16 v[204:205], v180 offset:34816
  ds_read_b64_tr_b16 v[206:207], v180 offset:35840
  s_waitcnt lgkmcnt(6)
  v_mfma_f32_32x32x16_bf16 v[240:255], v[220:223], v[216:219], v[240:255]
  ds_read_b128 v[208:211], v177 offset:34816
  ds_read_b64_tr_b16 v[212:213], v180 offset:36864
  ds_read_b64_tr_b16 v[214:215], v180 offset:37888
  s_waitcnt lgkmcnt(6)
  v_mfma_f32_32x32x16_bf16 v[240:255], v[196:199], v[192:195], v[240:255]
  ds_read_b128 v[216:219], v177 offset:35840
  ds_read_b64_tr_b16 v[220:221], v180 offset:38912
  ds_read_b64_tr_b16 v[222:223], v180 offset:39936
  s_waitcnt lgkmcnt(6)
  v_mfma_f32_32x32x16_bf16 v[240:255], v[204:207], v[200:203], v[240:255]
  s_barrier
  ds_read_b128 v[192:195], v177 offset:49152
  ds_read_b64_tr_b16 v[196:197], v180 offset:49152
  ds_read_b64_tr_b16 v[198:199], v180 offset:50176
  s_waitcnt lgkmcnt(6)
  v_mfma_f32_32x32x16_bf16 v[240:255], v[212:215], v[208:211], v[240:255]
  ds_read_b128 v[200:203], v177 offset:50176
  ds_read_b64_tr_b16 v[204:205], v180 offset:51200
  ds_read_b64_tr_b16 v[206:207], v180 offset:52224
  s_waitcnt lgkmcnt(6)
  v_mfma_f32_32x32x16_bf16 v[240:255], v[220:223], v[216:219], v[240:255]
  ds_read_b128 v[208:211], v177 offset:51200
  ds_read_b64_tr_b16 v[212:213], v180 offset:53248
  ds_read_b64_tr_b16 v[214:215], v180 offset:54272
  s_waitcnt lgkmcnt(6)
  v_mfma_f32_32x32x16_bf16 v[240:255], v[196:199], v[192:195], v[240:255]
  ds_read_b128 v[216:219], v177 offset:52224
  ds_read_b64_tr_b16 v[220:221], v180 offset:55296
  ds_read_b64_tr_b16 v[222:223], v180 offset:56320
  s_waitcnt lgkmcnt(6)
  v_mfma_f32_32x32x16_bf16 v[240:255], v[204:207], v[200:203], v[240:255]
  s_barrier
  ds_read_b128 v[192:195], v178 offset:0
  ds_read_b64_tr_b16 v[196:197], v181 offset:0
  ds_read_b64_tr_b16 v[198:199], v181 offset:1024
  s_waitcnt lgkmcnt(6)
  v_mfma_f32_32x32x16_bf16 v[240:255], v[212:215], v[208:211], v[240:255]
  ds_read_b128 v[200:203], v178 offset:1024
  ds_read_b64_tr_b16 v[204:205], v181 offset:2048
  ds_read_b64_tr_b16 v[206:207], v181 offset:3072
  s_waitcnt lgkmcnt(6)
  v_mfma_f32_32x32x16_bf16 v[240:255], v[220:223], v[216:219], v[240:255]
  ds_read_b128 v[208:211], v178 offset:2048
  ds_read_b64_tr_b16 v[212:213], v181 offset:4096
  ds_read_b64_tr_b16 v[214:215], v181 offset:5120
  s_waitcnt lgkmcnt(6)
  v_mfma_f32_32x32x16_bf16 v[240:255], v[196:199], v[192:195], v[240:255]
  ds_read_b128 v[216:219], v178 offset:3072
  ds_read_b64_tr_b16 v[220:221], v181 offset:6144
  ds_read_b64_tr_b16 v[222:223], v181 offset:7168
  s_waitcnt lgkmcnt(6)
  v_mfma_f32_32x32x16_bf16 v[240:255], v[204:207], v[200:203], v[240:255]
  s_barrier
  ds_read_b128 v[192:195], v178 offset:16384
  ds_read_b64_tr_b16 v[196:197], v181 offset:16384
  ds_read_b64_tr_b16 v[198:199], v181 offset:17408
  s_waitcnt lgkmcnt(6)
  v_mfma_f32_32x32x16_bf16 v[240:255], v[212:215], v[208:211], v[240:255]
  ds_read_b128 v[200:203], v178 offset:17408
  ds_read_b64_tr_b16 v[204:205], v181 offset:18432
  ds_read_b64_tr_b16 v[206:207], v181 offset:19456
  s_waitcnt lgkmcnt(6)
  v_mfma_f32_32x32x16_bf16 v[240:255], v[220:223], v[216:219], v[240:255]
  ds_read_b128 v[208:211], v178 offset:18432
  ds_read_b64_tr_b16 v[212:213], v181 offset:20480
  ds_read_b64_tr_b16 v[214:215], v181 offset:21504
  s_waitcnt lgkmcnt(6)
  v_mfma_f32_32x32x16_bf16 v[240:255], v[196:199], v[192:195], v[240:255]
  ds_read_b128 v[216:219], v178 offset:19456
  ds_read_b64_tr_b16 v[220:221], v181 offset:22528
  ds_read_b64_tr_b16 v[222:223], v181 offset:23552
  s_waitcnt lgkmcnt(6)
  v_mfma_f32_32x32x16_bf16 v[240:255], v[204:207], v[200:203], v[240:255]
  s_waitcnt lgkmcnt(3)
  v_mfma_f32_32x32x16_bf16 v[240:255], v[212:215], v[208:211], v[240:255]
  s_waitcnt lgkmcnt(0)
  v_mfma_f32_32x32x16_bf16 v[240:255], v[220:223], v[216:219], v[240:255]
  v_mul_f32 v12, 0xbfb8aa3b, v224
  v_mul_f32 v13, 0xbfb8aa3b, v225
  v_mul_f32 v14, 0xbfb8aa3b, v226
  v_mul_f32 v15, 0xbfb8aa3b, v227
  v_exp_f32 v12, v12
  v_exp_f32 v13, v13
  v_exp_f32 v14, v14
  v_exp_f32 v15, v15
  s_nop 3
  v_mul_f32 v240, v240, v224
  v_mul_f32 v241, v241, v225
  v_mul_f32 v242, v242, v226
  v_mul_f32 v243, v243, v227
  v_add_f32 v12, 1.0, v12
  v_add_f32 v13, 1.0, v13
  v_add_f32 v14, 1.0, v14
  v_add_f32 v15, 1.0, v15
  v_rcp_f32 v12, v12
  v_rcp_f32 v13, v13
  v_rcp_f32 v14, v14
  v_rcp_f32 v15, v15
  v_lshlrev_b32 v16, 16, v184
  v_and_b32 v17, 0xffff0000, v184
  v_lshlrev_b32 v18, 16, v185
  v_and_b32 v19, 0xffff0000, v185
  v_fma_f32 v16, v240, v12, v16
  v_fma_f32 v17, v241, v13, v17
  v_fma_f32 v18, v242, v14, v18
  v_fma_f32 v19, v243, v15, v19
  v_cvt_pk_bf16_f32 v20, v16, v17
  v_cvt_pk_bf16_f32 v21, v18, v19
  buffer_store_dwordx2 v[20:21], v183, s[28:31], 0 offen offset:0
  v_mul_f32 v12, 0xbfb8aa3b, v228
  v_mul_f32 v13, 0xbfb8aa3b, v229
  v_mul_f32 v14, 0xbfb8aa3b, v230
  v_mul_f32 v15, 0xbfb8aa3b, v231
  v_exp_f32 v12, v12
  v_exp_f32 v13, v13
  v_exp_f32 v14, v14
  v_exp_f32 v15, v15
  v_mul_f32 v244, v244, v228
  v_mul_f32 v245, v245, v229
  v_mul_f32 v246, v246, v230
  v_mul_f32 v247, v247, v231
  v_add_f32 v12, 1.0, v12
  v_add_f32 v13, 1.0, v13
  v_add_f32 v14, 1.0, v14
  v_add_f32 v15, 1.0, v15
  v_rcp_f32 v12, v12
  v_rcp_f32 v13, v13
  v_rcp_f32 v14, v14
  v_rcp_f32 v15, v15
  v_lshlrev_b32 v16, 16, v186
  v_and_b32 v17, 0xffff0000, v186
  v_lshlrev_b32 v18, 16, v187
  v_and_b32 v19, 0xffff0000, v187
  v_fma_f32 v16, v244, v12, v16
  v_fma_f32 v17, v245, v13, v17
  v_fma_f32 v18, v246, v14, v18
  v_fma_f32 v19, v247, v15, v19
  v_cvt_pk_bf16_f32 v22, v16, v17
  v_cvt_pk_bf16_f32 v23, v18, v19
  buffer_store_dwordx2 v[22:23], v183, s[28:31], 0 offen offset:16
  v_mul_f32 v12, 0xbfb8aa3b, v232
  v_mul_f32 v13, 0xbfb8aa3b, v233
  v_mul_f32 v14, 0xbfb8aa3b, v234
  v_mul_f32 v15, 0xbfb8aa3b, v235
  v_exp_f32 v12, v12
  v_exp_f32 v13, v13
  v_exp_f32 v14, v14
  v_exp_f32 v15, v15
  v_mul_f32 v248, v248, v232
  v_mul_f32 v249, v249, v233
  v_mul_f32 v250, v250, v234
  v_mul_f32 v251, v251, v235
  v_add_f32 v12, 1.0, v12
  v_add_f32 v13, 1.0, v13
  v_add_f32 v14, 1.0, v14
  v_add_f32 v15, 1.0, v15
  v_rcp_f32 v12, v12
  v_rcp_f32 v13, v13
  v_rcp_f32 v14, v14
  v_rcp_f32 v15, v15
  v_lshlrev_b32 v16, 16, v188
  v_and_b32 v17, 0xffff0000, v188
  v_lshlrev_b32 v18, 16, v189
  v_and_b32 v19, 0xffff0000, v189
  v_fma_f32 v16, v248, v12, v16
  v_fma_f32 v17, v249, v13, v17
  v_fma_f32 v18, v250, v14, v18
  v_fma_f32 v19, v251, v15, v19
  v_cvt_pk_bf16_f32 v24, v16, v17
  v_cvt_pk_bf16_f32 v25, v18, v19
  buffer_store_dwordx2 v[24:25], v183, s[28:31], 0 offen offset:32
  v_mul_f32 v12, 0xbfb8aa3b, v236
  v_mul_f32 v13, 0xbfb8aa3b, v237
  v_mul_f32 v14, 0xbfb8aa3b, v238
  v_mul_f32 v15, 0xbfb8aa3b, v239
  v_exp_f32 v12, v12
  v_exp_f32 v13, v13
  v_exp_f32 v14, v14
  v_exp_f32 v15, v15
  v_mul_f32 v252, v252, v236
  v_mul_f32 v253, v253, v237
  v_mul_f32 v254, v254, v238
  v_mul_f32 v255, v255, v239
  v_add_f32 v12, 1.0, v12
  v_add_f32 v13, 1.0, v13
  v_add_f32 v14, 1.0, v14
  v_add_f32 v15, 1.0, v15
  v_rcp_f32 v12, v12
  v_rcp_f32 v13, v13
  v_rcp_f32 v14, v14
  v_rcp_f32 v15, v15
  v_lshlrev_b32 v16, 16, v190
  v_and_b32 v17, 0xffff0000, v190
  v_lshlrev_b32 v18, 16, v191
  v_and_b32 v19, 0xffff0000, v191
  v_fma_f32 v16, v252, v12, v16
  v_fma_f32 v17, v253, v13, v17
  v_fma_f32 v18, v254, v14, v18
  v_fma_f32 v19, v255, v15, v19
  v_cvt_pk_bf16_f32 v26, v16, v17
  v_cvt_pk_bf16_f32 v27, v18, v19
  buffer_store_dwordx2 v[26:27], v183, s[28:31], 0 offen offset:48
  s_memtime s[80:81]
  s_waitcnt lgkmcnt(0)
  v_writelane_b32 v40, s96, 0
  v_writelane_b32 v40, s44, 1
  v_writelane_b32 v40, s46, 2
  v_writelane_b32 v40, s78, 3
  v_writelane_b32 v40, s80, 4
  v_writelane_b32 v40, s22, 5
  v_writelane_b32 v40, s14, 6
  v_writelane_b32 v40, s20, 7
  s_lshl_b32 s60, s2, 2
  s_add_u32 s60, s60, s48
  s_lshl_b32 s60, s60, 5
  s_add_u32 s60, s60, 0x978000
  v_lshlrev_b32 v41, 2, v176
  v_mov_b32 v42, 0x7ffffff0
  v_cmp_gt_u32 vcc, 8, v176
  s_nop 1
  v_cndmask_b32 v41, v42, v41, vcc
  buffer_store_dword v40, v41, s[40:43], s60 offen
  s_endpgm
L_p2_loaderO:
  s_nop 1
  s_sub_u32 s38, s48, 4
  s_and_b32 s60, s38, 1
  s_lshr_b32 s61, s38, 1
  s_lshl_b32 s62, s32, 1
  s_add_u32 s62, s62, s60
  s_mul_i32 s62, s62, 144
  s_lshl_b32 s63, s61, 1
  s_add_u32 s62, s62, s63
  s_lshl_b32 s34, s62, 10
  s_lshl_b32 s62, s60, 2
  s_add_u32 s62, s62, s63
  s_lshl_b32 s35, s62, 10
  s_lshl_b32 s36, s38, 11
  s_add_u32 s36, s36, 8192
  s_lshl_b32 s37, s33, 7
  v_lshlrev_b32 v177, 4, v176
  v_lshrrev_b32 v192, 3, v176
  s_lshl_b32 s62, s38, 4
  v_add_u32 v192, s62, v192
  v_lshlrev_b32 v192, 10, v192
  v_and_b32 v193, 7, v176
  v_lshrrev_b32 v194, 2, v176
  v_and_b32 v194, 4, v194
  v_xor_b32 v193, v193, v194
  v_lshl_add_u32 v180, v193, 4, v192
  s_waitcnt lgkmcnt(0)
  s_add_u32 m0, s36, 0
  s_add_u32 s60, s37, 0
  buffer_load_dwordx4 v180, s[68:71], s60 offen lds
  s_add_u32 m0, s36, 1024
  s_add_u32 s60, s37, 8192
  buffer_load_dwordx4 v180, s[68:71], s60 offen lds
  s_waitcnt vmcnt(2)
  v_readfirstlane_b32 s63, v0
  s_nop 1
  s_cmp_ge_u32 s63, 16
  s_cbranch_scc1 L_p2O_a_go
  s_mov_b32 s82, 0
L_p2O_a_spin:
  buffer_load_dword v184, off, s[40:43], s87 sc1
  s_waitcnt vmcnt(0)
  v_readfirstlane_b32 s63, v184
  s_add_u32 s82, s82, 1
  s_cmp_ge_u32 s63, 16
  s_cbranch_scc1 L_p2O_a_go
  s_cmp_ge_u32 s82, 0x200000
  s_cbranch_scc1 L_p2O_a_go
  s_sleep 3
  s_branch L_p2O_a_spin
L_p2O_a_go:
  s_nop 1
  s_add_u32 m0, s35, 0
  s_add_u32 s60, s34, 0
  buffer_load_dwordx4 v177, s[40:43], s60 offen lds
  s_add_u32 m0, s35, 1024
  s_add_u32 s60, s34, 1024
  buffer_load_dwordx4 v177, s[40:43], s60 offen lds
  s_add_u32 m0, s36, 16384
  s_add_u32 s60, s37, 327680
  buffer_load_dwordx4 v180, s[68:71], s60 offen lds
  s_add_u32 m0, s36, 17408
  s_add_u32 s60, s37, 335872
  buffer_load_dwordx4 v180, s[68:71], s60 offen lds
  s_add_u32 m0, s35, 16384
  s_add_u32 s60, s34, 20480
  buffer_load_dwordx4 v177, s[40:43], s60 offen lds
  s_add_u32 m0, s35, 17408
  s_add_u32 s60, s34, 21504
  buffer_load_dwordx4 v177, s[40:43], s60 offen lds
  s_add_u32 m0, s36, 32768
  s_add_u32 s60, s37, 458752
  buffer_load_dwordx4 v180, s[68:71], s60 offen lds
  s_add_u32 m0, s36, 33792
  s_add_u32 s60, s37, 466944
  buffer_load_dwordx4 v180, s[68:71], s60 offen lds
  s_add_u32 m0, s35, 32768
  s_add_u32 s60, s34, 28672
  buffer_load_dwordx4 v177, s[40:43], s60 offen lds
  s_add_u32 m0, s35, 33792
  s_add_u32 s60, s34, 29696
  buffer_load_dwordx4 v177, s[40:43], s60 offen lds
  s_add_u32 m0, s36, 49152
  s_add_u32 s60, s37, 786432
  buffer_load_dwordx4 v180, s[68:71], s60 offen lds
  s_add_u32 m0, s36, 50176
  s_add_u32 s60, s37, 794624
  buffer_load_dwordx4 v180, s[68:71], s60 offen lds
  s_add_u32 m0, s35, 49152
  s_add_u32 s60, s34, 49152
  buffer_load_dwordx4 v177, s[40:43], s60 offen lds
  s_add_u32 m0, s35, 50176
  s_add_u32 s60, s34, 50176
  buffer_load_dwordx4 v177, s[40:43], s60 offen lds
  v_and_b32 v28, 0x1f0, v1
  v_add_u32 v28, s4, v28
  ds_read_b128 v[20:23], v28 offset:0
  ds_read_b128 v[24:27], v28 offset:512
  s_waitcnt lgkmcnt(1)
  v_add_f32 v20, v20, v21
  v_add_f32 v22, v22, v23
  v_add_f32 v20, v20, v22
  v_cvt_pk_bf16_f32 v21, v20, v20
  v_lshlrev_b32 v21, 16, v21
  v_sub_f32 v21, v20, v21
  v_cvt_pk_bf16_f32 v46, v20, v21
  s_nop 1
  v_mfma_f32_32x32x8_bf16 v[64:79], v[46:47], v[44:45], v[64:79]
  s_waitcnt lgkmcnt(0)
  v_add_f32 v24, v24, v25
  v_add_f32 v26, v26, v27
  v_add_f32 v24, v24, v26
  v_cvt_pk_bf16_f32 v25, v24, v24
  v_lshlrev_b32 v25, 16, v25
  v_sub_f32 v25, v24, v25
  v_cvt_pk_bf16_f32 v46, v24, v25
  s_waitcnt vmcnt(12)
  s_barrier
  s_add_u32 m0, s36, 65536
  s_add_u32 s60, s37, 917504
  buffer_load_dwordx4 v180, s[68:71], s60 offen lds
  s_add_u32 m0, s36, 66560
  s_add_u32 s60, s37, 925696
  buffer_load_dwordx4 v180, s[68:71], s60 offen lds
  s_add_u32 m0, s35, 65536
  s_add_u32 s60, s34, 57344
  buffer_load_dwordx4 v177, s[40:43], s60 offen lds
  s_add_u32 m0, s35, 66560
  s_add_u32 s60, s34, 58368
  buffer_load_dwordx4 v177, s[40:43], s60 offen lds
  s_add_u32 m0, s36, 81920
  s_add_u32 s60, s37, 1245184
  buffer_load_dwordx4 v180, s[68:71], s60 offen lds
  s_add_u32 m0, s36, 82944
  s_add_u32 s60, s37, 1253376
  buffer_load_dwordx4 v180, s[68:71], s60 offen lds
  s_add_u32 m0, s35, 81920
  s_add_u32 s60, s34, 77824
  buffer_load_dwordx4 v177, s[40:43], s60 offen lds
  s_add_u32 m0, s35, 82944
  s_add_u32 s60, s34, 78848
  buffer_load_dwordx4 v177, s[40:43], s60 offen lds
  v_mfma_f32_32x32x8_bf16 v[80:95], v[46:47], v[44:45], v[80:95]
  v_mul_f32 v28, v64, v64
  v_mul_f32 v29, v65, v65
  v_mul_f32 v30, v66, v66
  v_mul_f32 v31, v67, v67
  v_fma_f32 v28, v28, v2, v3
  v_fma_f32 v29, v29, v2, v3
  v_fma_f32 v30, v30, v2, v3
  v_fma_f32 v31, v31, v2, v3
  v_mul_f32 v28, v64, v28
  v_mul_f32 v29, v65, v29
  v_mul_f32 v30, v66, v30
  s_waitcnt vmcnt(16)
  s_barrier
  s_add_u32 m0, s36, 98304
  s_add_u32 s60, s37, 1376256
  buffer_load_dwordx4 v180, s[68:71], s60 offen lds
  s_add_u32 m0, s36, 99328
  s_add_u32 s60, s37, 1384448
  buffer_load_dwordx4 v180, s[68:71], s60 offen lds
  s_add_u32 m0, s35, 98304
  s_add_u32 s60, s34, 86016
  buffer_load_dwordx4 v177, s[40:43], s60 offen lds
  s_add_u32 m0, s35, 99328
  s_add_u32 s60, s34, 87040
  buffer_load_dwordx4 v177, s[40:43], s60 offen lds
  v_mul_f32 v31, v67, v31
  v_exp_f32 v28, v28
  v_exp_f32 v29, v29
  v_exp_f32 v30, v30
  v_exp_f32 v31, v31
  v_mul_f32 v80, v64, v80
  v_mul_f32 v81, v65, v81
  v_mul_f32 v82, v66, v82
  v_mul_f32 v83, v67, v83
  v_fma_f32 v28, v28, v4, v4
  v_fma_f32 v29, v29, v4, v4
  v_fma_f32 v30, v30, v4, v4
  v_fma_f32 v31, v31, v4, v4
  v_rcp_f32 v28, v28
  v_rcp_f32 v29, v29
  v_rcp_f32 v30, v30
  s_waitcnt vmcnt(16)
  s_barrier
  s_add_u32 m0, s36, 114688
  s_add_u32 s60, s37, 1703936
  buffer_load_dwordx4 v180, s[68:71], s60 offen lds
  s_add_u32 m0, s36, 115712
  s_add_u32 s60, s37, 1712128
  buffer_load_dwordx4 v180, s[68:71], s60 offen lds
  s_add_u32 m0, s35, 114688
  s_add_u32 s60, s34, 106496
  buffer_load_dwordx4 v177, s[40:43], s60 offen lds
  s_add_u32 m0, s35, 115712
  s_add_u32 s60, s34, 107520
  buffer_load_dwordx4 v177, s[40:43], s60 offen lds
  v_rcp_f32 v31, v31
  v_mul_f32 v80, v80, v28
  v_mul_f32 v81, v81, v29
  v_mul_f32 v82, v82, v30
  v_mul_f32 v83, v83, v31
  v_cvt_pk_bf16_f32 v20, v80, v81
  v_cvt_pk_bf16_f32 v21, v82, v83
  v_mul_f32 v28, v68, v68
  v_mul_f32 v29, v69, v69
  v_mul_f32 v30, v70, v70
  v_mul_f32 v31, v71, v71
  v_fma_f32 v28, v28, v2, v3
  v_fma_f32 v29, v29, v2, v3
  v_fma_f32 v30, v30, v2, v3
  v_fma_f32 v31, v31, v2, v3
  v_mul_f32 v28, v68, v28
  s_waitcnt vmcnt(16)
  s_barrier
  s_add_u32 m0, s36, 131072
  s_add_u32 s60, s37, 196608
  buffer_load_dwordx4 v180, s[68:71], s60 offen lds
  s_add_u32 m0, s36, 132096
  s_add_u32 s60, s37, 204800
  buffer_load_dwordx4 v180, s[68:71], s60 offen lds
  s_add_u32 m0, s35, 131072
  s_add_u32 s60, s34, 12288
  buffer_load_dwordx4 v177, s[40:43], s60 offen lds
  s_add_u32 m0, s35, 132096
  s_add_u32 s60, s34, 13312
  buffer_load_dwordx4 v177, s[40:43], s60 offen lds
  v_mul_f32 v29, v69, v29
  v_mul_f32 v30, v70, v30
  v_mul_f32 v31, v71, v31
  v_exp_f32 v28, v28
  v_exp_f32 v29, v29
  v_exp_f32 v30, v30
  v_exp_f32 v31, v31
  v_mul_f32 v84, v68, v84
  v_mul_f32 v85, v69, v85
  v_mul_f32 v86, v70, v86
  v_mul_f32 v87, v71, v87
  v_fma_f32 v28, v28, v4, v4
  v_fma_f32 v29, v29, v4, v4
  v_fma_f32 v30, v30, v4, v4
  v_fma_f32 v31, v31, v4, v4
  v_rcp_f32 v28, v28
  s_waitcnt vmcnt(16)
  s_barrier
  s_add_u32 m0, s36, 147456
  s_add_u32 s60, s37, 655360
  buffer_load_dwordx4 v180, s[68:71], s60 offen lds
  s_add_u32 m0, s36, 148480
  s_add_u32 s60, s37, 663552
  buffer_load_dwordx4 v180, s[68:71], s60 offen lds
  s_add_u32 m0, s35, 147456
  s_add_u32 s60, s34, 40960
  buffer_load_dwordx4 v177, s[40:43], s60 offen lds
  s_add_u32 m0, s35, 148480
  s_add_u32 s60, s34, 41984
  buffer_load_dwordx4 v177, s[40:43], s60 offen lds
  v_rcp_f32 v29, v29
  v_rcp_f32 v30, v30
  v_rcp_f32 v31, v31
  v_mul_f32 v84, v84, v28
  v_mul_f32 v85, v85, v29
  v_mul_f32 v86, v86, v30
  v_mul_f32 v87, v87, v31
  v_cvt_pk_bf16_f32 v22, v84, v85
  v_cvt_pk_bf16_f32 v23, v86, v87
  s_add_u32 s61, s66, 0
  buffer_store_dwordx4 v[20:23], v1, s[40:43], s61 offen sc1
  v_mul_f32 v28, v72, v72
  v_mul_f32 v29, v73, v73
  v_mul_f32 v30, v74, v74
  v_mul_f32 v31, v75, v75
  v_fma_f32 v28, v28, v2, v3
  s_waitcnt vmcnt(17)
  s_barrier
  s_add_u32 m0, s36, 0
  s_add_u32 s60, s37, 1114112
  buffer_load_dwordx4 v180, s[68:71], s60 offen lds
  s_add_u32 m0, s36, 1024
  s_add_u32 s60, s37, 1122304
  buffer_load_dwordx4 v180, s[68:71], s60 offen lds
  s_add_u32 m0, s35, 0
  s_add_u32 s60, s34, 69632
  buffer_load_dwordx4 v177, s[40:43], s60 offen lds
  s_add_u32 m0, s35, 1024
  s_add_u32 s60, s34, 70656
  buffer_load_dwordx4 v177, s[40:43], s60 offen lds
  v_fma_f32 v29, v29, v2, v3
  v_fma_f32 v30, v30, v2, v3
  v_fma_f32 v31, v31, v2, v3
  v_mul_f32 v28, v72, v28
  v_mul_f32 v29, v73, v29
  v_mul_f32 v30, v74, v30
  v_mul_f32 v31, v75, v31
  v_exp_f32 v28, v28
  v_exp_f32 v29, v29
  v_exp_f32 v30, v30
  v_exp_f32 v31, v31
  v_mul_f32 v88, v72, v88
  v_mul_f32 v89, v73, v89
  v_mul_f32 v90, v74, v90
  v_mul_f32 v91, v75, v91
  v_fma_f32 v28, v28, v4, v4
  s_waitcnt vmcnt(17)
  v_fma_f32 v29, v29, v4, v4
  v_fma_f32 v30, v30, v4, v4
  v_fma_f32 v31, v31, v4, v4
  v_rcp_f32 v28, v28
  v_rcp_f32 v29, v29
  v_rcp_f32 v30, v30
  v_rcp_f32 v31, v31
  v_mul_f32 v88, v88, v28
  v_mul_f32 v89, v89, v29
  v_mul_f32 v90, v90, v30
  v_mul_f32 v91, v91, v31
  v_cvt_pk_bf16_f32 v24, v88, v89
  v_cvt_pk_bf16_f32 v25, v90, v91
  v_mul_f32 v28, v76, v76
  v_mul_f32 v29, v77, v77
  v_mul_f32 v30, v78, v78
  v_mul_f32 v31, v79, v79
  v_fma_f32 v28, v28, v2, v3
  v_fma_f32 v29, v29, v2, v3
  v_fma_f32 v30, v30, v2, v3
  v_fma_f32 v31, v31, v2, v3
  v_mul_f32 v28, v76, v28
  v_mul_f32 v29, v77, v29
  v_mul_f32 v30, v78, v30
  v_mul_f32 v31, v79, v31
  v_exp_f32 v28, v28
  v_exp_f32 v29, v29
  v_exp_f32 v30, v30
  v_exp_f32 v31, v31
  v_mul_f32 v92, v76, v92
  v_mul_f32 v93, v77, v93
  v_mul_f32 v94, v78, v94
  v_mul_f32 v95, v79, v95
  v_fma_f32 v28, v28, v4, v4
  v_fma_f32 v29, v29, v4, v4
  v_fma_f32 v30, v30, v4, v4
  v_fma_f32 v31, v31, v4, v4
  v_rcp_f32 v28, v28
  v_rcp_f32 v29, v29
  v_rcp_f32 v30, v30
  v_rcp_f32 v31, v31
  v_mul_f32 v92, v92, v28
  v_mul_f32 v93, v93, v29
  v_mul_f32 v94, v94, v30
  v_mul_f32 v95, v95, v31
  v_cvt_pk_bf16_f32 v26, v92, v93
  v_cvt_pk_bf16_f32 v27, v94, v95
  s_add_u32 s61, s66, 1024
  buffer_store_dwordx4 v[24:27], v1, s[40:43], s61 offen sc1
  s_barrier
  s_add_u32 m0, s36, 16384
  s_add_u32 s60, s37, 1572864
  buffer_load_dwordx4 v180, s[68:71], s60 offen lds
  s_add_u32 m0, s36, 17408
  s_add_u32 s60, s37, 1581056
  buffer_load_dwordx4 v180, s[68:71], s60 offen lds
  s_add_u32 m0, s35, 16384
  s_add_u32 s60, s34, 98304
  buffer_load_dwordx4 v177, s[40:43], s60 offen lds
  s_add_u32 m0, s35, 17408
  s_add_u32 s60, s34, 99328
  buffer_load_dwordx4 v177, s[40:43], s60 offen lds
  s_waitcnt vmcnt(18)
  s_barrier
  s_add_u32 m0, s36, 32768
  s_add_u32 s60, s37, 65536
  buffer_load_dwordx4 v180, s[68:71], s60 offen lds
  s_add_u32 m0, s36, 33792
  s_add_u32 s60, s37, 73728
  buffer_load_dwordx4 v180, s[68:71], s60 offen lds
  s_mov_b32 s82, 0
L_p2O_b_spin:
  buffer_load_dword v184, off, s[40:43], s39 sc1
  s_waitcnt vmcnt(0)
  v_readfirstlane_b32 s63, v184
  s_add_u32 s82, s82, 1
  s_cmp_ge_u32 s63, 8
  s_cbranch_scc1 L_p2O_b_go
  s_cmp_ge_u32 s82, 0x200000
  s_cbranch_scc1 L_p2O_b_go
  s_sleep 3
  s_branch L_p2O_b_spin
L_p2O_b_go:
  s_nop 1
  s_add_u32 m0, s35, 32768
  s_add_u32 s60, s34, 4096
  buffer_load_dwordx4 v177, s[40:43], s60 offen lds
  s_add_u32 m0, s35, 33792
  s_add_u32 s60, s34, 5120
  buffer_load_dwordx4 v177, s[40:43], s60 offen lds
  s_barrier
  s_add_u32 m0, s36, 49152
  s_add_u32 s60, s37, 393216
  buffer_load_dwordx4 v180, s[68:71], s60 offen lds
  s_add_u32 m0, s36, 50176
  s_add_u32 s60, s37, 401408
  buffer_load_dwordx4 v180, s[68:71], s60 offen lds
  s_add_u32 m0, s35, 49152
  s_add_u32 s60, s34, 24576
  buffer_load_dwordx4 v177, s[40:43], s60 offen lds
  s_add_u32 m0, s35, 50176
  s_add_u32 s60, s34, 25600
  buffer_load_dwordx4 v177, s[40:43], s60 offen lds
  s_barrier
  s_add_u32 m0, s36, 65536
  s_add_u32 s60, s37, 524288
  buffer_load_dwordx4 v180, s[68:71], s60 offen lds
  s_add_u32 m0, s36, 66560
  s_add_u32 s60, s37, 532480
  buffer_load_dwordx4 v180, s[68:71], s60 offen lds
  s_add_u32 m0, s35, 65536
  s_add_u32 s60, s34, 32768
  buffer_load_dwordx4 v177, s[40:43], s60 offen lds
  s_add_u32 m0, s35, 66560
  s_add_u32 s60, s34, 33792
  buffer_load_dwordx4 v177, s[40:43], s60 offen lds
  s_barrier
  s_add_u32 m0, s36, 81920
  s_add_u32 s60, s37, 851968
  buffer_load_dwordx4 v180, s[68:71], s60 offen lds
  s_add_u32 m0, s36, 82944
  s_add_u32 s60, s37, 860160
  buffer_load_dwordx4 v180, s[68:71], s60 offen lds
  s_add_u32 m0, s35, 81920
  s_add_u32 s60, s34, 53248
  buffer_load_dwordx4 v177, s[40:43], s60 offen lds
  s_add_u32 m0, s35, 82944
  s_add_u32 s60, s34, 54272
  buffer_load_dwordx4 v177, s[40:43], s60 offen lds
  s_barrier
  s_add_u32 m0, s36, 98304
  s_add_u32 s60, s37, 983040
  buffer_load_dwordx4 v180, s[68:71], s60 offen lds
  s_add_u32 m0, s36, 99328
  s_add_u32 s60, s37, 991232
  buffer_load_dwordx4 v180, s[68:71], s60 offen lds
  s_add_u32 m0, s35, 98304
  s_add_u32 s60, s34, 61440
  buffer_load_dwordx4 v177, s[40:43], s60 offen lds
  s_add_u32 m0, s35, 99328
  s_add_u32 s60, s34, 62464
  buffer_load_dwordx4 v177, s[40:43], s60 offen lds
  s_waitcnt vmcnt(16)
  s_barrier
  s_add_u32 m0, s36, 114688
  s_add_u32 s60, s37, 1310720
  buffer_load_dwordx4 v180, s[68:71], s60 offen lds
  s_add_u32 m0, s36, 115712
  s_add_u32 s60, s37, 1318912
  buffer_load_dwordx4 v180, s[68:71], s60 offen lds
  s_add_u32 m0, s35, 114688
  s_add_u32 s60, s34, 81920
  buffer_load_dwordx4 v177, s[40:43], s60 offen lds
  s_add_u32 m0, s35, 115712
  s_add_u32 s60, s34, 82944
  buffer_load_dwordx4 v177, s[40:43], s60 offen lds
  s_waitcnt vmcnt(16)
  s_barrier
  s_add_u32 m0, s36, 131072
  s_add_u32 s60, s37, 1441792
  buffer_load_dwordx4 v180, s[68:71], s60 offen lds
  s_add_u32 m0, s36, 132096
  s_add_u32 s60, s37, 1449984
  buffer_load_dwordx4 v180, s[68:71], s60 offen lds
  s_add_u32 m0, s35, 131072
  s_add_u32 s60, s34, 90112
  buffer_load_dwordx4 v177, s[40:43], s60 offen lds
  s_add_u32 m0, s35, 132096
  s_add_u32 s60, s34, 91136
  buffer_load_dwordx4 v177, s[40:43], s60 offen lds
  s_waitcnt vmcnt(16)
  s_barrier
  s_add_u32 m0, s36, 147456
  s_add_u32 s60, s37, 1769472
  buffer_load_dwordx4 v180, s[68:71], s60 offen lds
  s_add_u32 m0, s36, 148480
  s_add_u32 s60, s37, 1777664
  buffer_load_dwordx4 v180, s[68:71], s60 offen lds
  s_add_u32 m0, s35, 147456
  s_add_u32 s60, s34, 110592
  buffer_load_dwordx4 v177, s[40:43], s60 offen lds
  s_add_u32 m0, s35, 148480
  s_add_u32 s60, s34, 111616
  buffer_load_dwordx4 v177, s[40:43], s60 offen lds
  s_waitcnt vmcnt(16)
  s_barrier
  s_add_u32 m0, s36, 0
  s_add_u32 s60, s37, 131072
  buffer_load_dwordx4 v180, s[68:71], s60 offen lds
  s_add_u32 m0, s36, 1024
  s_add_u32 s60, s37, 139264
  buffer_load_dwordx4 v180, s[68:71], s60 offen lds
  s_mov_b32 s82, 0
L_p2O_c_spin:
  buffer_load_dword v184, off, s[40:43], s86 sc1
  s_waitcnt vmcnt(0)
  v_readfirstlane_b32 s63, v184
  s_add_u32 s82, s82, 1
  s_cmp_ge_u32 s63, 16
  s_cbranch_scc1 L_p2O_c_go
  s_cmp_ge_u32 s82, 0x200000
  s_cbranch_scc1 L_p2O_c_go
  s_sleep 3
  s_branch L_p2O_c_spin
L_p2O_c_go:
  s_nop 1
  s_add_u32 m0, s35, 0
  s_add_u32 s60, s34, 8192
  buffer_load_dwordx4 v177, s[40:43], s60 offen lds
  s_add_u32 m0, s35, 1024
  s_add_u32 s60, s34, 9216
  buffer_load_dwordx4 v177, s[40:43], s60 offen lds
  s_barrier
  s_add_u32 m0, s36, 16384
  s_add_u32 s60, s37, 589824
  buffer_load_dwordx4 v180, s[68:71], s60 offen lds
  s_add_u32 m0, s36, 17408
  s_add_u32 s60, s37, 598016
  buffer_load_dwordx4 v180, s[68:71], s60 offen lds
  s_add_u32 m0, s35, 16384
  s_add_u32 s60, s34, 36864
  buffer_load_dwordx4 v177, s[40:43], s60 offen lds
  s_add_u32 m0, s35, 17408
  s_add_u32 s60, s34, 37888
  buffer_load_dwordx4 v177, s[40:43], s60 offen lds
  s_barrier
  s_add_u32 m0, s36, 32768
  s_add_u32 s60, s37, 1048576
  buffer_load_dwordx4 v180, s[68:71], s60 offen lds
  s_add_u32 m0, s36, 33792
  s_add_u32 s60, s37, 1056768
  buffer_load_dwordx4 v180, s[68:71], s60 offen lds
  s_add_u32 m0, s35, 32768
  s_add_u32 s60, s34, 65536
  buffer_load_dwordx4 v177, s[40:43], s60 offen lds
  s_add_u32 m0, s35, 33792
  s_add_u32 s60, s34, 66560
  buffer_load_dwordx4 v177, s[40:43], s60 offen lds
  s_barrier
  s_add_u32 m0, s36, 49152
  s_add_u32 s60, s37, 1507328
  buffer_load_dwordx4 v180, s[68:71], s60 offen lds
  s_add_u32 m0, s36, 50176
  s_add_u32 s60, s37, 1515520
  buffer_load_dwordx4 v180, s[68:71], s60 offen lds
  s_add_u32 m0, s35, 49152
  s_add_u32 s60, s34, 94208
  buffer_load_dwordx4 v177, s[40:43], s60 offen lds
  s_add_u32 m0, s35, 50176
  s_add_u32 s60, s34, 95232
  buffer_load_dwordx4 v177, s[40:43], s60 offen lds
  s_barrier
  s_add_u32 m0, s36, 65536
  s_add_u32 s60, s37, 262144
  buffer_load_dwordx4 v180, s[68:71], s60 offen lds
  s_add_u32 m0, s36, 66560
  s_add_u32 s60, s37, 270336
  buffer_load_dwordx4 v180, s[68:71], s60 offen lds
  s_add_u32 m0, s35, 65536
  s_add_u32 s60, s34, 16384
  buffer_load_dwordx4 v177, s[40:43], s60 offen lds
  s_add_u32 m0, s35, 66560
  s_add_u32 s60, s34, 17408
  buffer_load_dwordx4 v177, s[40:43], s60 offen lds
  s_waitcnt vmcnt(16)
  s_barrier
  s_add_u32 m0, s36, 81920
  s_add_u32 s60, s37, 720896
  buffer_load_dwordx4 v180, s[68:71], s60 offen lds
  s_add_u32 m0, s36, 82944
  s_add_u32 s60, s37, 729088
  buffer_load_dwordx4 v180, s[68:71], s60 offen lds
  s_add_u32 m0, s35, 81920
  s_add_u32 s60, s34, 45056
  buffer_load_dwordx4 v177, s[40:43], s60 offen lds
  s_add_u32 m0, s35, 82944
  s_add_u32 s60, s34, 46080
  buffer_load_dwordx4 v177, s[40:43], s60 offen lds
  s_waitcnt vmcnt(16)
  s_barrier
  s_add_u32 m0, s36, 98304
  s_add_u32 s60, s37, 1179648
  buffer_load_dwordx4 v180, s[68:71], s60 offen lds
  s_add_u32 m0, s36, 99328
  s_add_u32 s60, s37, 1187840
  buffer_load_dwordx4 v180, s[68:71], s60 offen lds
  s_add_u32 m0, s35, 98304
  s_add_u32 s60, s34, 73728
  buffer_load_dwordx4 v177, s[40:43], s60 offen lds
  s_add_u32 m0, s35, 99328
  s_add_u32 s60, s34, 74752
  buffer_load_dwordx4 v177, s[40:43], s60 offen lds
  s_waitcnt vmcnt(16)
  s_barrier
  s_add_u32 m0, s36, 114688
  s_add_u32 s60, s37, 1638400
  buffer_load_dwordx4 v180, s[68:71], s60 offen lds
  s_add_u32 m0, s36, 115712
  s_add_u32 s60, s37, 1646592
  buffer_load_dwordx4 v180, s[68:71], s60 offen lds
  s_add_u32 m0, s35, 114688
  s_add_u32 s60, s34, 102400
  buffer_load_dwordx4 v177, s[40:43], s60 offen lds
  s_add_u32 m0, s35, 115712
  s_add_u32 s60, s34, 103424
  buffer_load_dwordx4 v177, s[40:43], s60 offen lds
  s_waitcnt vmcnt(16)
  s_barrier
  s_add_u32 m0, s36, 131072
  s_add_u32 s60, s37, 0
  buffer_load_dwordx4 v180, s[72:75], s60 offen lds
  s_add_u32 m0, s36, 132096
  s_add_u32 s60, s37, 8192
  buffer_load_dwordx4 v180, s[72:75], s60 offen lds
  s_add_u32 m0, s35, 131072
  s_add_u32 s60, s34, 114688
  buffer_load_dwordx4 v177, s[40:43], s60 offen lds
  s_add_u32 m0, s35, 132096
  s_add_u32 s60, s34, 115712
  buffer_load_dwordx4 v177, s[40:43], s60 offen lds
  s_waitcnt vmcnt(16)
  s_barrier
  s_add_u32 m0, s36, 147456
  s_add_u32 s60, s37, 65536
  buffer_load_dwordx4 v180, s[72:75], s60 offen lds
  s_add_u32 m0, s36, 148480
  s_add_u32 s60, s37, 73728
  buffer_load_dwordx4 v180, s[72:75], s60 offen lds
  s_add_u32 m0, s35, 147456
  s_add_u32 s60, s34, 118784
  buffer_load_dwordx4 v177, s[40:43], s60 offen lds
  s_add_u32 m0, s35, 148480
  s_add_u32 s60, s34, 119808
  buffer_load_dwordx4 v177, s[40:43], s60 offen lds
  s_waitcnt vmcnt(16)
  s_barrier
  s_add_u32 m0, s36, 0
  s_add_u32 s60, s37, 131072
  buffer_load_dwordx4 v180, s[72:75], s60 offen lds
  s_add_u32 m0, s36, 1024
  s_add_u32 s60, s37, 139264
  buffer_load_dwordx4 v180, s[72:75], s60 offen lds
  s_add_u32 m0, s35, 0
  s_add_u32 s60, s34, 122880
  buffer_load_dwordx4 v177, s[40:43], s60 offen lds
  s_add_u32 m0, s35, 1024
  s_add_u32 s60, s34, 123904
  buffer_load_dwordx4 v177, s[40:43], s60 offen lds
  s_waitcnt vmcnt(16)
  s_barrier
  s_add_u32 m0, s36, 16384
  s_add_u32 s60, s37, 196608
  buffer_load_dwordx4 v180, s[72:75], s60 offen lds
  s_add_u32 m0, s36, 17408
  s_add_u32 s60, s37, 204800
  buffer_load_dwordx4 v180, s[72:75], s60 offen lds
  s_add_u32 m0, s35, 16384
  s_add_u32 s60, s34, 126976
  buffer_load_dwordx4 v177, s[40:43], s60 offen lds
  s_add_u32 m0, s35, 17408
  s_add_u32 s60, s34, 128000
  buffer_load_dwordx4 v177, s[40:43], s60 offen lds
  s_waitcnt vmcnt(16)
  s_barrier
  s_add_u32 m0, s36, 32768
  s_add_u32 s60, s37, 262144
  buffer_load_dwordx4 v180, s[72:75], s60 offen lds
  s_add_u32 m0, s36, 33792
  s_add_u32 s60, s37, 270336
  buffer_load_dwordx4 v180, s[72:75], s60 offen lds
  s_add_u32 m0, s35, 32768
  s_add_u32 s60, s34, 131072
  buffer_load_dwordx4 v177, s[40:43], s60 offen lds
  s_add_u32 m0, s35, 33792
  s_add_u32 s60, s34, 132096
  buffer_load_dwordx4 v177, s[40:43], s60 offen lds
  s_waitcnt vmcnt(16)
  s_barrier
  s_add_u32 m0, s36, 49152
  s_add_u32 s60, s37, 327680
  buffer_load_dwordx4 v180, s[72:75], s60 offen lds
  s_add_u32 m0, s36, 50176
  s_add_u32 s60, s37, 335872
  buffer_load_dwordx4 v180, s[72:75], s60 offen lds
  s_add_u32 m0, s35, 49152
  s_add_u32 s60, s34, 135168
  buffer_load_dwordx4 v177, s[40:43], s60 offen lds
  s_add_u32 m0, s35, 50176
  s_add_u32 s60, s34, 136192
  buffer_load_dwordx4 v177, s[40:43], s60 offen lds
  s_waitcnt vmcnt(16)
  s_barrier
  s_add_u32 m0, s36, 65536
  s_add_u32 s60, s37, 393216
  buffer_load_dwordx4 v180, s[72:75], s60 offen lds
  s_add_u32 m0, s36, 66560
  s_add_u32 s60, s37, 401408
  buffer_load_dwordx4 v180, s[72:75], s60 offen lds
  s_add_u32 m0, s35, 65536
  s_add_u32 s60, s34, 139264
  buffer_load_dwordx4 v177, s[40:43], s60 offen lds
  s_add_u32 m0, s35, 66560
  s_add_u32 s60, s34, 140288
  buffer_load_dwordx4 v177, s[40:43], s60 offen lds
  s_waitcnt vmcnt(16)
  s_barrier
  s_add_u32 m0, s36, 81920
  s_add_u32 s60, s37, 458752
  buffer_load_dwordx4 v180, s[72:75], s60 offen lds
  s_add_u32 m0, s36, 82944
  s_add_u32 s60, s37, 466944
  buffer_load_dwordx4 v180, s[72:75], s60 offen lds
  s_add_u32 m0, s35, 81920
  s_add_u32 s60, s34, 143360
  buffer_load_dwordx4 v177, s[40:43], s60 offen lds
  s_add_u32 m0, s35, 82944
  s_add_u32 s60, s34, 144384
  buffer_load_dwordx4 v177, s[40:43], s60 offen lds
  s_waitcnt vmcnt(16)
  s_barrier
  s_waitcnt vmcnt(12)
  s_barrier
  s_waitcnt vmcnt(8)
  s_barrier
  s_waitcnt vmcnt(4)
  s_barrier
  s_waitcnt vmcnt(0)
  s_barrier
  s_endpgm
L_k1O_c1:
  v_mfma_f32_16x16x32_bf16 v[36:39], v[32:35], v[48:51], 0
  v_mfma_f32_16x16x32_bf16 v[40:43], v[32:35], v[52:55], 0
  s_branch L_k1O_c1_r
L_k1O_c2:
  v_mfma_f32_16x16x32_bf16 v[36:39], v[32:35], v[56:59], 0
  v_mfma_f32_16x16x32_bf16 v[40:43], v[32:35], v[60:63], 0
  s_branch L_k1O_c2_r
L_k1O_c3:
  v_mfma_f32_16x16x32_bf16 v[12:15], v[32:35], v[128:131], v[12:15]
  v_mfma_f32_16x16x32_bf16 v[12:15], v[32:35], v[132:135], v[12:15]
  v_mfma_f32_32x32x16_bf16 v[96:111], v[128:131], v[128:131], 0
  v_mfma_f32_32x32x16_bf16 v[96:111], v[132:135], v[132:135], v[96:111]
  s_branch L_k1O_c3_r
L_k1O_c4:
  v_mfma_f32_16x16x32_bf16 v[36:39], v[32:35], v[48:51], 0
  v_mfma_f32_16x16x32_bf16 v[40:43], v[32:35], v[52:55], 0
  s_branch L_k1O_c4_r
L_k1O_c5:
  v_mfma_f32_16x16x32_bf16 v[36:39], v[32:35], v[56:59], 0
  v_mfma_f32_16x16x32_bf16 v[40:43], v[32:35], v[60:63], 0
  s_branch L_k1O_c5_r
L_k1O_c6:
  v_mfma_f32_16x16x32_bf16 v[12:15], v[32:35], v[136:139], v[12:15]
  v_mfma_f32_16x16x32_bf16 v[12:15], v[32:35], v[140:143], v[12:15]
  v_mfma_f32_32x32x16_bf16 v[96:111], v[136:139], v[136:139], 0
  v_mfma_f32_32x32x16_bf16 v[96:111], v[140:143], v[140:143], v[96:111]
  s_branch L_k1O_c6_r
L_k1O_c7:
  v_mfma_f32_16x16x32_bf16 v[36:39], v[32:35], v[48:51], v[36:39]
  v_mfma_f32_16x16x32_bf16 v[40:43], v[32:35], v[52:55], v[40:43]
  s_branch L_k1O_c7_r
L_k1O_c8:
  v_mfma_f32_16x16x32_bf16 v[36:39], v[32:35], v[56:59], v[36:39]
  v_mfma_f32_16x16x32_bf16 v[40:43], v[32:35], v[60:63], v[40:43]
  s_branch L_k1O_c8_r
L_k1O_c9:
  v_mfma_f32_16x16x32_bf16 v[12:15], v[32:35], v[144:147], v[12:15]
  v_mfma_f32_16x16x32_bf16 v[12:15], v[32:35], v[148:151], v[12:15]
  v_mfma_f32_32x32x16_bf16 v[96:111], v[144:147], v[144:147], v[96:111]
  v_mfma_f32_32x32x16_bf16 v[96:111], v[148:151], v[148:151], v[96:111]
  s_branch L_k1O_c9_r
L_k1O_c10:
  v_mfma_f32_16x16x32_bf16 v[36:39], v[32:35], v[48:51], v[36:39]
  v_mfma_f32_16x16x32_bf16 v[40:43], v[32:35], v[52:55], v[40:43]
  s_branch L_k1O_c10_r
L_k1O_c11:
  v_mfma_f32_16x16x32_bf16 v[36:39], v[32:35], v[56:59], v[36:39]
  v_mfma_f32_16x16x32_bf16 v[40:43], v[32:35], v[60:63], v[40:43]
  s_branch L_k1O_c11_r
L_k1O_c12:
  v_mfma_f32_16x16x32_bf16 v[12:15], v[32:35], v[152:155], v[12:15]
  v_mfma_f32_16x16x32_bf16 v[12:15], v[32:35], v[156:159], v[12:15]
  v_mfma_f32_32x32x16_bf16 v[96:111], v[152:155], v[152:155], v[96:111]
  v_mfma_f32_32x32x16_bf16 v[96:111], v[156:159], v[156:159], v[96:111]
  s_branch L_k1O_c12_r
L_k1O_c13:
  v_mfma_f32_16x16x32_bf16 v[36:39], v[32:35], v[48:51], v[36:39]
  v_mfma_f32_16x16x32_bf16 v[40:43], v[32:35], v[52:55], v[40:43]
  s_branch L_k1O_c13_r
L_k1O_c14:
  v_mfma_f32_16x16x32_bf16 v[36:39], v[32:35], v[56:59], v[36:39]
  v_mfma_f32_16x16x32_bf16 v[40:43], v[32:35], v[60:63], v[40:43]
  s_branch L_k1O_c14_r
L_k1O_c15:
  v_mfma_f32_16x16x32_bf16 v[12:15], v[32:35], v[160:163], v[12:15]
  v_mfma_f32_16x16x32_bf16 v[12:15], v[32:35], v[164:167], v[12:15]
  v_mfma_f32_32x32x16_bf16 v[96:111], v[160:163], v[160:163], v[96:111]
  v_mfma_f32_32x32x16_bf16 v[96:111], v[164:167], v[164:167], v[96:111]
  s_branch L_k1O_c15_r
L_k1O_c16:
  v_mfma_f32_16x16x32_bf16 v[36:39], v[32:35], v[48:51], v[36:39]
  v_mfma_f32_16x16x32_bf16 v[40:43], v[32:35], v[52:55], v[40:43]
  s_branch L_k1O_c16_r
L_k1O_c17:
  v_mfma_f32_16x16x32_bf16 v[36:39], v[32:35], v[56:59], v[36:39]
  v_mfma_f32_16x16x32_bf16 v[40:43], v[32:35], v[60:63], v[40:43]
  s_branch L_k1O_c17_r
L_k1O_c18:
  v_mfma_f32_16x16x32_bf16 v[12:15], v[32:35], v[168:171], v[12:15]
  v_mfma_f32_16x16x32_bf16 v[12:15], v[32:35], v[172:175], v[12:15]
  v_mfma_f32_32x32x16_bf16 v[96:111], v[168:171], v[168:171], v[96:111]
  v_mfma_f32_32x32x16_bf16 v[96:111], v[172:175], v[172:175], v[96:111]
  s_branch L_k1O_c18_r
L_k1O_c19:
  v_mfma_f32_16x16x32_bf16 v[36:39], v[32:35], v[48:51], v[36:39]
  v_mfma_f32_16x16x32_bf16 v[40:43], v[32:35], v[52:55], v[40:43]
  s_branch L_k1O_c19_r
L_k1O_c20:
  v_mfma_f32_16x16x32_bf16 v[36:39], v[32:35], v[56:59], v[36:39]
  v_mfma_f32_16x16x32_bf16 v[40:43], v[32:35], v[60:63], v[40:43]
  s_branch L_k1O_c20_r
L_k1O_c21:
  v_mfma_f32_16x16x32_bf16 v[12:15], v[32:35], v[176:179], v[12:15]
  v_mfma_f32_16x16x32_bf16 v[12:15], v[32:35], v[180:183], v[12:15]
  v_mfma_f32_32x32x16_bf16 v[96:111], v[176:179], v[176:179], v[96:111]
  v_mfma_f32_32x32x16_bf16 v[96:111], v[180:183], v[180:183], v[96:111]
  s_branch L_k1O_c21_r
L_k1O_c22:
  v_mfma_f32_16x16x32_bf16 v[36:39], v[32:35], v[48:51], v[36:39]
  v_mfma_f32_16x16x32_bf16 v[40:43], v[32:35], v[52:55], v[40:43]
  s_branch L_k1O_c22_r
L_k1O_c23:
  v_mfma_f32_16x16x32_bf16 v[36:39], v[32:35], v[56:59], v[36:39]
  v_mfma_f32_16x16x32_bf16 v[40:43], v[32:35], v[60:63], v[40:43]
  s_branch L_k1O_c23_r
L_k1O_c24:
  v_mfma_f32_16x16x32_bf16 v[12:15], v[32:35], v[184:187], v[12:15]
  v_mfma_f32_16x16x32_bf16 v[12:15], v[32:35], v[188:191], v[12:15]
  v_mfma_f32_32x32x16_bf16 v[96:111], v[184:187], v[184:187], v[96:111]
  v_mfma_f32_32x32x16_bf16 v[96:111], v[188:191], v[188:191], v[96:111]
  s_branch L_k1O_c24_r
L_k1O_c25:
  v_mfma_f32_16x16x32_bf16 v[36:39], v[32:35], v[48:51], v[36:39]
  v_mfma_f32_16x16x32_bf16 v[40:43], v[32:35], v[52:55], v[40:43]
  s_branch L_k1O_c25_r
L_k1O_c26:
  v_mfma_f32_16x16x32_bf16 v[36:39], v[32:35], v[56:59], v[36:39]
  v_mfma_f32_16x16x32_bf16 v[40:43], v[32:35], v[60:63], v[40:43]
  s_branch L_k1O_c26_r
L_k1O_c27:
  v_mfma_f32_16x16x32_bf16 v[12:15], v[32:35], v[192:195], v[12:15]
  v_mfma_f32_16x16x32_bf16 v[12:15], v[32:35], v[196:199], v[12:15]
  v_mfma_f32_32x32x16_bf16 v[96:111], v[192:195], v[192:195], v[96:111]
  v_mfma_f32_32x32x16_bf16 v[96:111], v[196:199], v[196:199], v[96:111]
  s_branch L_k1O_c27_r
L_k1O_c28:
  v_mfma_f32_16x16x32_bf16 v[36:39], v[32:35], v[48:51], v[36:39]
  v_mfma_f32_16x16x32_bf16 v[40:43], v[32:35], v[52:55], v[40:43]
  s_branch L_k1O_c28_r
L_k1O_c29:
  v_mfma_f32_16x16x32_bf16 v[36:39], v[32:35], v[56:59], v[36:39]
  v_mfma_f32_16x16x32_bf16 v[40:43], v[32:35], v[60:63], v[40:43]
  s_branch L_k1O_c29_r
L_k1O_c30:
  v_mfma_f32_16x16x32_bf16 v[12:15], v[32:35], v[200:203], v[12:15]
  v_mfma_f32_16x16x32_bf16 v[12:15], v[32:35], v[204:207], v[12:15]
  v_mfma_f32_32x32x16_bf16 v[96:111], v[200:203], v[200:203], v[96:111]
  v_mfma_f32_32x32x16_bf16 v[96:111], v[204:207], v[204:207], v[96:111]
  s_branch L_k1O_c30_r
L_k1O_c31:
  v_mfma_f32_16x16x32_bf16 v[36:39], v[32:35], v[48:51], v[36:39]
  v_mfma_f32_16x16x32_bf16 v[40:43], v[32:35], v[52:55], v[40:43]
  s_branch L_k1O_c31_r
L_k1O_c32:
  v_mfma_f32_16x16x32_bf16 v[36:39], v[32:35], v[56:59], v[36:39]
  v_mfma_f32_16x16x32_bf16 v[40:43], v[32:35], v[60:63], v[40:43]
  s_branch L_k1O_c32_r
L_k1O_c33:
  v_mfma_f32_16x16x32_bf16 v[12:15], v[32:35], v[208:211], v[12:15]
  v_mfma_f32_16x16x32_bf16 v[12:15], v[32:35], v[212:215], v[12:15]
  v_mfma_f32_32x32x16_bf16 v[96:111], v[208:211], v[208:211], v[96:111]
  v_mfma_f32_32x32x16_bf16 v[96:111], v[212:215], v[212:215], v[96:111]
  s_branch L_k1O_c33_r
L_k1O_c34:
  v_mfma_f32_16x16x32_bf16 v[36:39], v[32:35], v[48:51], v[36:39]
  v_mfma_f32_16x16x32_bf16 v[40:43], v[32:35], v[52:55], v[40:43]
  s_branch L_k1O_c34_r
L_k1O_c35:
  v_mfma_f32_16x16x32_bf16 v[36:39], v[32:35], v[56:59], v[36:39]
  v_mfma_f32_16x16x32_bf16 v[40:43], v[32:35], v[60:63], v[40:43]
  s_branch L_k1O_c35_r
L_k1O_c36:
  v_mfma_f32_16x16x32_bf16 v[12:15], v[32:35], v[216:219], v[12:15]
  v_mfma_f32_16x16x32_bf16 v[12:15], v[32:35], v[220:223], v[12:15]
  v_mfma_f32_32x32x16_bf16 v[96:111], v[216:219], v[216:219], v[96:111]
  v_mfma_f32_32x32x16_bf16 v[96:111], v[220:223], v[220:223], v[96:111]
  s_branch L_k1O_c36_r
L_k1O_c37:
  v_mfma_f32_16x16x32_bf16 v[36:39], v[32:35], v[48:51], v[36:39]
  v_mfma_f32_16x16x32_bf16 v[40:43], v[32:35], v[52:55], v[40:43]
  s_branch L_k1O_c37_r
L_k1O_c38:
  v_mfma_f32_16x16x32_bf16 v[36:39], v[32:35], v[56:59], v[36:39]
  v_mfma_f32_16x16x32_bf16 v[40:43], v[32:35], v[60:63], v[40:43]
  s_branch L_k1O_c38_r
L_k1O_c39:
  v_mfma_f32_16x16x32_bf16 v[12:15], v[32:35], v[224:227], v[12:15]
  v_mfma_f32_16x16x32_bf16 v[12:15], v[32:35], v[228:231], v[12:15]
  v_mfma_f32_32x32x16_bf16 v[96:111], v[224:227], v[224:227], v[96:111]
  v_mfma_f32_32x32x16_bf16 v[96:111], v[228:231], v[228:231], v[96:111]
  s_branch L_k1O_c39_r
L_k1O_c40:
  v_mfma_f32_16x16x32_bf16 v[36:39], v[32:35], v[48:51], v[36:39]
  v_mfma_f32_16x16x32_bf16 v[40:43], v[32:35], v[52:55], v[40:43]
  s_branch L_k1O_c40_r
L_k1O_c41:
  v_mfma_f32_16x16x32_bf16 v[36:39], v[32:35], v[56:59], v[36:39]
  v_mfma_f32_16x16x32_bf16 v[40:43], v[32:35], v[60:63], v[40:43]
  s_branch L_k1O_c41_r
L_k1O_c42:
  v_mfma_f32_16x16x32_bf16 v[12:15], v[32:35], v[232:235], v[12:15]
  v_mfma_f32_16x16x32_bf16 v[12:15], v[32:35], v[236:239], v[12:15]
  v_mfma_f32_32x32x16_bf16 v[96:111], v[232:235], v[232:235], v[96:111]
  v_mfma_f32_32x32x16_bf16 v[96:111], v[236:239], v[236:239], v[96:111]
  s_branch L_k1O_c42_r
L_k1O_c43:
  v_mfma_f32_16x16x32_bf16 v[36:39], v[32:35], v[48:51], v[36:39]
  v_mfma_f32_16x16x32_bf16 v[40:43], v[32:35], v[52:55], v[40:43]
  s_branch L_k1O_c43_r
L_k1O_c44:
  v_mfma_f32_16x16x32_bf16 v[36:39], v[32:35], v[56:59], v[36:39]
  v_mfma_f32_16x16x32_bf16 v[40:43], v[32:35], v[60:63], v[40:43]
  s_branch L_k1O_c44_r
L_k1O_c45:
  v_mfma_f32_16x16x32_bf16 v[12:15], v[32:35], v[240:243], v[12:15]
  v_mfma_f32_16x16x32_bf16 v[12:15], v[32:35], v[244:247], v[12:15]
  v_mfma_f32_32x32x16_bf16 v[96:111], v[240:243], v[240:243], v[96:111]
  v_mfma_f32_32x32x16_bf16 v[96:111], v[244:247], v[244:247], v[96:111]
  s_branch L_k1O_c45_r
L_k1O_c46:
  v_mfma_f32_16x16x32_bf16 v[36:39], v[32:35], v[48:51], v[36:39]
  v_mfma_f32_16x16x32_bf16 v[40:43], v[32:35], v[52:55], v[40:43]
  s_branch L_k1O_c46_r
L_k1O_c47:
  v_mfma_f32_16x16x32_bf16 v[36:39], v[32:35], v[56:59], v[36:39]
  v_mfma_f32_16x16x32_bf16 v[40:43], v[32:35], v[60:63], v[40:43]
  s_branch L_k1O_c47_r
L_k1O_c48:
  v_mfma_f32_16x16x32_bf16 v[12:15], v[32:35], v[248:251], v[12:15]
  v_mfma_f32_16x16x32_bf16 v[12:15], v[32:35], v[252:255], v[12:15]
  v_mfma_f32_32x32x16_bf16 v[96:111], v[248:251], v[248:251], v[96:111]
  v_mfma_f32_32x32x16_bf16 v[96:111], v[252:255], v[252:255], v[96:111]
  s_branch L_k1O_c48_r
L_k1O_c49:
  v_mfma_f32_16x16x32_bf16 v[36:39], v[32:35], v[48:51], 0
  v_mfma_f32_16x16x32_bf16 v[36:39], v[32:35], v[52:55], v[36:39]
  s_branch L_k1O_c49_r
L_k1O_c50:
  v_mfma_f32_16x16x32_bf16 v[36:39], v[32:35], v[56:59], 0
  v_mfma_f32_16x16x32_bf16 v[36:39], v[32:35], v[60:63], v[36:39]
  s_branch L_k1O_c50_r
L_k1O_c51:
  v_mfma_f32_16x16x32_bf16 v[36:39], v[32:35], v[48:51], 0
  v_mfma_f32_16x16x32_bf16 v[36:39], v[32:35], v[52:55], v[36:39]
  s_branch L_k1O_c51_r
L_k1O_c52:
  v_mfma_f32_16x16x32_bf16 v[36:39], v[32:35], v[56:59], 0
  v_mfma_f32_16x16x32_bf16 v[36:39], v[32:35], v[60:63], v[36:39]
  s_branch L_k1O_c52_r
L_k1O_c53:
  v_mfma_f32_16x16x32_bf16 v[36:39], v[32:35], v[48:51], v[36:39]
  v_mfma_f32_16x16x32_bf16 v[36:39], v[32:35], v[52:55], v[36:39]
  s_branch L_k1O_c53_r
L_k1O_c54:
  v_mfma_f32_16x16x32_bf16 v[36:39], v[32:35], v[56:59], v[36:39]
  v_mfma_f32_16x16x32_bf16 v[36:39], v[32:35], v[60:63], v[36:39]
  s_branch L_k1O_c54_r
L_k1O_c55:
  v_mfma_f32_16x16x32_bf16 v[36:39], v[32:35], v[48:51], v[36:39]
  v_mfma_f32_16x16x32_bf16 v[36:39], v[32:35], v[52:55], v[36:39]
  s_branch L_k1O_c55_r
L_k1O_c56:
  v_mfma_f32_16x16x32_bf16 v[36:39], v[32:35], v[56:59], v[36:39]
  v_mfma_f32_16x16x32_bf16 v[36:39], v[32:35], v[60:63], v[36:39]
  s_branch L_k1O_c56_r
L_k1O_c57:
  v_mfma_f32_16x16x32_bf16 v[36:39], v[32:35], v[48:51], v[36:39]
  v_mfma_f32_16x16x32_bf16 v[36:39], v[32:35], v[52:55], v[36:39]
  s_branch L_k1O_c57_r
L_k1O_c58:
  v_mfma_f32_16x16x32_bf16 v[36:39], v[32:35], v[56:59], v[36:39]
  v_mfma_f32_16x16x32_bf16 v[36:39], v[32:35], v[60:63], v[36:39]
  s_branch L_k1O_c58_r
L_k1O_c59:
  v_mfma_f32_16x16x32_bf16 v[36:39], v[32:35], v[48:51], v[36:39]
  v_mfma_f32_16x16x32_bf16 v[36:39], v[32:35], v[52:55], v[36:39]
  s_branch L_k1O_c59_r
L_k1O_c60:
  v_mfma_f32_16x16x32_bf16 v[36:39], v[32:35], v[56:59], v[36:39]
  v_mfma_f32_16x16x32_bf16 v[36:39], v[32:35], v[60:63], v[36:39]
  s_branch L_k1O_c60_r
L_k1O_c61:
  v_mfma_f32_16x16x32_bf16 v[36:39], v[32:35], v[48:51], v[36:39]
  v_mfma_f32_16x16x32_bf16 v[36:39], v[32:35], v[52:55], v[36:39]
  s_branch L_k1O_c61_r
L_k1O_c62:
  v_mfma_f32_16x16x32_bf16 v[36:39], v[32:35], v[56:59], v[36:39]
  v_mfma_f32_16x16x32_bf16 v[36:39], v[32:35], v[60:63], v[36:39]
  s_branch L_k1O_c62_r
L_k1O_c63:
  v_mfma_f32_16x16x32_bf16 v[36:39], v[32:35], v[48:51], v[36:39]
  v_mfma_f32_16x16x32_bf16 v[36:39], v[32:35], v[52:55], v[36:39]
  s_branch L_k1O_c63_r
L_k1O_c64:
  v_mfma_f32_16x16x32_bf16 v[36:39], v[32:35], v[56:59], v[36:39]
  v_mfma_f32_16x16x32_bf16 v[36:39], v[32:35], v[60:63], v[36:39]
  s_branch L_k1O_c64_r
L_k1O_c65:
  v_mfma_f32_16x16x32_bf16 v[36:39], v[32:35], v[48:51], 0
  v_mfma_f32_16x16x32_bf16 v[40:43], v[32:35], v[52:55], 0
  s_branch L_k1O_c65_r
L_k1O_c66:
  v_mfma_f32_16x16x32_bf16 v[36:39], v[32:35], v[56:59], 0
  v_mfma_f32_16x16x32_bf16 v[40:43], v[32:35], v[60:63], 0
  s_branch L_k1O_c66_r
L_k1O_c67:
  v_mfma_f32_16x16x32_bf16 v[36:39], v[32:35], v[48:51], 0
  v_mfma_f32_16x16x32_bf16 v[40:43], v[32:35], v[52:55], 0
  s_branch L_k1O_c67_r
L_k1O_c68:
  v_mfma_f32_16x16x32_bf16 v[36:39], v[32:35], v[56:59], 0
  v_mfma_f32_16x16x32_bf16 v[40:43], v[32:35], v[60:63], 0
  s_branch L_k1O_c68_r
L_k1O_c69:
  v_mfma_f32_16x16x32_bf16 v[36:39], v[32:35], v[48:51], v[36:39]
  v_mfma_f32_16x16x32_bf16 v[40:43], v[32:35], v[52:55], v[40:43]
  s_branch L_k1O_c69_r
L_k1O_c70:
  v_mfma_f32_16x16x32_bf16 v[36:39], v[32:35], v[56:59], v[36:39]
  v_mfma_f32_16x16x32_bf16 v[40:43], v[32:35], v[60:63], v[40:43]
  s_branch L_k1O_c70_r
L_k1O_c71:
  v_mfma_f32_16x16x32_bf16 v[36:39], v[32:35], v[48:51], v[36:39]
  v_mfma_f32_16x16x32_bf16 v[40:43], v[32:35], v[52:55], v[40:43]
  s_branch L_k1O_c71_r
L_k1O_c72:
  v_mfma_f32_16x16x32_bf16 v[36:39], v[32:35], v[56:59], v[36:39]
  v_mfma_f32_16x16x32_bf16 v[40:43], v[32:35], v[60:63], v[40:43]
  s_branch L_k1O_c72_r
L_k1O_c73:
  v_mfma_f32_16x16x32_bf16 v[36:39], v[32:35], v[48:51], v[36:39]
  v_mfma_f32_16x16x32_bf16 v[40:43], v[32:35], v[52:55], v[40:43]
  s_branch L_k1O_c73_r
L_k1O_c74:
  v_mfma_f32_16x16x32_bf16 v[36:39], v[32:35], v[56:59], v[36:39]
  v_mfma_f32_16x16x32_bf16 v[40:43], v[32:35], v[60:63], v[40:43]
  s_branch L_k1O_c74_r
L_k1O_c75:
  v_mfma_f32_16x16x32_bf16 v[36:39], v[32:35], v[48:51], v[36:39]
  v_mfma_f32_16x16x32_bf16 v[40:43], v[32:35], v[52:55], v[40:43]
  s_branch L_k1O_c75_r
L_k1O_c76:
  v_mfma_f32_16x16x32_bf16 v[36:39], v[32:35], v[56:59], v[36:39]
  v_mfma_f32_16x16x32_bf16 v[40:43], v[32:35], v[60:63], v[40:43]
  s_branch L_k1O_c76_r
L_k1O_c77:
  v_mfma_f32_16x16x32_bf16 v[36:39], v[32:35], v[48:51], v[36:39]
  v_mfma_f32_16x16x32_bf16 v[40:43], v[32:35], v[52:55], v[40:43]
  s_branch L_k1O_c77_r
L_k1O_c78:
  v_mfma_f32_16x16x32_bf16 v[36:39], v[32:35], v[56:59], v[36:39]
  v_mfma_f32_16x16x32_bf16 v[40:43], v[32:35], v[60:63], v[40:43]
  s_branch L_k1O_c78_r
L_k1O_c79:
  v_mfma_f32_16x16x32_bf16 v[36:39], v[32:35], v[48:51], v[36:39]
  v_mfma_f32_16x16x32_bf16 v[40:43], v[32:35], v[52:55], v[40:43]
  s_branch L_k1O_c79_r
L_k1O_c80:
  v_mfma_f32_16x16x32_bf16 v[36:39], v[32:35], v[56:59], v[36:39]
  v_mfma_f32_16x16x32_bf16 v[40:43], v[32:35], v[60:63], v[40:43]
  s_branch L_k1O_c80_r
L_k1O_c81:
  v_mfma_f32_16x16x32_bf16 v[36:39], v[32:35], v[48:51], v[36:39]
  v_mfma_f32_16x16x32_bf16 v[40:43], v[32:35], v[52:55], v[40:43]
  s_branch L_k1O_c81_r
L_k1O_c82:
  v_mfma_f32_16x16x32_bf16 v[36:39], v[32:35], v[56:59], v[36:39]
  v_mfma_f32_16x16x32_bf16 v[40:43], v[32:35], v[60:63], v[40:43]
  s_branch L_k1O_c82_r
L_k1O_c83:
  v_mfma_f32_16x16x32_bf16 v[36:39], v[32:35], v[48:51], v[36:39]
  v_mfma_f32_16x16x32_bf16 v[40:43], v[32:35], v[52:55], v[40:43]
  s_branch L_k1O_c83_r
L_k1O_c84:
  v_mfma_f32_16x16x32_bf16 v[36:39], v[32:35], v[56:59], v[36:39]
  v_mfma_f32_16x16x32_bf16 v[40:43], v[32:35], v[60:63], v[40:43]
  s_branch L_k1O_c84_r
L_k1O_c85:
  v_mfma_f32_16x16x32_bf16 v[36:39], v[32:35], v[48:51], v[36:39]
  v_mfma_f32_16x16x32_bf16 v[40:43], v[32:35], v[52:55], v[40:43]
  s_branch L_k1O_c85_r
L_k1O_c86:
  v_mfma_f32_16x16x32_bf16 v[36:39], v[32:35], v[56:59], v[36:39]
  v_mfma_f32_16x16x32_bf16 v[40:43], v[32:35], v[60:63], v[40:43]
  s_branch L_k1O_c86_r
L_k1O_c87:
  v_mfma_f32_16x16x32_bf16 v[36:39], v[32:35], v[48:51], v[36:39]
  v_mfma_f32_16x16x32_bf16 v[40:43], v[32:35], v[52:55], v[40:43]
  s_branch L_k1O_c87_r
L_k1O_c88:
  v_mfma_f32_16x16x32_bf16 v[36:39], v[32:35], v[56:59], v[36:39]
  v_mfma_f32_16x16x32_bf16 v[40:43], v[32:35], v[60:63], v[40:43]
  s_branch L_k1O_c88_r
L_k1O_c89:
  v_mfma_f32_16x16x32_bf16 v[36:39], v[32:35], v[48:51], v[36:39]
  v_mfma_f32_16x16x32_bf16 v[40:43], v[32:35], v[52:55], v[40:43]
  s_branch L_k1O_c89_r
L_k1O_c90:
  v_mfma_f32_16x16x32_bf16 v[36:39], v[32:35], v[56:59], v[36:39]
  v_mfma_f32_16x16x32_bf16 v[40:43], v[32:35], v[60:63], v[40:43]
  s_branch L_k1O_c90_r
L_k1O_c91:
  v_mfma_f32_16x16x32_bf16 v[36:39], v[32:35], v[48:51], v[36:39]
  v_mfma_f32_16x16x32_bf16 v[40:43], v[32:35], v[52:55], v[40:43]
  s_branch L_k1O_c91_r
L_k1O_c92:
  v_mfma_f32_16x16x32_bf16 v[36:39], v[32:35], v[56:59], v[36:39]
  v_mfma_f32_16x16x32_bf16 v[40:43], v[32:35], v[60:63], v[40:43]
  s_branch L_k1O_c92_r
L_k1O_c93:
  v_mfma_f32_16x16x32_bf16 v[36:39], v[32:35], v[48:51], v[36:39]
  v_mfma_f32_16x16x32_bf16 v[40:43], v[32:35], v[52:55], v[40:43]
  s_branch L_k1O_c93_r
L_k1O_c94:
  v_mfma_f32_16x16x32_bf16 v[36:39], v[32:35], v[56:59], v[36:39]
  v_mfma_f32_16x16x32_bf16 v[40:43], v[32:35], v[60:63], v[40:43]
  s_branch L_k1O_c94_r
L_k1O_c95:
  v_mfma_f32_16x16x32_bf16 v[36:39], v[32:35], v[48:51], v[36:39]
  v_mfma_f32_16x16x32_bf16 v[40:43], v[32:35], v[52:55], v[40:43]
  s_branch L_k1O_c95_r
L_k1O_c96:
  v_mfma_f32_16x16x32_bf16 v[36:39], v[32:35], v[56:59], v[36:39]
  v_mfma_f32_16x16x32_bf16 v[40:43], v[32:35], v[60:63], v[40:43]
  s_branch L_k1O_c96_r
L_k1_exit:
  s_endpgm
.fill 64, 4, 0xBF800000
.p2alignl 16, 0xBF800000
.fill 512, 4, 0xBF800000
.section .rodata,"a"
.p2align 6
.amdhsa_kernel recurrent_scan__linear_attn_block__glu_gated_geglu__prompt_kernel
  .amdhsa_next_free_vgpr 256
  .amdhsa_next_free_sgpr 102
  .amdhsa_accum_offset 256
  .amdhsa_group_segment_fixed_size 0
  .amdhsa_kernarg_size 80
  .amdhsa_user_sgpr_count 2
  .amdhsa_user_sgpr_kernarg_segment_ptr 1
  .amdhsa_system_sgpr_workgroup_id_x 1
.end_amdhsa_kernel
```
